```python
import torch

def _softmax(x, axis=-1):
    return torch.softmax(x, dim=axis)
def _gelu(x):
    return torch.nn.functional.gelu(x, approximate="tanh")
def _silu(x):
    return torch.nn.functional.silu(x)
def _sigmoid(x):
    return torch.sigmoid(x)
def _layernorm(x, axis=-1, eps=1e-5):
    m = x.mean(dim=axis, keepdim=True)
    v = x.var(dim=axis, keepdim=True, unbiased=False)
    return (x - m) / torch.sqrt(v + eps)
def _scatter_add(tgt, idx, src, axis=0):
    return tgt.clone().index_add_(axis, idx, src)
def _segment_sum(src, seg, n):
    out = torch.zeros((n,) + src.shape[1:], dtype=src.dtype)
    return out.index_add_(0, seg, src)
def _pad(x, pw):
    flat = tuple(v for pair in reversed(pw) for v in pair)
    return torch.nn.functional.pad(x, flat)

kernel_name = 'standalone__mha_block_cached__near_ridge'

def setup_inputs():

    _w = (lambda a: (lambda t: t.to(torch.bfloat16) if t.is_floating_point() else t)(torch.as_tensor(a)))
    B, Sq, D = 16, 192, 576
    H, Sk, Dh = 32, 1024, 128
    return {
        "x": _w((lambda *s: torch.randn(*s, dtype=torch.bfloat16) * 0.8)(B, Sq, D)),
        "k_cache": _w((lambda *s: torch.randn(*s, dtype=torch.bfloat16) * 0.8)(B, H, Sk, Dh)),
        "v_cache": _w((lambda *s: torch.randn(*s, dtype=torch.bfloat16) * 0.05)(B, H, Sk, Dh)),
        "wq": _w((lambda *s: torch.randn(*s, dtype=torch.bfloat16) * 0.8)(D, H * Dh) * (D ** -0.5)),
        "wo": _w((lambda *s: torch.randn(*s, dtype=torch.bfloat16) * 0.05)(H * Dh, D) * ((H * Dh) ** -0.5)),
    }

def reference(x, k_cache, v_cache, wq, wo):
    B, Sq, D = x.shape
    H, Dh = 32, 128
    q = (lambda x, *d: x.permute(*d))((x @ wq).reshape(B, Sq, H, Dh), 0, 2, 1, 3)
    scores = torch.einsum("bhqd,bhkd->bhqk", q, k_cache) * (Dh ** -0.5)
    p = _softmax(scores, axis=-1)
    o = torch.einsum("bhqk,bhkd->bhqd", p, v_cache)
    return (lambda x, *d: x.permute(*d))(o, 0, 2, 1, 3).reshape(B, Sq, H * Dh) @ wo
```

```asm
; @launch grid=(256,1,1) block=(256,1,1) lds=163840
.amdgcn_target "amdgcn-amd-amdhsa--gfx950"
.text
.globl standalone__mha_block_cached__near_ridge_kernel
.p2align 8
.type standalone__mha_block_cached__near_ridge_kernel,@function
standalone__mha_block_cached__near_ridge_kernel:
    s_cmp_ge_u32 s2, 256
    s_cbranch_scc1 L_end
    s_load_dwordx16 s[4:19], s[0:1], 0
    s_getpc_b64 s[82:83]
L_pce:
    s_lshr_b32 s3, s2, 3
    s_lshl_b32 s3, s3, 11
    v_lshrrev_b32 v15, 4, v0
    v_lshl_add_u32 v15, v15, 7, s3
    v_min_u32 v15, L_codeend-L_pce, v15
    global_load_dword v16, v15, s[82:83]
    v_lshrrev_b32 v28, 6, v0
    s_nop 0
    v_readfirstlane_b32 s52, v28
    v_and_b32 v0, 63, v0
    s_and_b32 s55, s2, 1
    s_lshl_b32 s55, s55, 3
    s_bfe_u32 s53, s2, 0x30003
    s_or_b32 s53, s53, s55
    s_bfe_u32 s55, s2, 0x20001
    s_lshl_b32 s55, s55, 2
    s_lshr_b32 s54, s2, 6
    s_or_b32 s54, s54, s55
    v_lshrrev_b32 v29, 4, v0
    v_bfe_u32 v30, v0, 2, 2
    v_and_b32 v28, 3, v0
    v_lshlrev_b32 v1, 13, v30
    v_lshl_add_u32 v1, v29, 6, v1
    v_lshl_add_u32 v1, v28, 4, v1
    s_lshr_b32 s55, s52, 1
    s_lshl_b32 s55, s55, 8
    s_and_b32 s56, s52, 1
    s_lshl_b32 s81, s56, 17
    s_add_u32 s55, s55, s81
    v_add_u32 v1, s55, v1
    v_lshrrev_b32 v31, 3, v0
    v_and_b32 v32, 6, v31
    v_and_b32 v33, 7, v0
    v_xor_b32 v32, v32, v33
    v_lshlrev_b32 v32, 4, v32
    s_mul_i32 s55, s52, 48
    v_add_u32 v31, s55, v31
    v_mul_u32_u24 v2, 1152, v31
    v_add_u32 v2, v2, v32
    s_mov_b32 s58, 0
    s_mov_b32 s59, 0
    s_lshl_b32 s60, s52, 12
    s_add_u32 s60, s60, 147456
    s_mul_i32 s61, s52, 6144
    s_add_u32 s61, s61, 98304
    s_mul_i32 s62, s53, 221184
    s_lshl_b32 s63, s54, 9
    s_waitcnt lgkmcnt(0)
    s_add_u32 s20, s4, s62
    s_addc_u32 s21, s5, 0
    s_mov_b32 s22, 221184
    s_mov_b32 s23, 0x20000
    s_add_u32 s24, s10, s63
    s_addc_u32 s25, s11, 0
    s_mov_b32 s26, 0
    s_mov_b32 s27, 0x20000
    s_sub_u32 s26, 4718592, s63
    s_mov_b32 m0, s60
    s_add_u32 s55, s58, 0
    buffer_load_dwordx4 v1, s[24:27], s55 offen offset:0 sc1 lds
    s_add_u32 s55, s58, 31744
    buffer_load_dwordx4 v1, s[24:27], s55 offen offset:1024 sc1 lds
    s_add_u32 s55, s58, 63488
    buffer_load_dwordx4 v1, s[24:27], s55 offen offset:2048 sc1 lds
    s_add_u32 s55, s58, 95232
    buffer_load_dwordx4 v1, s[24:27], s55 offen offset:3072 sc1 lds
    s_add_u32 s58, s58, 262144
    s_add_u32 s60, s60, 16384
    s_cmp_ge_u32 s60, 163840
    s_cselect_b32 s56, 163840, 0
    s_sub_u32 s60, s60, s56
    s_lshr_b32 s56, s60, 14
    s_cmp_eq_u32 s56, 3
    s_cselect_b32 s56, 81920, 0
    s_add_u32 s60, s60, s56
    s_add_u32 m0, s61, 0
    s_add_u32 s55, s59, 0
    buffer_load_dwordx4 v2, s[20:23], s55 offen offset:0 sc1 lds
    s_add_u32 s55, s59, 8192
    buffer_load_dwordx4 v2, s[20:23], s55 offen offset:1024 sc1 lds
    s_add_u32 s55, s59, 16384
    buffer_load_dwordx4 v2, s[20:23], s55 offen offset:2048 sc1 lds
    s_add_u32 s55, s59, 24576
    buffer_load_dwordx4 v2, s[20:23], s55 offen offset:3072 sc1 lds
    s_add_u32 m0, s61, 4096
    s_add_u32 s55, s59, 36864
    buffer_load_dwordx4 v2, s[20:23], s55 offen offset:0 sc1 lds
    s_add_u32 s55, s59, 45056
    buffer_load_dwordx4 v2, s[20:23], s55 offen offset:1024 sc1 lds
    s_add_u32 s59, s59, 128
    s_add_u32 s61, s61, 24576
    s_cmp_ge_u32 s61, 122880
    s_cselect_b32 s56, 73728, 0
    s_sub_u32 s61, s61, s56
    s_mov_b32 m0, s60
    s_add_u32 s55, s58, 0
    buffer_load_dwordx4 v1, s[24:27], s55 offen offset:0 sc1 lds
    s_add_u32 s55, s58, 31744
    buffer_load_dwordx4 v1, s[24:27], s55 offen offset:1024 sc1 lds
    s_add_u32 s55, s58, 63488
    buffer_load_dwordx4 v1, s[24:27], s55 offen offset:2048 sc1 lds
    s_add_u32 s55, s58, 95232
    buffer_load_dwordx4 v1, s[24:27], s55 offen offset:3072 sc1 lds
    s_add_u32 s58, s58, 262144
    s_add_u32 s60, s60, 16384
    s_cmp_ge_u32 s60, 163840
    s_cselect_b32 s56, 163840, 0
    s_sub_u32 s60, s60, s56
    s_lshr_b32 s56, s60, 14
    s_cmp_eq_u32 s56, 3
    s_cselect_b32 s56, 81920, 0
    s_add_u32 s60, s60, s56
    s_mov_b32 m0, s60
    s_add_u32 s55, s58, 0
    buffer_load_dwordx4 v1, s[24:27], s55 offen offset:0 sc1 lds
    s_add_u32 s55, s58, 31744
    buffer_load_dwordx4 v1, s[24:27], s55 offen offset:1024 sc1 lds
    s_add_u32 s55, s58, 63488
    buffer_load_dwordx4 v1, s[24:27], s55 offen offset:2048 sc1 lds
    s_add_u32 s55, s58, 95232
    buffer_load_dwordx4 v1, s[24:27], s55 offen offset:3072 sc1 lds
    s_add_u32 s58, s58, 262144
    s_add_u32 s60, s60, 16384
    s_cmp_ge_u32 s60, 163840
    s_cselect_b32 s56, 163840, 0
    s_sub_u32 s60, s60, s56
    s_lshr_b32 s56, s60, 14
    s_cmp_eq_u32 s56, 3
    s_cselect_b32 s56, 81920, 0
    s_add_u32 s60, s60, s56
    s_and_b32 s56, s52, 1
    s_lshl_b32 s56, s56, 1
    v_xor_b32 v3, s56, v28
    v_lshlrev_b32 v3, 4, v3
    v_lshl_add_u32 v3, v30, 8, v3
    v_lshl_add_u32 v3, v29, 6, v3
    s_lshl_b32 s65, s52, 11
    v_add_u32 v3, s65, v3
    s_add_u32 s65, s65, 98304
    s_lshl_b32 s55, s53, 23
    s_lshl_b32 s56, s54, 19
    s_add_u32 s55, s55, s56
    s_add_u32 s44, s6, s55
    s_addc_u32 s45, s7, 0
    s_mov_b32 s46, 524288
    s_mov_b32 s47, 0x20000
    s_add_u32 s28, s6, s55
    s_addc_u32 s29, s7, 0
    s_add_u32 s28, s28, 8192
    s_addc_u32 s29, s29, 0
    s_mov_b32 s30, 253952
    s_mov_b32 s31, 0x20000
    s_add_u32 s36, s6, s55
    s_addc_u32 s37, s7, 0
    s_add_u32 s36, s36, 270336
    s_addc_u32 s37, s37, 0
    s_mov_b32 s38, 253952
    s_mov_b32 s39, 0x20000
    s_add_u32 s32, s8, s55
    s_addc_u32 s33, s9, 0
    s_mov_b32 s34, 262144
    s_mov_b32 s35, 0x20000
    s_add_u32 s40, s8, s55
    s_addc_u32 s41, s9, 0
    s_add_u32 s40, s40, 262144
    s_addc_u32 s41, s41, 0
    s_mov_b32 s42, 262144
    s_mov_b32 s43, 0x20000
    s_mov_b32 s66, 0
    s_mul_i32 s55, s53, 1572864
    s_add_u32 s48, s18, s55
    s_addc_u32 s49, s19, 0
    s_mov_b32 s50, 1572864
    s_mov_b32 s51, 0x20000
    s_lshr_b32 s100, s52, 1
    s_lshl_b32 s81, s54, 1
    s_add_u32 s100, s100, s81
    s_mul_i32 s100, s100, 49152
    s_and_b32 s81, s52, 1
    s_mul_i32 s81, s81, 6144
    s_add_u32 s100, s100, s81
    s_lshr_b32 s81, s52, 1
    s_mul_i32 s81, s81, 3072
    s_add_u32 s101, s100, 3072
    s_sub_u32 s101, s101, s81
    s_add_u32 s100, s100, s81
    s_lshr_b32 s55, s54, 2
    s_mul_i32 s55, s55, 1179648
    s_and_b32 s56, s54, 3
    s_mul_i32 s81, s56, 288
    s_add_u32 s55, s55, s81
    s_add_u32 s72, s12, s55
    s_addc_u32 s73, s13, 0
    s_mov_b32 s74, 1178784
    s_mov_b32 s75, 0x20000
    s_mov_b32 s78, s56
    s_add_u32 s76, s18, 67108864
    s_addc_u32 s77, s19, 0
    s_lshl_b32 s55, s53, 3
    s_lshr_b32 s56, s54, 1
    s_add_u32 s55, s55, s56
    s_lshl_b32 s55, s55, 7
    v_lshl_add_u32 v60, v28, 2, s55
    s_mov_b32 s67, 0x47800000
    s_mov_b32 s68, 0x3e0293ee
    s_mov_b32 s69, 0x3e0293ee
    s_lshr_b32 s55, s2, 3
    s_and_b32 s55, s55, 3
    s_sub_u32 s55, 15, s55
    s_cmp_eq_u32 s52, 0
    s_cselect_b32 s80, s55, 99
    s_sub_u32 s3, s80, 8
    v_lshlrev_b32 v13, 11, v29
    v_lshl_add_u32 v13, v30, 6, v13
    v_lshl_add_u32 v13, v28, 4, v13
    s_lshr_b32 s55, s52, 1
    s_lshl_b32 s55, s55, 13
    v_add_u32 v13, s55, v13
    v_add_u32 v4, 147456, v13
    v_and_b32 v31, 15, v0
    v_and_b32 v14, 6, v0
    v_xor_b32 v14, v14, v29
    v_lshlrev_b32 v14, 4, v14
    v_lshl_add_u32 v14, v31, 7, v14
    s_and_b32 s56, s52, 1
    s_mul_i32 s56, s56, 12288
    s_lshr_b32 s81, s52, 1
    s_mul_i32 s81, s81, 6144
    s_add_u32 s56, s56, s81
    s_lshl_b32 s81, s81, 1
    s_sub_u32 s79, 6144, s81
    v_add_u32 v14, s56, v14
    v_add_u32 v5, 98304, v14
    v_xor_b32 v6, 64, v5
    s_mov_b32 s62, 147456
    s_mov_b32 s63, 98304
    v_and_b32 v11, 1, v30
    v_lshlrev_b32 v11, 1, v11
    v_lshrrev_b32 v7, 1, v30
    v_or_b32 v7, v7, v11
    v_xor_b32 v11, v11, v29
    v_lshlrev_b32 v11, 4, v11
    v_lshl_add_u32 v11, v7, 10, v11
    v_lshl_add_u32 v11, v28, 6, v11
    s_sub_u32 s82, 32768, s55
    s_lshl_b32 s55, s55, 1
    v_add_u32 v11, s55, v11
    v_and_b32 v9, 1, v29
    v_lshrrev_b32 v12, 1, v29
    v_lshl_add_u32 v12, v9, 1, v12
    v_lshlrev_b32 v12, 10, v12
    v_lshl_add_u32 v12, v30, 6, v12
    v_lshl_add_u32 v12, v9, 5, v12
    v_lshl_add_u32 v12, v28, 3, v12
    v_add_u32 v12, s55, v12
    v_add_u32 v8, s79, v5
    v_add_u32 v9, s79, v6
    s_mov_b32 s64, 98304
    s_lshl_b32 s55, s2, 2
    s_add_u32 s55, s55, s52
    s_mul_i32 s55, s55, 4608
    v_min_u32 v15, 47, v0
    v_lshl_add_u32 v15, v15, 4, s55
    s_lshr_b32 s70, s54, 2
    s_lshl_b32 s70, s70, 2
    s_add_u32 s70, s70, 4
    s_mov_b32 s71, -18
    v_mov_b32 v20, 0
    s_add_u32 m0, s61, 0
    s_add_u32 s55, s59, 0
    buffer_load_dwordx4 v2, s[20:23], s55 offen offset:0 sc1 lds
    s_add_u32 s55, s59, 8192
    buffer_load_dwordx4 v2, s[20:23], s55 offen offset:1024 sc1 lds
    s_add_u32 s55, s59, 16384
    buffer_load_dwordx4 v2, s[20:23], s55 offen offset:2048 sc1 lds
    s_add_u32 s55, s59, 24576
    buffer_load_dwordx4 v2, s[20:23], s55 offen offset:3072 sc1 lds
    s_add_u32 m0, s61, 4096
    s_add_u32 s55, s59, 36864
    buffer_load_dwordx4 v2, s[20:23], s55 offen offset:0 sc1 lds
    s_add_u32 s55, s59, 45056
    buffer_load_dwordx4 v2, s[20:23], s55 offen offset:1024 sc1 lds
    s_add_u32 s59, s59, 128
    s_add_u32 s61, s61, 24576
    s_cmp_ge_u32 s61, 122880
    s_cselect_b32 s56, 73728, 0
    s_sub_u32 s61, s61, s56
    s_mov_b32 m0, s60
    s_add_u32 s55, s58, 0
    buffer_load_dwordx4 v1, s[24:27], s55 offen offset:0 sc1 lds
    s_add_u32 s55, s58, 31744
    buffer_load_dwordx4 v1, s[24:27], s55 offen offset:1024 sc1 lds
    s_add_u32 s55, s58, 63488
    buffer_load_dwordx4 v1, s[24:27], s55 offen offset:2048 sc1 lds
    s_add_u32 s55, s58, 95232
    buffer_load_dwordx4 v1, s[24:27], s55 offen offset:3072 sc1 lds
    s_add_u32 s58, s58, 262144
    s_add_u32 s60, s60, 16384
    s_cmp_ge_u32 s60, 163840
    s_cselect_b32 s56, 163840, 0
    s_sub_u32 s60, s60, s56
    s_lshr_b32 s56, s60, 14
    s_cmp_eq_u32 s56, 3
    s_cselect_b32 s56, 81920, 0
    s_add_u32 s60, s60, s56
    global_store_dword v60, v20, s[76:77] sc1
    s_waitcnt vmcnt(15)
    s_barrier
    ds_read_b64_tr_b16 a[192:193], v4 offset:0
    ds_read_b64_tr_b16 a[194:195], v4 offset:1024
    ds_read_b128 v[16:19], v5 offset:0
    ds_read_b128 v[20:23], v5 offset:2048
    ds_read_b128 v[24:27], v5 offset:4096
    ds_read_b128 v[28:31], v8 offset:0
    ds_read_b128 v[32:35], v8 offset:2048
    ds_read_b128 v[36:39], v8 offset:4096
    ds_read_b64_tr_b16 a[196:197], v4 offset:8
    ds_read_b64_tr_b16 a[198:199], v4 offset:1032
    ds_read_b64_tr_b16 a[200:201], v4 offset:256
    ds_read_b64_tr_b16 a[202:203], v4 offset:1280
    ds_read_b64_tr_b16 a[204:205], v4 offset:264
    ds_read_b64_tr_b16 a[206:207], v4 offset:1288
    ds_read_b64_tr_b16 a[208:209], v4 offset:512
    ds_read_b64_tr_b16 a[210:211], v4 offset:1536
    ds_read_b64_tr_b16 a[212:213], v4 offset:520
    ds_read_b64_tr_b16 a[214:215], v4 offset:1544
    ds_read_b64_tr_b16 a[216:217], v4 offset:768
    ds_read_b64_tr_b16 a[218:219], v4 offset:1792
    ds_read_b64_tr_b16 a[220:221], v4 offset:776
    ds_read_b64_tr_b16 a[222:223], v4 offset:1800
    s_add_u32 s62, s62, 16384
    s_cmp_ge_u32 s62, 163840
    s_cselect_b32 s81, 163840, 0
    s_sub_u32 s62, s62, s81
    s_lshr_b32 s81, s62, 14
    s_cmp_eq_u32 s81, 3
    s_cselect_b32 s81, 81920, 0
    s_add_u32 s62, s62, s81
    v_add_u32 v4, s62, v13
    s_waitcnt lgkmcnt(0)
    v_mfma_f32_16x16x32_bf16 v[64:67], a[192:195], v[16:19], 0
    ds_read_b64_tr_b16 a[224:225], v4 offset:0
    v_mfma_f32_16x16x32_bf16 v[96:99], a[192:195], v[20:23], 0
    s_mov_b32 m0, s60
    ds_read_b64_tr_b16 a[226:227], v4 offset:1024
    v_mfma_f32_16x16x32_bf16 v[128:131], a[192:195], v[24:27], 0
    s_add_u32 s55, s58, 0
    buffer_load_dwordx4 v1, s[24:27], s55 offen offset:0 sc1 lds
    v_mfma_f32_16x16x32_bf16 v[160:163], a[192:195], v[28:31], 0
    ds_read_b128 v[40:43], v6 offset:0
    v_mfma_f32_16x16x32_bf16 v[192:195], a[192:195], v[32:35], 0
    ds_read_b128 v[44:47], v6 offset:2048
    v_mfma_f32_16x16x32_bf16 v[224:227], a[192:195], v[36:39], 0
    ds_read_b128 v[48:51], v6 offset:4096
    v_mfma_f32_16x16x32_bf16 v[68:71], a[196:199], v[16:19], 0
    s_add_u32 s55, s58, 31744
    buffer_load_dwordx4 v1, s[24:27], s55 offen offset:1024 sc1 lds
    v_mfma_f32_16x16x32_bf16 v[100:103], a[196:199], v[20:23], 0
    ds_read_b128 v[52:55], v9 offset:0
    v_mfma_f32_16x16x32_bf16 v[132:135], a[196:199], v[24:27], 0
    ds_read_b128 v[56:59], v9 offset:2048
    v_mfma_f32_16x16x32_bf16 v[164:167], a[196:199], v[28:31], 0
    s_add_u32 s63, s63, 24576
    ds_read_b128 v[60:63], v9 offset:4096
    v_mfma_f32_16x16x32_bf16 v[196:199], a[196:199], v[32:35], 0
    s_add_u32 s55, s58, 63488
    s_cmp_ge_u32 s63, 122880
    s_cselect_b32 s81, 73728, 0
    buffer_load_dwordx4 v1, s[24:27], s55 offen offset:2048 sc1 lds
    v_mfma_f32_16x16x32_bf16 v[228:231], a[196:199], v[36:39], 0
    s_sub_u32 s63, s63, s81
    ds_read_b64_tr_b16 a[228:229], v4 offset:8
    v_mfma_f32_16x16x32_bf16 v[72:75], a[200:203], v[16:19], 0
    ds_read_b64_tr_b16 a[230:231], v4 offset:1032
    v_mfma_f32_16x16x32_bf16 v[104:107], a[200:203], v[20:23], 0
    ds_read_b64_tr_b16 a[232:233], v4 offset:256
    v_mfma_f32_16x16x32_bf16 v[136:139], a[200:203], v[24:27], 0
    s_add_u32 s55, s58, 95232
    buffer_load_dwordx4 v1, s[24:27], s55 offen offset:3072 sc1 lds
    v_mfma_f32_16x16x32_bf16 v[168:171], a[200:203], v[28:31], 0
    s_add_u32 s58, s58, 262144
    s_add_u32 s60, s60, 16384
    s_cmp_ge_u32 s60, 163840
    s_cselect_b32 s56, 163840, 0
    s_sub_u32 s60, s60, s56
    s_lshr_b32 s56, s60, 14
    s_cmp_eq_u32 s56, 3
    s_cselect_b32 s56, 81920, 0
    s_add_u32 s60, s60, s56
    s_add_u32 s62, s62, 16384
    ds_read_b64_tr_b16 a[234:235], v4 offset:1280
    v_mfma_f32_16x16x32_bf16 v[200:203], a[200:203], v[32:35], 0
    s_cmp_ge_u32 s62, 163840
    s_cselect_b32 s81, 163840, 0
    ds_read_b64_tr_b16 a[236:237], v4 offset:264
    v_mfma_f32_16x16x32_bf16 v[232:235], a[200:203], v[36:39], 0
    s_add_u32 m0, s61, 0
    s_sub_u32 s62, s62, s81
    ds_read_b64_tr_b16 a[238:239], v4 offset:1288
    v_mfma_f32_16x16x32_bf16 v[76:79], a[204:207], v[16:19], 0
    s_add_u32 s55, s59, 0
    s_lshr_b32 s81, s62, 14
    buffer_load_dwordx4 v2, s[20:23], s55 offen offset:0 sc1 lds
    v_mfma_f32_16x16x32_bf16 v[108:111], a[204:207], v[20:23], 0
    s_cmp_eq_u32 s81, 3
    s_cselect_b32 s81, 81920, 0
    ds_read_b64_tr_b16 a[240:241], v4 offset:512
    v_mfma_f32_16x16x32_bf16 v[140:143], a[204:207], v[24:27], 0
    ds_read_b64_tr_b16 a[242:243], v4 offset:1536
    v_mfma_f32_16x16x32_bf16 v[172:175], a[204:207], v[28:31], 0
    ds_read_b64_tr_b16 a[244:245], v4 offset:520
    v_mfma_f32_16x16x32_bf16 v[204:207], a[204:207], v[32:35], 0
    s_add_u32 s55, s59, 8192
    s_add_u32 s62, s62, s81
    buffer_load_dwordx4 v2, s[20:23], s55 offen offset:1024 sc1 lds
    v_mfma_f32_16x16x32_bf16 v[236:239], a[204:207], v[36:39], 0
    ds_read_b64_tr_b16 a[246:247], v4 offset:1544
    v_mfma_f32_16x16x32_bf16 v[80:83], a[208:211], v[16:19], 0
    ds_read_b64_tr_b16 a[248:249], v4 offset:768
    v_mfma_f32_16x16x32_bf16 v[112:115], a[208:211], v[20:23], 0
    ds_read_b64_tr_b16 a[250:251], v4 offset:1792
    v_mfma_f32_16x16x32_bf16 v[144:147], a[208:211], v[24:27], 0
    s_add_u32 s55, s59, 16384
    buffer_load_dwordx4 v2, s[20:23], s55 offen offset:2048 sc1 lds
    v_mfma_f32_16x16x32_bf16 v[176:179], a[208:211], v[28:31], 0
    ds_read_b64_tr_b16 a[252:253], v4 offset:776
    v_mfma_f32_16x16x32_bf16 v[208:211], a[208:211], v[32:35], 0
    ds_read_b64_tr_b16 a[254:255], v4 offset:1800
    v_mfma_f32_16x16x32_bf16 v[240:243], a[208:211], v[36:39], 0
    v_mfma_f32_16x16x32_bf16 v[84:87], a[212:215], v[16:19], 0
    s_add_u32 s55, s59, 24576
    buffer_load_dwordx4 v2, s[20:23], s55 offen offset:3072 sc1 lds
    v_mfma_f32_16x16x32_bf16 v[116:119], a[212:215], v[20:23], 0
    v_mfma_f32_16x16x32_bf16 v[148:151], a[212:215], v[24:27], 0
    v_mfma_f32_16x16x32_bf16 v[180:183], a[212:215], v[28:31], 0
    s_add_u32 m0, s61, 4096
    v_mfma_f32_16x16x32_bf16 v[212:215], a[212:215], v[32:35], 0
    s_add_u32 s55, s59, 36864
    buffer_load_dwordx4 v2, s[20:23], s55 offen offset:0 sc1 lds
    v_mfma_f32_16x16x32_bf16 v[244:247], a[212:215], v[36:39], 0
    v_mfma_f32_16x16x32_bf16 v[88:91], a[216:219], v[16:19], 0
    v_mfma_f32_16x16x32_bf16 v[120:123], a[216:219], v[20:23], 0
    v_mfma_f32_16x16x32_bf16 v[152:155], a[216:219], v[24:27], 0
    s_add_u32 s55, s59, 45056
    buffer_load_dwordx4 v2, s[20:23], s55 offen offset:1024 sc1 lds
    v_mfma_f32_16x16x32_bf16 v[184:187], a[216:219], v[28:31], 0
    s_add_u32 s59, s59, 128
    s_add_u32 s61, s61, 24576
    s_cmp_ge_u32 s61, 122880
    s_cselect_b32 s56, 73728, 0
    s_sub_u32 s61, s61, s56
    v_mfma_f32_16x16x32_bf16 v[216:219], a[216:219], v[32:35], 0
    v_mfma_f32_16x16x32_bf16 v[248:251], a[216:219], v[36:39], 0
    v_mfma_f32_16x16x32_bf16 v[92:95], a[220:223], v[16:19], 0
    v_add_u32 v4, s62, v13
    v_mfma_f32_16x16x32_bf16 v[124:127], a[220:223], v[20:23], 0
    v_add_u32 v5, s63, v14
    v_mfma_f32_16x16x32_bf16 v[156:159], a[220:223], v[24:27], 0
    v_xor_b32 v6, 64, v5
    v_mfma_f32_16x16x32_bf16 v[188:191], a[220:223], v[28:31], 0
    v_add_u32 v8, s79, v5
    v_mfma_f32_16x16x32_bf16 v[220:223], a[220:223], v[32:35], 0
    v_add_u32 v9, s79, v6
    v_mfma_f32_16x16x32_bf16 v[252:255], a[220:223], v[36:39], 0
    s_waitcnt vmcnt(10) lgkmcnt(0)
    s_barrier
    s_mov_b32 s83, 8192
    v_mfma_f32_16x16x32_bf16 v[64:67], a[224:227], v[40:43], v[64:67]
    v_add_u32 v7, 0, v0
    ds_read_b64_tr_b16 a[192:193], v4 offset:0
    v_mul_u32_u24 v10, 3641, v7
    v_mfma_f32_16x16x32_bf16 v[96:99], a[224:227], v[44:47], v[96:99]
    s_mov_b32 m0, s60
    ds_read_b64_tr_b16 a[194:195], v4 offset:1024
    v_lshrrev_b32 v10, 16, v10
    v_mad_i32_i24 v7, v10, s71, v7
    v_mfma_f32_16x16x32_bf16 v[128:131], a[224:227], v[48:51], v[128:131]
    s_add_u32 s55, s58, 0
    v_mul_u32_u24 v10, 1152, v10
    buffer_load_dwordx4 v1, s[24:27], s55 offen offset:0 sc1 lds
    v_accvgpr_write_b32 a0, v10
    v_cmp_gt_u32 vcc, 16, v7
    v_mfma_f32_16x16x32_bf16 v[160:163], a[224:227], v[52:55], v[160:163]
    s_add_u32 s60, s60, 16384
    ds_read_b128 v[16:19], v5 offset:0
    v_add_u32 v10, s70, v7
    v_and_b32 v10, 15, v10
    v_mfma_f32_16x16x32_bf16 v[192:195], a[224:227], v[56:59], v[192:195]
    s_cmp_ge_u32 s60, 163840
    s_cselect_b32 s56, 163840, 0
    v_cndmask_b32 v7, v7, v10, vcc
    ds_read_b128 v[20:23], v5 offset:2048
    v_accvgpr_read_b32 v10, a0
    v_mfma_f32_16x16x32_bf16 v[224:227], a[224:227], v[60:63], v[224:227]
    s_sub_u32 s60, s60, s56
    v_mfma_f32_16x16x32_bf16 v[68:71], a[228:231], v[40:43], v[68:71]
    s_lshr_b32 s56, s60, 14
    ds_read_b128 v[24:27], v5 offset:4096
    v_lshl_add_u32 v7, v7, 4, v10
    v_accvgpr_write_b32 a0, v7
    v_add_u32 v7, 64, v0
    v_mfma_f32_16x16x32_bf16 v[100:103], a[228:231], v[44:47], v[100:103]
    s_cmp_eq_u32 s56, 3
    s_cselect_b32 s56, 81920, 0
    v_mul_u32_u24 v10, 3641, v7
    ds_read_b128 v[28:31], v8 offset:0
    v_lshrrev_b32 v10, 16, v10
    v_mfma_f32_16x16x32_bf16 v[132:135], a[228:231], v[48:51], v[132:135]
    s_add_u32 s55, s58, 31744
    buffer_load_dwordx4 v1, s[24:27], s55 offen offset:1024 sc1 lds
    v_mad_i32_i24 v7, v10, s71, v7
    v_mul_u32_u24 v10, 1152, v10
    v_mfma_f32_16x16x32_bf16 v[164:167], a[228:231], v[52:55], v[164:167]
    s_add_u32 s60, s60, s56
    v_accvgpr_write_b32 a1, v10
    ds_read_b128 v[32:35], v8 offset:2048
    v_cmp_gt_u32 vcc, 16, v7
    v_add_u32 v10, s70, v7
    v_mfma_f32_16x16x32_bf16 v[196:199], a[228:231], v[56:59], v[196:199]
    ds_read_b128 v[36:39], v8 offset:4096
    v_and_b32 v10, 15, v10
    v_cndmask_b32 v7, v7, v10, vcc
    v_mfma_f32_16x16x32_bf16 v[228:231], a[228:231], v[60:63], v[228:231]
    v_mfma_f32_16x16x32_bf16 v[72:75], a[232:235], v[40:43], v[72:75]
    v_accvgpr_read_b32 v10, a1
    ds_read_b64_tr_b16 a[196:197], v4 offset:8
    v_lshl_add_u32 v7, v7, 4, v10
    v_mfma_f32_16x16x32_bf16 v[104:107], a[232:235], v[44:47], v[104:107]
    ds_read_b64_tr_b16 a[198:199], v4 offset:1032
    v_accvgpr_write_b32 a1, v7
    v_add_u32 v7, 128, v0
    v_mul_u32_u24 v10, 3641, v7
    v_mfma_f32_16x16x32_bf16 v[136:139], a[232:235], v[48:51], v[136:139]
    s_add_u32 s55, s58, 63488
    v_lshrrev_b32 v10, 16, v10
    buffer_load_dwordx4 v1, s[24:27], s55 offen offset:2048 sc1 lds
    v_mad_i32_i24 v7, v10, s71, v7
    v_mfma_f32_16x16x32_bf16 v[168:171], a[232:235], v[52:55], v[168:171]
    s_add_u32 s62, s62, 16384
    ds_read_b64_tr_b16 a[200:201], v4 offset:256
    v_mul_u32_u24 v10, 1152, v10
    v_accvgpr_write_b32 a2, v10
    v_mfma_f32_16x16x32_bf16 v[200:203], a[232:235], v[56:59], v[200:203]
    s_cmp_ge_u32 s62, 163840
    s_cselect_b32 s81, 163840, 0
    v_cmp_gt_u32 vcc, 16, v7
    ds_read_b64_tr_b16 a[202:203], v4 offset:1280
    v_add_u32 v10, s70, v7
    v_and_b32 v10, 15, v10
    v_mfma_f32_16x16x32_bf16 v[232:235], a[232:235], v[60:63], v[232:235]
    s_sub_u32 s62, s62, s81
    v_mfma_f32_16x16x32_bf16 v[76:79], a[236:239], v[40:43], v[76:79]
    s_lshr_b32 s81, s62, 14
    ds_read_b64_tr_b16 a[204:205], v4 offset:264
    v_cndmask_b32 v7, v7, v10, vcc
    v_accvgpr_read_b32 v10, a2
    v_mfma_f32_16x16x32_bf16 v[108:111], a[236:239], v[44:47], v[108:111]
    s_cmp_eq_u32 s81, 3
    s_cselect_b32 s81, 81920, 0
    v_lshl_add_u32 v7, v7, 4, v10
    ds_read_b64_tr_b16 a[206:207], v4 offset:1288
    v_accvgpr_write_b32 a2, v7
    v_add_u32 v7, 192, v0
    v_mfma_f32_16x16x32_bf16 v[140:143], a[236:239], v[48:51], v[140:143]
    s_add_u32 s55, s58, 95232
    buffer_load_dwordx4 v1, s[24:27], s55 offen offset:3072 sc1 lds
    v_mul_u32_u24 v10, 3641, v7
    v_lshrrev_b32 v10, 16, v10
    v_mfma_f32_16x16x32_bf16 v[172:175], a[236:239], v[52:55], v[172:175]
    s_add_u32 s58, s58, 262144
    v_mad_i32_i24 v7, v10, s71, v7
    ds_read_b64_tr_b16 a[208:209], v4 offset:512
    v_mul_u32_u24 v10, 1152, v10
    v_mfma_f32_16x16x32_bf16 v[204:207], a[236:239], v[56:59], v[204:207]
    s_add_u32 s62, s62, s81
    ds_read_b64_tr_b16 a[210:211], v4 offset:1536
    v_accvgpr_write_b32 a3, v10
    v_cmp_gt_u32 vcc, 16, v7
    v_add_u32 v10, s70, v7
    v_mfma_f32_16x16x32_bf16 v[236:239], a[236:239], v[60:63], v[236:239]
    v_mfma_f32_16x16x32_bf16 v[80:83], a[240:243], v[40:43], v[80:83]
    v_and_b32 v10, 15, v10
    ds_read_b64_tr_b16 a[212:213], v4 offset:520
    v_cndmask_b32 v7, v7, v10, vcc
    v_mfma_f32_16x16x32_bf16 v[112:115], a[240:243], v[44:47], v[112:115]
    s_mov_b32 m0, s60
    ds_read_b64_tr_b16 a[214:215], v4 offset:1544
    v_accvgpr_read_b32 v10, a3
    v_lshl_add_u32 v7, v7, 4, v10
    v_mfma_f32_16x16x32_bf16 v[144:147], a[240:243], v[48:51], v[144:147]
    s_add_u32 s55, s58, 0
    v_accvgpr_write_b32 a3, v7
    buffer_load_dwordx4 v1, s[24:27], s55 offen offset:0 sc1 lds
    v_add_u32 v7, 256, v0
    v_mul_u32_u24 v10, 3641, v7
    v_mfma_f32_16x16x32_bf16 v[176:179], a[240:243], v[52:55], v[176:179]
    s_add_u32 s60, s60, 16384
    ds_read_b64_tr_b16 a[216:217], v4 offset:768
    v_lshrrev_b32 v10, 16, v10
    v_mad_i32_i24 v7, v10, s71, v7
    v_mfma_f32_16x16x32_bf16 v[208:211], a[240:243], v[56:59], v[208:211]
    s_cmp_ge_u32 s60, 163840
    s_cselect_b32 s56, 163840, 0
    v_mul_u32_u24 v10, 1152, v10
    ds_read_b64_tr_b16 a[218:219], v4 offset:1792
    v_accvgpr_write_b32 a4, v10
    v_mfma_f32_16x16x32_bf16 v[240:243], a[240:243], v[60:63], v[240:243]
    s_sub_u32 s60, s60, s56
    global_load_dwordx4 a[16:19], v15, s[12:13] sc1
    v_cmp_gt_u32 vcc, 16, v7
    v_add_u32 v10, s70, v7
    v_and_b32 v10, 15, v10
    v_mfma_f32_16x16x32_bf16 v[84:87], a[244:247], v[40:43], v[84:87]
    s_lshr_b32 s56, s60, 14
    v_cndmask_b32 v7, v7, v10, vcc
    ds_read_b64_tr_b16 a[220:221], v4 offset:776
    v_accvgpr_read_b32 v10, a4
    v_mfma_f32_16x16x32_bf16 v[116:119], a[244:247], v[44:47], v[116:119]
    s_cmp_eq_u32 s56, 3
    s_cselect_b32 s56, 81920, 0
    ds_read_b64_tr_b16 a[222:223], v4 offset:1800
    v_lshl_add_u32 v7, v7, 4, v10
    v_accvgpr_write_b32 a4, v7
    v_mfma_f32_16x16x32_bf16 v[148:151], a[244:247], v[48:51], v[148:151]
    s_add_u32 s55, s58, 31744
    v_add_u32 v7, 320, v0
    buffer_load_dwordx4 v1, s[24:27], s55 offen offset:1024 sc1 lds
    v_mul_u32_u24 v10, 3641, v7
    v_lshrrev_b32 v10, 16, v10
    v_mfma_f32_16x16x32_bf16 v[180:183], a[244:247], v[52:55], v[180:183]
    s_add_u32 s60, s60, s56
    v_mfma_f32_16x16x32_bf16 v[212:215], a[244:247], v[56:59], v[212:215]
    v_mfma_f32_16x16x32_bf16 v[244:247], a[244:247], v[60:63], v[244:247]
    v_add_u32 v15, 768, v15
    v_mfma_f32_16x16x32_bf16 v[88:91], a[248:251], v[40:43], v[88:91]
    v_mfma_f32_16x16x32_bf16 v[120:123], a[248:251], v[44:47], v[120:123]
    v_mfma_f32_16x16x32_bf16 v[152:155], a[248:251], v[48:51], v[152:155]
    s_add_u32 s55, s58, 63488
    buffer_load_dwordx4 v1, s[24:27], s55 offen offset:2048 sc1 lds
    v_mad_i32_i24 v7, v10, s71, v7
    v_mul_u32_u24 v10, 1152, v10
    v_mfma_f32_16x16x32_bf16 v[184:187], a[248:251], v[52:55], v[184:187]
    v_mfma_f32_16x16x32_bf16 v[216:219], a[248:251], v[56:59], v[216:219]
    v_mfma_f32_16x16x32_bf16 v[248:251], a[248:251], v[60:63], v[248:251]
    v_mfma_f32_16x16x32_bf16 v[92:95], a[252:255], v[40:43], v[92:95]
    v_add_u32 v4, s62, v13
    v_mfma_f32_16x16x32_bf16 v[124:127], a[252:255], v[44:47], v[124:127]
    v_mfma_f32_16x16x32_bf16 v[156:159], a[252:255], v[48:51], v[156:159]
    s_add_u32 s55, s58, 95232
    v_accvgpr_write_b32 a5, v10
    buffer_load_dwordx4 v1, s[24:27], s55 offen offset:3072 sc1 lds
    v_cmp_gt_u32 vcc, 16, v7
    v_add_u32 v10, s70, v7
    v_mfma_f32_16x16x32_bf16 v[188:191], a[252:255], v[52:55], v[188:191]
    s_add_u32 s58, s58, 262144
    v_mfma_f32_16x16x32_bf16 v[220:223], a[252:255], v[56:59], v[220:223]
    v_mfma_f32_16x16x32_bf16 v[252:255], a[252:255], v[60:63], v[252:255]
    s_waitcnt lgkmcnt(0)
    v_mfma_f32_16x16x32_bf16 v[64:67], a[192:195], v[16:19], v[64:67]
    ds_read_b64_tr_b16 a[224:225], v4 offset:0
    v_and_b32 v10, 15, v10
    v_cndmask_b32 v7, v7, v10, vcc
    v_mfma_f32_16x16x32_bf16 v[96:99], a[192:195], v[20:23], v[96:99]
    s_add_u32 m0, s61, 0
    v_accvgpr_read_b32 v10, a5
    ds_read_b64_tr_b16 a[226:227], v4 offset:1024
    v_lshl_add_u32 v7, v7, 4, v10
    v_mfma_f32_16x16x32_bf16 v[128:131], a[192:195], v[24:27], v[128:131]
    s_add_u32 s55, s59, 0
    buffer_load_dwordx4 v2, s[20:23], s55 offen offset:0 sc1 lds
    v_accvgpr_write_b32 a5, v7
    v_add_u32 v7, 384, v0
    v_mul_u32_u24 v10, 3641, v7
    v_mfma_f32_16x16x32_bf16 v[160:163], a[192:195], v[28:31], v[160:163]
    v_lshrrev_b32 v10, 16, v10
    ds_read_b128 v[40:43], v6 offset:0
    v_mad_i32_i24 v7, v10, s71, v7
    v_mfma_f32_16x16x32_bf16 v[192:195], a[192:195], v[32:35], v[192:195]
    ds_read_b128 v[44:47], v6 offset:2048
    v_mul_u32_u24 v10, 1152, v10
    v_accvgpr_write_b32 a6, v10
    v_mfma_f32_16x16x32_bf16 v[224:227], a[192:195], v[36:39], v[224:227]
    v_mfma_f32_16x16x32_bf16 v[68:71], a[196:199], v[16:19], v[68:71]
    v_cmp_gt_u32 vcc, 16, v7
    ds_read_b128 v[48:51], v6 offset:4096
    v_add_u32 v10, s70, v7
    v_and_b32 v10, 15, v10
    v_mfma_f32_16x16x32_bf16 v[100:103], a[196:199], v[20:23], v[100:103]
    ds_read_b128 v[52:55], v9 offset:0
    v_cndmask_b32 v7, v7, v10, vcc
    v_accvgpr_read_b32 v10, a6
    v_mfma_f32_16x16x32_bf16 v[132:135], a[196:199], v[24:27], v[132:135]
    s_add_u32 s55, s59, 8192
    v_lshl_add_u32 v7, v7, 4, v10
    buffer_load_dwordx4 v2, s[20:23], s55 offen offset:1024 sc1 lds
    v_accvgpr_write_b32 a6, v7
    v_mfma_f32_16x16x32_bf16 v[164:167], a[196:199], v[28:31], v[164:167]
    s_add_u32 s63, s63, 24576
    ds_read_b128 v[56:59], v9 offset:2048
    v_add_u32 v7, 448, v0
    v_mul_u32_u24 v10, 3641, v7
    v_lshrrev_b32 v10, 16, v10
    v_mfma_f32_16x16x32_bf16 v[196:199], a[196:199], v[32:35], v[196:199]
    s_cmp_ge_u32 s63, 122880
    s_cselect_b32 s81, 73728, 0
    v_mad_i32_i24 v7, v10, s71, v7
    ds_read_b128 v[60:63], v9 offset:4096
    v_mul_u32_u24 v10, 1152, v10
    v_mfma_f32_16x16x32_bf16 v[228:231], a[196:199], v[36:39], v[228:231]
    s_sub_u32 s63, s63, s81
    v_mfma_f32_16x16x32_bf16 v[72:75], a[200:203], v[16:19], v[72:75]
    ds_read_b64_tr_b16 a[228:229], v4 offset:8
    v_accvgpr_write_b32 a7, v10
    v_cmp_gt_u32 vcc, 16, v7
    v_mfma_f32_16x16x32_bf16 v[104:107], a[200:203], v[20:23], v[104:107]
    v_add_u32 v10, s70, v7
    ds_read_b64_tr_b16 a[230:231], v4 offset:1032
    v_and_b32 v10, 15, v10
    v_cndmask_b32 v7, v7, v10, vcc
    v_mfma_f32_16x16x32_bf16 v[136:139], a[200:203], v[24:27], v[136:139]
    s_add_u32 s55, s59, 16384
    buffer_load_dwordx4 v2, s[20:23], s55 offen offset:2048 sc1 lds
    v_accvgpr_read_b32 v10, a7
    v_lshl_add_u32 v7, v7, 4, v10
    v_mfma_f32_16x16x32_bf16 v[168:171], a[200:203], v[28:31], v[168:171]
    s_add_u32 s62, s62, 16384
    v_accvgpr_write_b32 a7, v7
    ds_read_b64_tr_b16 a[232:233], v4 offset:256
    v_add_u32 v7, 512, v0
    v_mul_u32_u24 v10, 3641, v7
    v_mfma_f32_16x16x32_bf16 v[200:203], a[200:203], v[32:35], v[200:203]
    s_cmp_ge_u32 s62, 163840
    s_cselect_b32 s81, 163840, 0
    ds_read_b64_tr_b16 a[234:235], v4 offset:1280
    v_lshrrev_b32 v10, 16, v10
    v_mad_i32_i24 v7, v10, s71, v7
    v_mfma_f32_16x16x32_bf16 v[232:235], a[200:203], v[36:39], v[232:235]
    s_sub_u32 s62, s62, s81
    v_mfma_f32_16x16x32_bf16 v[76:79], a[204:207], v[16:19], v[76:79]
    s_lshr_b32 s81, s62, 14
    v_mul_u32_u24 v10, 1152, v10
    ds_read_b64_tr_b16 a[236:237], v4 offset:264
    v_accvgpr_write_b32 a8, v10
    v_mfma_f32_16x16x32_bf16 v[108:111], a[204:207], v[20:23], v[108:111]
    s_cmp_eq_u32 s81, 3
    s_cselect_b32 s81, 81920, 0
    ds_read_b64_tr_b16 a[238:239], v4 offset:1288
    v_cmp_gt_u32 vcc, 16, v7
    v_add_u32 v10, s70, v7
    v_and_b32 v10, 15, v10
    v_mfma_f32_16x16x32_bf16 v[140:143], a[204:207], v[24:27], v[140:143]
    s_add_u32 s55, s59, 24576
    v_cndmask_b32 v7, v7, v10, vcc
    buffer_load_dwordx4 v2, s[20:23], s55 offen offset:3072 sc1 lds
    v_accvgpr_read_b32 v10, a8
    v_mfma_f32_16x16x32_bf16 v[172:175], a[204:207], v[28:31], v[172:175]
    ds_read_b64_tr_b16 a[240:241], v4 offset:512
    v_lshl_add_u32 v7, v7, 4, v10
    v_accvgpr_write_b32 a8, v7
    v_mfma_f32_16x16x32_bf16 v[204:207], a[204:207], v[32:35], v[204:207]
    s_add_u32 s62, s62, s81
    v_accvgpr_write_b32 a32, 0
    ds_read_b64_tr_b16 a[242:243], v4 offset:1536
    v_accvgpr_write_b32 a33, 0
    v_accvgpr_write_b32 a34, 0
    v_mfma_f32_16x16x32_bf16 v[236:239], a[204:207], v[36:39], v[236:239]
    v_mfma_f32_16x16x32_bf16 v[80:83], a[208:211], v[16:19], v[80:83]
    ds_read_b64_tr_b16 a[244:245], v4 offset:520
    v_accvgpr_write_b32 a35, 0
    v_accvgpr_write_b32 a36, 0
    v_mfma_f32_16x16x32_bf16 v[112:115], a[208:211], v[20:23], v[112:115]
    s_add_u32 m0, s61, 4096
    v_accvgpr_write_b32 a37, 0
    ds_read_b64_tr_b16 a[246:247], v4 offset:1544
    v_accvgpr_write_b32 a38, 0
    v_mfma_f32_16x16x32_bf16 v[144:147], a[208:211], v[24:27], v[144:147]
    s_add_u32 s55, s59, 36864
    buffer_load_dwordx4 v2, s[20:23], s55 offen offset:0 sc1 lds
    v_accvgpr_write_b32 a39, 0
    v_accvgpr_write_b32 a40, 0
    v_accvgpr_write_b32 a41, 0
    v_mfma_f32_16x16x32_bf16 v[176:179], a[208:211], v[28:31], v[176:179]
    v_accvgpr_write_b32 a42, 0
    ds_read_b64_tr_b16 a[248:249], v4 offset:768
    v_accvgpr_write_b32 a43, 0
    v_mfma_f32_16x16x32_bf16 v[208:211], a[208:211], v[32:35], v[208:211]
    ds_read_b64_tr_b16 a[250:251], v4 offset:1792
    v_accvgpr_write_b32 a44, 0
    v_accvgpr_write_b32 a45, 0
    v_mfma_f32_16x16x32_bf16 v[240:243], a[208:211], v[36:39], v[240:243]
    v_mfma_f32_16x16x32_bf16 v[84:87], a[212:215], v[16:19], v[84:87]
    v_accvgpr_write_b32 a46, 0
    ds_read_b64_tr_b16 a[252:253], v4 offset:776
    v_accvgpr_write_b32 a47, 0
    v_accvgpr_write_b32 a48, 0
    v_mfma_f32_16x16x32_bf16 v[116:119], a[212:215], v[20:23], v[116:119]
    ds_read_b64_tr_b16 a[254:255], v4 offset:1800
    v_accvgpr_write_b32 a49, 0
    v_accvgpr_write_b32 a50, 0
    v_mfma_f32_16x16x32_bf16 v[148:151], a[212:215], v[24:27], v[148:151]
    s_add_u32 s55, s59, 45056
    v_accvgpr_write_b32 a51, 0
    buffer_load_dwordx4 v2, s[20:23], s55 offen offset:1024 sc1 lds
    v_accvgpr_write_b32 a52, 0
    v_accvgpr_write_b32 a53, 0
    v_mfma_f32_16x16x32_bf16 v[180:183], a[212:215], v[28:31], v[180:183]
    s_add_u32 s59, s59, 128
    v_mfma_f32_16x16x32_bf16 v[212:215], a[212:215], v[32:35], v[212:215]
    s_add_u32 s61, s61, 24576
    v_mfma_f32_16x16x32_bf16 v[244:247], a[212:215], v[36:39], v[244:247]
    s_cmp_ge_u32 s61, 122880
    s_cselect_b32 s56, 73728, 0
    v_mfma_f32_16x16x32_bf16 v[88:91], a[216:219], v[16:19], v[88:91]
    s_sub_u32 s61, s61, s56
    v_mfma_f32_16x16x32_bf16 v[120:123], a[216:219], v[20:23], v[120:123]
    v_mfma_f32_16x16x32_bf16 v[152:155], a[216:219], v[24:27], v[152:155]
    v_mfma_f32_16x16x32_bf16 v[184:187], a[216:219], v[28:31], v[184:187]
    v_mfma_f32_16x16x32_bf16 v[216:219], a[216:219], v[32:35], v[216:219]
    v_mfma_f32_16x16x32_bf16 v[248:251], a[216:219], v[36:39], v[248:251]
    v_mfma_f32_16x16x32_bf16 v[92:95], a[220:223], v[16:19], v[92:95]
    v_add_u32 v4, s62, v13
    v_mfma_f32_16x16x32_bf16 v[124:127], a[220:223], v[20:23], v[124:127]
    v_add_u32 v5, s63, v14
    v_mfma_f32_16x16x32_bf16 v[156:159], a[220:223], v[24:27], v[156:159]
    v_xor_b32 v6, 64, v5
    v_mfma_f32_16x16x32_bf16 v[188:191], a[220:223], v[28:31], v[188:191]
    v_add_u32 v8, s79, v5
    v_mfma_f32_16x16x32_bf16 v[220:223], a[220:223], v[32:35], v[220:223]
    v_add_u32 v9, s79, v6
    v_mfma_f32_16x16x32_bf16 v[252:255], a[220:223], v[36:39], v[252:255]
    s_waitcnt vmcnt(11) lgkmcnt(0)
    s_barrier
    v_mfma_f32_16x16x32_bf16 v[64:67], a[224:227], v[40:43], v[64:67]
    ds_read_b64_tr_b16 a[192:193], v4 offset:0
    v_accvgpr_write_b32 a54, 0
    v_accvgpr_write_b32 a55, 0
    v_mfma_f32_16x16x32_bf16 v[96:99], a[224:227], v[44:47], v[96:99]
    s_mov_b32 m0, s60
    v_accvgpr_write_b32 a56, 0
    ds_read_b64_tr_b16 a[194:195], v4 offset:1024
    v_accvgpr_write_b32 a57, 0
    v_mfma_f32_16x16x32_bf16 v[128:131], a[224:227], v[48:51], v[128:131]
    s_add_u32 s55, s58, 0
    buffer_load_dwordx4 v1, s[24:27], s55 offen offset:0 sc1 lds
    v_accvgpr_write_b32 a58, 0
    v_accvgpr_write_b32 a59, 0
    v_accvgpr_write_b32 a60, 0
    v_mfma_f32_16x16x32_bf16 v[160:163], a[224:227], v[52:55], v[160:163]
    s_add_u32 s60, s60, 16384
    v_accvgpr_write_b32 a61, 0
    ds_read_b128 v[16:19], v5 offset:0
    v_accvgpr_write_b32 a62, 0
    v_mfma_f32_16x16x32_bf16 v[192:195], a[224:227], v[56:59], v[192:195]
    s_cmp_ge_u32 s60, 163840
    s_cselect_b32 s56, 163840, 0
    ds_read_b128 v[20:23], v5 offset:2048
    v_accvgpr_write_b32 a63, 0
    v_accvgpr_write_b32 a64, 0
    v_mfma_f32_16x16x32_bf16 v[224:227], a[224:227], v[60:63], v[224:227]
    s_sub_u32 s60, s60, s56
    v_mfma_f32_16x16x32_bf16 v[68:71], a[228:231], v[40:43], v[68:71]
    s_lshr_b32 s56, s60, 14
    v_accvgpr_write_b32 a65, 0
    ds_read_b128 v[24:27], v5 offset:4096
    v_accvgpr_write_b32 a66, 0
    v_accvgpr_write_b32 a67, 0
    v_mfma_f32_16x16x32_bf16 v[100:103], a[228:231], v[44:47], v[100:103]
    s_cmp_eq_u32 s56, 3
    s_cselect_b32 s56, 81920, 0
    ds_read_b128 v[28:31], v8 offset:0
    v_accvgpr_write_b32 a68, 0
    v_accvgpr_write_b32 a69, 0
    v_mfma_f32_16x16x32_bf16 v[132:135], a[228:231], v[48:51], v[132:135]
    s_add_u32 s55, s58, 31744
    v_accvgpr_write_b32 a70, 0
    buffer_load_dwordx4 v1, s[24:27], s55 offen offset:1024 sc1 lds
    v_accvgpr_write_b32 a71, 0
    v_mfma_f32_16x16x32_bf16 v[164:167], a[228:231], v[52:55], v[164:167]
    s_add_u32 s60, s60, s56
    ds_read_b128 v[32:35], v8 offset:2048
    v_accvgpr_write_b32 a72, 0
    v_accvgpr_write_b32 a73, 0
    v_accvgpr_write_b32 a74, 0
    v_mfma_f32_16x16x32_bf16 v[196:199], a[228:231], v[56:59], v[196:199]
    v_accvgpr_write_b32 a75, 0
    ds_read_b128 v[36:39], v8 offset:4096
    v_accvgpr_write_b32 a76, 0
    v_mfma_f32_16x16x32_bf16 v[228:231], a[228:231], v[60:63], v[228:231]
    v_mfma_f32_16x16x32_bf16 v[72:75], a[232:235], v[40:43], v[72:75]
    ds_read_b64_tr_b16 a[196:197], v4 offset:8
    v_accvgpr_write_b32 a77, 0
    v_accvgpr_write_b32 a78, 0
    v_mfma_f32_16x16x32_bf16 v[104:107], a[232:235], v[44:47], v[104:107]
    v_accvgpr_write_b32 a79, 0
    ds_read_b64_tr_b16 a[198:199], v4 offset:1032
    v_accvgpr_write_b32 a80, 0
    v_accvgpr_write_b32 a81, 0
    v_mfma_f32_16x16x32_bf16 v[136:139], a[232:235], v[48:51], v[136:139]
    s_add_u32 s55, s58, 63488
    buffer_load_dwordx4 v1, s[24:27], s55 offen offset:2048 sc1 lds
    v_accvgpr_write_b32 a82, 0
    v_accvgpr_write_b32 a83, 0
    v_mfma_f32_16x16x32_bf16 v[168:171], a[232:235], v[52:55], v[168:171]
    s_add_u32 s62, s62, 16384
    v_accvgpr_write_b32 a84, 0
    ds_read_b64_tr_b16 a[200:201], v4 offset:256
    v_accvgpr_write_b32 a85, 0
    v_mfma_f32_16x16x32_bf16 v[200:203], a[232:235], v[56:59], v[200:203]
    s_cmp_ge_u32 s62, 163840
    s_cselect_b32 s81, 163840, 0
    ds_read_b64_tr_b16 a[202:203], v4 offset:1280
    v_accvgpr_write_b32 a86, 0
    v_accvgpr_write_b32 a87, 0
    v_accvgpr_write_b32 a88, 0
    v_mfma_f32_16x16x32_bf16 v[232:235], a[232:235], v[60:63], v[232:235]
    s_sub_u32 s62, s62, s81
    v_mfma_f32_16x16x32_bf16 v[76:79], a[236:239], v[40:43], v[76:79]
    s_lshr_b32 s81, s62, 14
    v_accvgpr_write_b32 a89, 0
    ds_read_b64_tr_b16 a[204:205], v4 offset:264
    v_accvgpr_write_b32 a90, 0
    v_mfma_f32_16x16x32_bf16 v[108:111], a[236:239], v[44:47], v[108:111]
    s_cmp_eq_u32 s81, 3
    s_cselect_b32 s81, 81920, 0
    ds_read_b64_tr_b16 a[206:207], v4 offset:1288
    v_accvgpr_write_b32 a91, 0
    v_accvgpr_write_b32 a92, 0
    v_accvgpr_write_b32 a93, 0
    v_mfma_f32_16x16x32_bf16 v[140:143], a[236:239], v[48:51], v[140:143]
    s_add_u32 s55, s58, 95232
    v_accvgpr_write_b32 a94, 0
    buffer_load_dwordx4 v1, s[24:27], s55 offen offset:3072 sc1 lds
    v_accvgpr_write_b32 a95, 0
    v_mfma_f32_16x16x32_bf16 v[172:175], a[236:239], v[52:55], v[172:175]
    s_add_u32 s58, s58, 262144
    ds_read_b64_tr_b16 a[208:209], v4 offset:512
    v_accvgpr_write_b32 a96, 0
    v_accvgpr_write_b32 a97, 0
    v_mfma_f32_16x16x32_bf16 v[204:207], a[236:239], v[56:59], v[204:207]
    s_add_u32 s62, s62, s81
    v_accvgpr_write_b32 a98, 0
    ds_read_b64_tr_b16 a[210:211], v4 offset:1536
    v_accvgpr_write_b32 a99, 0
    v_accvgpr_write_b32 a100, 0
    v_mfma_f32_16x16x32_bf16 v[236:239], a[236:239], v[60:63], v[236:239]
    v_mfma_f32_16x16x32_bf16 v[80:83], a[240:243], v[40:43], v[80:83]
    ds_read_b64_tr_b16 a[212:213], v4 offset:520
    v_accvgpr_write_b32 a101, 0
    v_accvgpr_write_b32 a102, 0
    v_mfma_f32_16x16x32_bf16 v[112:115], a[240:243], v[44:47], v[112:115]
    s_mov_b32 m0, s60
    v_accvgpr_write_b32 a103, 0
    ds_read_b64_tr_b16 a[214:215], v4 offset:1544
    v_accvgpr_write_b32 a104, 0
    v_mfma_f32_16x16x32_bf16 v[144:147], a[240:243], v[48:51], v[144:147]
    s_add_u32 s55, s58, 0
    buffer_load_dwordx4 v1, s[24:27], s55 offen offset:0 sc1 lds
    v_accvgpr_write_b32 a105, 0
    v_accvgpr_write_b32 a106, 0
    v_accvgpr_write_b32 a107, 0
    v_mfma_f32_16x16x32_bf16 v[176:179], a[240:243], v[52:55], v[176:179]
    s_add_u32 s60, s60, 16384
    v_accvgpr_write_b32 a108, 0
    ds_read_b64_tr_b16 a[216:217], v4 offset:768
    v_accvgpr_write_b32 a109, 0
    v_mfma_f32_16x16x32_bf16 v[208:211], a[240:243], v[56:59], v[208:211]
    s_cmp_ge_u32 s60, 163840
    s_cselect_b32 s56, 163840, 0
    ds_read_b64_tr_b16 a[218:219], v4 offset:1792
    v_accvgpr_write_b32 a110, 0
    v_accvgpr_write_b32 a111, 0
    v_mfma_f32_16x16x32_bf16 v[240:243], a[240:243], v[60:63], v[240:243]
    s_sub_u32 s60, s60, s56
    v_accvgpr_write_b32 a112, 0
    global_load_dwordx4 a[16:19], v15, s[12:13] sc1
    v_accvgpr_write_b32 a113, 0
    v_accvgpr_write_b32 a114, 0
    v_mfma_f32_16x16x32_bf16 v[84:87], a[244:247], v[40:43], v[84:87]
    s_lshr_b32 s56, s60, 14
    ds_read_b64_tr_b16 a[220:221], v4 offset:776
    v_accvgpr_write_b32 a115, 0
    v_accvgpr_write_b32 a116, 0
    v_mfma_f32_16x16x32_bf16 v[116:119], a[244:247], v[44:47], v[116:119]
    s_cmp_eq_u32 s56, 3
    s_cselect_b32 s56, 81920, 0
    v_accvgpr_write_b32 a117, 0
    ds_read_b64_tr_b16 a[222:223], v4 offset:1800
    v_accvgpr_write_b32 a118, 0
    v_mfma_f32_16x16x32_bf16 v[148:151], a[244:247], v[48:51], v[148:151]
    s_add_u32 s55, s58, 31744
    buffer_load_dwordx4 v1, s[24:27], s55 offen offset:1024 sc1 lds
    v_accvgpr_write_b32 a119, 0
    v_accvgpr_write_b32 a120, 0
    v_accvgpr_write_b32 a121, 0
    v_mfma_f32_16x16x32_bf16 v[180:183], a[244:247], v[52:55], v[180:183]
    s_add_u32 s60, s60, s56
    v_mfma_f32_16x16x32_bf16 v[212:215], a[244:247], v[56:59], v[212:215]
    v_mfma_f32_16x16x32_bf16 v[244:247], a[244:247], v[60:63], v[244:247]
    v_add_u32 v15, 768, v15
    v_mfma_f32_16x16x32_bf16 v[88:91], a[248:251], v[40:43], v[88:91]
    v_mfma_f32_16x16x32_bf16 v[120:123], a[248:251], v[44:47], v[120:123]
    v_mfma_f32_16x16x32_bf16 v[152:155], a[248:251], v[48:51], v[152:155]
    s_add_u32 s55, s58, 63488
    v_accvgpr_write_b32 a122, 0
    buffer_load_dwordx4 v1, s[24:27], s55 offen offset:2048 sc1 lds
    v_accvgpr_write_b32 a123, 0
    v_mfma_f32_16x16x32_bf16 v[184:187], a[248:251], v[52:55], v[184:187]
    v_mfma_f32_16x16x32_bf16 v[216:219], a[248:251], v[56:59], v[216:219]
    v_mfma_f32_16x16x32_bf16 v[248:251], a[248:251], v[60:63], v[248:251]
    v_mfma_f32_16x16x32_bf16 v[92:95], a[252:255], v[40:43], v[92:95]
    v_add_u32 v4, s62, v13
    v_mfma_f32_16x16x32_bf16 v[124:127], a[252:255], v[44:47], v[124:127]
    v_mfma_f32_16x16x32_bf16 v[156:159], a[252:255], v[48:51], v[156:159]
    s_add_u32 s55, s58, 95232
    buffer_load_dwordx4 v1, s[24:27], s55 offen offset:3072 sc1 lds
    v_accvgpr_write_b32 a124, 0
    v_accvgpr_write_b32 a125, 0
    v_accvgpr_write_b32 a126, 0
    v_mfma_f32_16x16x32_bf16 v[188:191], a[252:255], v[52:55], v[188:191]
    s_add_u32 s58, s58, 262144
    v_mfma_f32_16x16x32_bf16 v[220:223], a[252:255], v[56:59], v[220:223]
    v_mfma_f32_16x16x32_bf16 v[252:255], a[252:255], v[60:63], v[252:255]
    s_waitcnt lgkmcnt(0)
    v_mfma_f32_16x16x32_bf16 v[64:67], a[192:195], v[16:19], v[64:67]
    v_accvgpr_write_b32 a127, 0
    ds_read_b64_tr_b16 a[224:225], v4 offset:0
    v_accvgpr_write_b32 a128, 0
    v_mfma_f32_16x16x32_bf16 v[96:99], a[192:195], v[20:23], v[96:99]
    s_add_u32 m0, s61, 0
    ds_read_b64_tr_b16 a[226:227], v4 offset:1024
    v_accvgpr_write_b32 a129, 0
    v_accvgpr_write_b32 a130, 0
    v_mfma_f32_16x16x32_bf16 v[128:131], a[192:195], v[24:27], v[128:131]
    s_add_u32 s55, s59, 0
    v_accvgpr_write_b32 a131, 0
    buffer_load_dwordx4 v2, s[20:23], s55 offen offset:0 sc1 lds
    v_accvgpr_write_b32 a132, 0
    v_accvgpr_write_b32 a133, 0
    v_mfma_f32_16x16x32_bf16 v[160:163], a[192:195], v[28:31], v[160:163]
    ds_read_b128 v[40:43], v6 offset:0
    v_accvgpr_write_b32 a134, 0
    v_accvgpr_write_b32 a135, 0
    v_mfma_f32_16x16x32_bf16 v[192:195], a[192:195], v[32:35], v[192:195]
    v_accvgpr_write_b32 a136, 0
    ds_read_b128 v[44:47], v6 offset:2048
    v_accvgpr_write_b32 a137, 0
    v_mfma_f32_16x16x32_bf16 v[224:227], a[192:195], v[36:39], v[224:227]
    v_mfma_f32_16x16x32_bf16 v[68:71], a[196:199], v[16:19], v[68:71]
    ds_read_b128 v[48:51], v6 offset:4096
    v_accvgpr_write_b32 a138, 0
    v_accvgpr_write_b32 a139, 0
    v_accvgpr_write_b32 a140, 0
    v_mfma_f32_16x16x32_bf16 v[100:103], a[196:199], v[20:23], v[100:103]
    v_accvgpr_write_b32 a141, 0
    ds_read_b128 v[52:55], v9 offset:0
    v_accvgpr_write_b32 a142, 0
    v_mfma_f32_16x16x32_bf16 v[132:135], a[196:199], v[24:27], v[132:135]
    s_add_u32 s55, s59, 8192
    buffer_load_dwordx4 v2, s[20:23], s55 offen offset:1024 sc1 lds
    v_accvgpr_write_b32 a143, 0
    v_accvgpr_write_b32 a144, 0
    v_mfma_f32_16x16x32_bf16 v[164:167], a[196:199], v[28:31], v[164:167]
    s_add_u32 s63, s63, 24576
    v_accvgpr_write_b32 a145, 0
    ds_read_b128 v[56:59], v9 offset:2048
    v_accvgpr_write_b32 a146, 0
    v_accvgpr_write_b32 a147, 0
    v_mfma_f32_16x16x32_bf16 v[196:199], a[196:199], v[32:35], v[196:199]
    s_cmp_ge_u32 s63, 122880
    s_cselect_b32 s81, 73728, 0
    ds_read_b128 v[60:63], v9 offset:4096
    v_accvgpr_write_b32 a148, 0
    v_accvgpr_write_b32 a149, 0
    v_mfma_f32_16x16x32_bf16 v[228:231], a[196:199], v[36:39], v[228:231]
    s_sub_u32 s63, s63, s81
    v_mfma_f32_16x16x32_bf16 v[72:75], a[200:203], v[16:19], v[72:75]
    v_accvgpr_write_b32 a150, 0
    ds_read_b64_tr_b16 a[228:229], v4 offset:8
    v_accvgpr_write_b32 a151, 0
    v_mfma_f32_16x16x32_bf16 v[104:107], a[200:203], v[20:23], v[104:107]
    ds_read_b64_tr_b16 a[230:231], v4 offset:1032
    v_accvgpr_write_b32 a152, 0
    v_accvgpr_write_b32 a153, 0
    v_accvgpr_write_b32 a154, 0
    v_mfma_f32_16x16x32_bf16 v[136:139], a[200:203], v[24:27], v[136:139]
    s_add_u32 s55, s59, 16384
    v_accvgpr_write_b32 a155, 0
    buffer_load_dwordx4 v2, s[20:23], s55 offen offset:2048 sc1 lds
    v_accvgpr_write_b32 a156, 0
    v_mfma_f32_16x16x32_bf16 v[168:171], a[200:203], v[28:31], v[168:171]
    s_add_u32 s62, s62, 16384
    ds_read_b64_tr_b16 a[232:233], v4 offset:256
    v_accvgpr_write_b32 a157, 0
    v_accvgpr_write_b32 a158, 0
    v_accvgpr_write_b32 a159, 0
    v_mfma_f32_16x16x32_bf16 v[200:203], a[200:203], v[32:35], v[200:203]
    s_cmp_ge_u32 s62, 163840
    s_cselect_b32 s81, 163840, 0
    v_accvgpr_write_b32 a160, 0
    ds_read_b64_tr_b16 a[234:235], v4 offset:1280
    v_accvgpr_write_b32 a161, 0
    v_mfma_f32_16x16x32_bf16 v[232:235], a[200:203], v[36:39], v[232:235]
    s_sub_u32 s62, s62, s81
    v_mfma_f32_16x16x32_bf16 v[76:79], a[204:207], v[16:19], v[76:79]
    s_lshr_b32 s81, s62, 14
    ds_read_b64_tr_b16 a[236:237], v4 offset:264
    v_accvgpr_write_b32 a162, 0
    v_accvgpr_write_b32 a163, 0
    v_mfma_f32_16x16x32_bf16 v[108:111], a[204:207], v[20:23], v[108:111]
    s_cmp_eq_u32 s81, 3
    s_cselect_b32 s81, 81920, 0
    v_accvgpr_write_b32 a164, 0
    ds_read_b64_tr_b16 a[238:239], v4 offset:1288
    v_accvgpr_write_b32 a165, 0
    v_accvgpr_write_b32 a166, 0
    v_mfma_f32_16x16x32_bf16 v[140:143], a[204:207], v[24:27], v[140:143]
    s_add_u32 s55, s59, 24576
    buffer_load_dwordx4 v2, s[20:23], s55 offen offset:3072 sc1 lds
    v_accvgpr_write_b32 a167, 0
    v_accvgpr_write_b32 a168, 0
    v_mfma_f32_16x16x32_bf16 v[172:175], a[204:207], v[28:31], v[172:175]
    v_accvgpr_write_b32 a169, 0
    ds_read_b64_tr_b16 a[240:241], v4 offset:512
    v_accvgpr_write_b32 a170, 0
    v_mfma_f32_16x16x32_bf16 v[204:207], a[204:207], v[32:35], v[204:207]
    s_add_u32 s62, s62, s81
    ds_read_b64_tr_b16 a[242:243], v4 offset:1536
    v_accvgpr_write_b32 a171, 0
    v_accvgpr_write_b32 a172, 0
    v_accvgpr_write_b32 a173, 0
    v_mfma_f32_16x16x32_bf16 v[236:239], a[204:207], v[36:39], v[236:239]
    v_mfma_f32_16x16x32_bf16 v[80:83], a[208:211], v[16:19], v[80:83]
    v_accvgpr_write_b32 a174, 0
    ds_read_b64_tr_b16 a[244:245], v4 offset:520
    v_accvgpr_write_b32 a175, 0
    v_mfma_f32_16x16x32_bf16 v[112:115], a[208:211], v[20:23], v[112:115]
    s_add_u32 m0, s61, 4096
    ds_read_b64_tr_b16 a[246:247], v4 offset:1544
    v_accvgpr_write_b32 a176, 0
    v_accvgpr_write_b32 a177, 0
    v_mfma_f32_16x16x32_bf16 v[144:147], a[208:211], v[24:27], v[144:147]
    s_add_u32 s55, s59, 36864
    v_accvgpr_write_b32 a178, 0
    buffer_load_dwordx4 v2, s[20:23], s55 offen offset:0 sc1 lds
    v_accvgpr_write_b32 a179, 0
    v_accvgpr_write_b32 a180, 0
    v_mfma_f32_16x16x32_bf16 v[176:179], a[208:211], v[28:31], v[176:179]
    ds_read_b64_tr_b16 a[248:249], v4 offset:768
    v_accvgpr_write_b32 a181, 0
    v_accvgpr_write_b32 a182, 0
    v_mfma_f32_16x16x32_bf16 v[208:211], a[208:211], v[32:35], v[208:211]
    v_accvgpr_write_b32 a183, 0
    ds_read_b64_tr_b16 a[250:251], v4 offset:1792
    v_accvgpr_write_b32 a184, 0
    v_mfma_f32_16x16x32_bf16 v[240:243], a[208:211], v[36:39], v[240:243]
    v_mfma_f32_16x16x32_bf16 v[84:87], a[212:215], v[16:19], v[84:87]
    ds_read_b64_tr_b16 a[252:253], v4 offset:776
    v_accvgpr_write_b32 a185, 0
    v_accvgpr_write_b32 a186, 0
    v_accvgpr_write_b32 a187, 0
    v_mfma_f32_16x16x32_bf16 v[116:119], a[212:215], v[20:23], v[116:119]
    v_accvgpr_write_b32 a188, 0
    ds_read_b64_tr_b16 a[254:255], v4 offset:1800
    v_accvgpr_write_b32 a189, 0
    v_mfma_f32_16x16x32_bf16 v[148:151], a[212:215], v[24:27], v[148:151]
    s_add_u32 s55, s59, 45056
    buffer_load_dwordx4 v2, s[20:23], s55 offen offset:1024 sc1 lds
    v_accvgpr_write_b32 a190, 0
    v_accvgpr_write_b32 a191, 0
    v_add_u32 v7, s82, v11
    v_mfma_f32_16x16x32_bf16 v[180:183], a[212:215], v[28:31], v[180:183]
    s_add_u32 s59, s59, 128
    v_mfma_f32_16x16x32_bf16 v[212:215], a[212:215], v[32:35], v[212:215]
    s_add_u32 s61, s61, 24576
    v_mfma_f32_16x16x32_bf16 v[244:247], a[212:215], v[36:39], v[244:247]
    s_cmp_ge_u32 s61, 122880
    s_cselect_b32 s56, 73728, 0
    v_mfma_f32_16x16x32_bf16 v[88:91], a[216:219], v[16:19], v[88:91]
    s_sub_u32 s61, s61, s56
    v_mfma_f32_16x16x32_bf16 v[120:123], a[216:219], v[20:23], v[120:123]
    v_mfma_f32_16x16x32_bf16 v[152:155], a[216:219], v[24:27], v[152:155]
    v_mfma_f32_16x16x32_bf16 v[184:187], a[216:219], v[28:31], v[184:187]
    v_mfma_f32_16x16x32_bf16 v[216:219], a[216:219], v[32:35], v[216:219]
    v_mfma_f32_16x16x32_bf16 v[248:251], a[216:219], v[36:39], v[248:251]
    v_mfma_f32_16x16x32_bf16 v[92:95], a[220:223], v[16:19], v[92:95]
    v_add_u32 v4, s62, v13
    v_mfma_f32_16x16x32_bf16 v[124:127], a[220:223], v[20:23], v[124:127]
    v_add_u32 v5, s63, v14
    v_mfma_f32_16x16x32_bf16 v[156:159], a[220:223], v[24:27], v[156:159]
    v_xor_b32 v6, 64, v5
    v_mfma_f32_16x16x32_bf16 v[188:191], a[220:223], v[28:31], v[188:191]
    v_add_u32 v8, s79, v5
    v_mfma_f32_16x16x32_bf16 v[220:223], a[220:223], v[32:35], v[220:223]
    v_add_u32 v9, s79, v6
    v_mfma_f32_16x16x32_bf16 v[252:255], a[220:223], v[36:39], v[252:255]
    s_waitcnt vmcnt(11) lgkmcnt(0)
    s_barrier
    s_mov_b32 s57, 4
.p2align 6
L_qloop:
    v_mfma_f32_16x16x32_bf16 v[64:67], a[224:227], v[40:43], v[64:67]
    ds_read_b64_tr_b16 a[192:193], v4 offset:0
    v_mfma_f32_16x16x32_bf16 v[96:99], a[224:227], v[44:47], v[96:99]
    s_mov_b32 m0, s60
    ds_read_b64_tr_b16 a[194:195], v4 offset:1024
    v_mfma_f32_16x16x32_bf16 v[128:131], a[224:227], v[48:51], v[128:131]
    s_add_u32 s55, s58, 0
    buffer_load_dwordx4 v1, s[24:27], s55 offen offset:0 sc1 lds
    v_mfma_f32_16x16x32_bf16 v[160:163], a[224:227], v[52:55], v[160:163]
    s_add_u32 s60, s60, 16384
    ds_read_b128 v[16:19], v5 offset:0
    v_mfma_f32_16x16x32_bf16 v[192:195], a[224:227], v[56:59], v[192:195]
    s_cmp_ge_u32 s60, 163840
    s_cselect_b32 s56, 163840, 0
    ds_read_b128 v[20:23], v5 offset:2048
    v_mfma_f32_16x16x32_bf16 v[224:227], a[224:227], v[60:63], v[224:227]
    s_sub_u32 s60, s60, s56
    v_mfma_f32_16x16x32_bf16 v[68:71], a[228:231], v[40:43], v[68:71]
    s_lshr_b32 s56, s60, 14
    ds_read_b128 v[24:27], v5 offset:4096
    v_mfma_f32_16x16x32_bf16 v[100:103], a[228:231], v[44:47], v[100:103]
    s_cmp_eq_u32 s56, 3
    s_cselect_b32 s56, 81920, 0
    ds_read_b128 v[28:31], v8 offset:0
    v_mfma_f32_16x16x32_bf16 v[132:135], a[228:231], v[48:51], v[132:135]
    s_add_u32 s55, s58, 31744
    buffer_load_dwordx4 v1, s[24:27], s55 offen offset:1024 sc1 lds
    v_mfma_f32_16x16x32_bf16 v[164:167], a[228:231], v[52:55], v[164:167]
    s_add_u32 s60, s60, s56
    ds_read_b128 v[32:35], v8 offset:2048
    v_mfma_f32_16x16x32_bf16 v[196:199], a[228:231], v[56:59], v[196:199]
    ds_read_b128 v[36:39], v8 offset:4096
    v_mfma_f32_16x16x32_bf16 v[228:231], a[228:231], v[60:63], v[228:231]
    v_mfma_f32_16x16x32_bf16 v[72:75], a[232:235], v[40:43], v[72:75]
    ds_read_b64_tr_b16 a[196:197], v4 offset:8
    v_mfma_f32_16x16x32_bf16 v[104:107], a[232:235], v[44:47], v[104:107]
    ds_read_b64_tr_b16 a[198:199], v4 offset:1032
    v_mfma_f32_16x16x32_bf16 v[136:139], a[232:235], v[48:51], v[136:139]
    s_add_u32 s55, s58, 63488
    buffer_load_dwordx4 v1, s[24:27], s55 offen offset:2048 sc1 lds
    v_mfma_f32_16x16x32_bf16 v[168:171], a[232:235], v[52:55], v[168:171]
    s_add_u32 s62, s62, 16384
    ds_read_b64_tr_b16 a[200:201], v4 offset:256
    v_mfma_f32_16x16x32_bf16 v[200:203], a[232:235], v[56:59], v[200:203]
    s_cmp_ge_u32 s62, 163840
    s_cselect_b32 s81, 163840, 0
    ds_read_b64_tr_b16 a[202:203], v4 offset:1280
    v_mfma_f32_16x16x32_bf16 v[232:235], a[232:235], v[60:63], v[232:235]
    s_sub_u32 s62, s62, s81
    v_mfma_f32_16x16x32_bf16 v[76:79], a[236:239], v[40:43], v[76:79]
    s_lshr_b32 s81, s62, 14
    ds_read_b64_tr_b16 a[204:205], v4 offset:264
    v_mfma_f32_16x16x32_bf16 v[108:111], a[236:239], v[44:47], v[108:111]
    s_cmp_eq_u32 s81, 3
    s_cselect_b32 s81, 81920, 0
    ds_read_b64_tr_b16 a[206:207], v4 offset:1288
    v_mfma_f32_16x16x32_bf16 v[140:143], a[236:239], v[48:51], v[140:143]
    s_add_u32 s55, s58, 95232
    buffer_load_dwordx4 v1, s[24:27], s55 offen offset:3072 sc1 lds
    v_mfma_f32_16x16x32_bf16 v[172:175], a[236:239], v[52:55], v[172:175]
    s_add_u32 s58, s58, 262144
    ds_read_b64_tr_b16 a[208:209], v4 offset:512
    v_mfma_f32_16x16x32_bf16 v[204:207], a[236:239], v[56:59], v[204:207]
    s_add_u32 s62, s62, s81
    ds_read_b64_tr_b16 a[210:211], v4 offset:1536
    v_mfma_f32_16x16x32_bf16 v[236:239], a[236:239], v[60:63], v[236:239]
    v_mfma_f32_16x16x32_bf16 v[80:83], a[240:243], v[40:43], v[80:83]
    ds_read_b64_tr_b16 a[212:213], v4 offset:520
    v_mfma_f32_16x16x32_bf16 v[112:115], a[240:243], v[44:47], v[112:115]
    s_mov_b32 m0, s60
    ds_read_b64_tr_b16 a[214:215], v4 offset:1544
    v_mfma_f32_16x16x32_bf16 v[144:147], a[240:243], v[48:51], v[144:147]
    s_add_u32 s55, s58, 0
    buffer_load_dwordx4 v1, s[24:27], s55 offen offset:0 sc1 lds
    v_mfma_f32_16x16x32_bf16 v[176:179], a[240:243], v[52:55], v[176:179]
    s_add_u32 s60, s60, 16384
    ds_read_b64_tr_b16 a[216:217], v4 offset:768
    v_mfma_f32_16x16x32_bf16 v[208:211], a[240:243], v[56:59], v[208:211]
    s_cmp_ge_u32 s60, 163840
    s_cselect_b32 s56, 163840, 0
    ds_read_b64_tr_b16 a[218:219], v4 offset:1792
    v_mfma_f32_16x16x32_bf16 v[240:243], a[240:243], v[60:63], v[240:243]
    s_sub_u32 s60, s60, s56
    global_load_dwordx4 a[16:19], v15, s[12:13] sc1
    v_mfma_f32_16x16x32_bf16 v[84:87], a[244:247], v[40:43], v[84:87]
    s_lshr_b32 s56, s60, 14
    ds_read_b64_tr_b16 a[220:221], v4 offset:776
    v_mfma_f32_16x16x32_bf16 v[116:119], a[244:247], v[44:47], v[116:119]
    s_cmp_eq_u32 s56, 3
    s_cselect_b32 s56, 81920, 0
    ds_read_b64_tr_b16 a[222:223], v4 offset:1800
    v_mfma_f32_16x16x32_bf16 v[148:151], a[244:247], v[48:51], v[148:151]
    s_add_u32 s55, s58, 31744
    buffer_load_dwordx4 v1, s[24:27], s55 offen offset:1024 sc1 lds
    v_mfma_f32_16x16x32_bf16 v[180:183], a[244:247], v[52:55], v[180:183]
    s_add_u32 s60, s60, s56
    v_mfma_f32_16x16x32_bf16 v[212:215], a[244:247], v[56:59], v[212:215]
    v_mfma_f32_16x16x32_bf16 v[244:247], a[244:247], v[60:63], v[244:247]
    v_add_u32 v15, 768, v15
    v_mfma_f32_16x16x32_bf16 v[88:91], a[248:251], v[40:43], v[88:91]
    v_mfma_f32_16x16x32_bf16 v[120:123], a[248:251], v[44:47], v[120:123]
    v_mfma_f32_16x16x32_bf16 v[152:155], a[248:251], v[48:51], v[152:155]
    s_add_u32 s55, s58, 63488
    buffer_load_dwordx4 v1, s[24:27], s55 offen offset:2048 sc1 lds
    v_mfma_f32_16x16x32_bf16 v[184:187], a[248:251], v[52:55], v[184:187]
    v_mfma_f32_16x16x32_bf16 v[216:219], a[248:251], v[56:59], v[216:219]
    v_mfma_f32_16x16x32_bf16 v[248:251], a[248:251], v[60:63], v[248:251]
    v_mfma_f32_16x16x32_bf16 v[92:95], a[252:255], v[40:43], v[92:95]
    v_add_u32 v4, s62, v13
    v_mfma_f32_16x16x32_bf16 v[124:127], a[252:255], v[44:47], v[124:127]
    v_mfma_f32_16x16x32_bf16 v[156:159], a[252:255], v[48:51], v[156:159]
    s_add_u32 s55, s58, 95232
    buffer_load_dwordx4 v1, s[24:27], s55 offen offset:3072 sc1 lds
    v_mfma_f32_16x16x32_bf16 v[188:191], a[252:255], v[52:55], v[188:191]
    s_add_u32 s58, s58, 262144
    v_mfma_f32_16x16x32_bf16 v[220:223], a[252:255], v[56:59], v[220:223]
    v_mfma_f32_16x16x32_bf16 v[252:255], a[252:255], v[60:63], v[252:255]
    s_waitcnt lgkmcnt(0)
    v_mfma_f32_16x16x32_bf16 v[64:67], a[192:195], v[16:19], v[64:67]
    ds_read_b64_tr_b16 a[224:225], v4 offset:0
    v_mfma_f32_16x16x32_bf16 v[96:99], a[192:195], v[20:23], v[96:99]
    s_add_u32 m0, s61, 0
    ds_read_b64_tr_b16 a[226:227], v4 offset:1024
    v_mfma_f32_16x16x32_bf16 v[128:131], a[192:195], v[24:27], v[128:131]
    s_add_u32 s55, s59, 0
    buffer_load_dwordx4 v2, s[20:23], s55 offen offset:0 sc1 lds
    v_mfma_f32_16x16x32_bf16 v[160:163], a[192:195], v[28:31], v[160:163]
    ds_read_b128 v[40:43], v6 offset:0
    v_mfma_f32_16x16x32_bf16 v[192:195], a[192:195], v[32:35], v[192:195]
    ds_read_b128 v[44:47], v6 offset:2048
    v_mfma_f32_16x16x32_bf16 v[224:227], a[192:195], v[36:39], v[224:227]
    v_mfma_f32_16x16x32_bf16 v[68:71], a[196:199], v[16:19], v[68:71]
    ds_read_b128 v[48:51], v6 offset:4096
    v_mfma_f32_16x16x32_bf16 v[100:103], a[196:199], v[20:23], v[100:103]
    ds_read_b128 v[52:55], v9 offset:0
    v_mfma_f32_16x16x32_bf16 v[132:135], a[196:199], v[24:27], v[132:135]
    s_add_u32 s55, s59, 8192
    buffer_load_dwordx4 v2, s[20:23], s55 offen offset:1024 sc1 lds
    v_mfma_f32_16x16x32_bf16 v[164:167], a[196:199], v[28:31], v[164:167]
    s_add_u32 s63, s63, 24576
    ds_read_b128 v[56:59], v9 offset:2048
    v_mfma_f32_16x16x32_bf16 v[196:199], a[196:199], v[32:35], v[196:199]
    s_cmp_ge_u32 s63, 122880
    s_cselect_b32 s81, 73728, 0
    ds_read_b128 v[60:63], v9 offset:4096
    v_mfma_f32_16x16x32_bf16 v[228:231], a[196:199], v[36:39], v[228:231]
    s_sub_u32 s63, s63, s81
    v_mfma_f32_16x16x32_bf16 v[72:75], a[200:203], v[16:19], v[72:75]
    ds_read_b64_tr_b16 a[228:229], v4 offset:8
    v_mfma_f32_16x16x32_bf16 v[104:107], a[200:203], v[20:23], v[104:107]
    ds_read_b64_tr_b16 a[230:231], v4 offset:1032
    v_mfma_f32_16x16x32_bf16 v[136:139], a[200:203], v[24:27], v[136:139]
    s_add_u32 s55, s59, 16384
    buffer_load_dwordx4 v2, s[20:23], s55 offen offset:2048 sc1 lds
    v_mfma_f32_16x16x32_bf16 v[168:171], a[200:203], v[28:31], v[168:171]
    s_add_u32 s62, s62, 16384
    ds_read_b64_tr_b16 a[232:233], v4 offset:256
    v_mfma_f32_16x16x32_bf16 v[200:203], a[200:203], v[32:35], v[200:203]
    s_cmp_ge_u32 s62, 163840
    s_cselect_b32 s81, 163840, 0
    ds_read_b64_tr_b16 a[234:235], v4 offset:1280
    v_mfma_f32_16x16x32_bf16 v[232:235], a[200:203], v[36:39], v[232:235]
    s_sub_u32 s62, s62, s81
    v_mfma_f32_16x16x32_bf16 v[76:79], a[204:207], v[16:19], v[76:79]
    s_lshr_b32 s81, s62, 14
    ds_read_b64_tr_b16 a[236:237], v4 offset:264
    v_mfma_f32_16x16x32_bf16 v[108:111], a[204:207], v[20:23], v[108:111]
    s_cmp_eq_u32 s81, 3
    s_cselect_b32 s81, 81920, 0
    ds_read_b64_tr_b16 a[238:239], v4 offset:1288
    v_mfma_f32_16x16x32_bf16 v[140:143], a[204:207], v[24:27], v[140:143]
    s_add_u32 s55, s59, 24576
    buffer_load_dwordx4 v2, s[20:23], s55 offen offset:3072 sc1 lds
    v_mfma_f32_16x16x32_bf16 v[172:175], a[204:207], v[28:31], v[172:175]
    ds_read_b64_tr_b16 a[240:241], v4 offset:512
    v_mfma_f32_16x16x32_bf16 v[204:207], a[204:207], v[32:35], v[204:207]
    s_add_u32 s62, s62, s81
    ds_read_b64_tr_b16 a[242:243], v4 offset:1536
    v_mfma_f32_16x16x32_bf16 v[236:239], a[204:207], v[36:39], v[236:239]
    v_mfma_f32_16x16x32_bf16 v[80:83], a[208:211], v[16:19], v[80:83]
    ds_read_b64_tr_b16 a[244:245], v4 offset:520
    v_mfma_f32_16x16x32_bf16 v[112:115], a[208:211], v[20:23], v[112:115]
    s_add_u32 m0, s61, 4096
    ds_read_b64_tr_b16 a[246:247], v4 offset:1544
    v_mfma_f32_16x16x32_bf16 v[144:147], a[208:211], v[24:27], v[144:147]
    s_add_u32 s55, s59, 36864
    buffer_load_dwordx4 v2, s[20:23], s55 offen offset:0 sc1 lds
    v_mfma_f32_16x16x32_bf16 v[176:179], a[208:211], v[28:31], v[176:179]
    ds_read_b64_tr_b16 a[248:249], v4 offset:768
    v_mfma_f32_16x16x32_bf16 v[208:211], a[208:211], v[32:35], v[208:211]
    ds_read_b64_tr_b16 a[250:251], v4 offset:1792
    v_mfma_f32_16x16x32_bf16 v[240:243], a[208:211], v[36:39], v[240:243]
    v_mfma_f32_16x16x32_bf16 v[84:87], a[212:215], v[16:19], v[84:87]
    ds_read_b64_tr_b16 a[252:253], v4 offset:776
    v_mfma_f32_16x16x32_bf16 v[116:119], a[212:215], v[20:23], v[116:119]
    ds_read_b64_tr_b16 a[254:255], v4 offset:1800
    v_mfma_f32_16x16x32_bf16 v[148:151], a[212:215], v[24:27], v[148:151]
    s_add_u32 s55, s59, 45056
    buffer_load_dwordx4 v2, s[20:23], s55 offen offset:1024 sc1 lds
    v_mfma_f32_16x16x32_bf16 v[180:183], a[212:215], v[28:31], v[180:183]
    s_add_u32 s59, s59, 128
    v_mfma_f32_16x16x32_bf16 v[212:215], a[212:215], v[32:35], v[212:215]
    s_add_u32 s61, s61, 24576
    v_mfma_f32_16x16x32_bf16 v[244:247], a[212:215], v[36:39], v[244:247]
    s_cmp_ge_u32 s61, 122880
    s_cselect_b32 s56, 73728, 0
    v_mfma_f32_16x16x32_bf16 v[88:91], a[216:219], v[16:19], v[88:91]
    s_sub_u32 s61, s61, s56
    v_mfma_f32_16x16x32_bf16 v[120:123], a[216:219], v[20:23], v[120:123]
    v_mfma_f32_16x16x32_bf16 v[152:155], a[216:219], v[24:27], v[152:155]
    v_mfma_f32_16x16x32_bf16 v[184:187], a[216:219], v[28:31], v[184:187]
    v_mfma_f32_16x16x32_bf16 v[216:219], a[216:219], v[32:35], v[216:219]
    v_mfma_f32_16x16x32_bf16 v[248:251], a[216:219], v[36:39], v[248:251]
    v_mfma_f32_16x16x32_bf16 v[92:95], a[220:223], v[16:19], v[92:95]
    v_add_u32 v4, s62, v13
    v_mfma_f32_16x16x32_bf16 v[124:127], a[220:223], v[20:23], v[124:127]
    v_add_u32 v5, s63, v14
    v_mfma_f32_16x16x32_bf16 v[156:159], a[220:223], v[24:27], v[156:159]
    s_sub_u32 s57, s57, 1
    v_xor_b32 v6, 64, v5
    v_mfma_f32_16x16x32_bf16 v[188:191], a[220:223], v[28:31], v[188:191]
    s_cmp_lg_u32 s57, 0
    v_add_u32 v8, s79, v5
    v_mfma_f32_16x16x32_bf16 v[220:223], a[220:223], v[32:35], v[220:223]
    v_add_u32 v9, s79, v6
    v_mfma_f32_16x16x32_bf16 v[252:255], a[220:223], v[36:39], v[252:255]
    s_waitcnt vmcnt(11) lgkmcnt(0)
    s_barrier
    s_cbranch_scc1 L_qloop
    v_mfma_f32_16x16x32_bf16 v[64:67], a[224:227], v[40:43], v[64:67]
    ds_read_b64_tr_b16 a[192:193], v4 offset:0
    v_mfma_f32_16x16x32_bf16 v[96:99], a[224:227], v[44:47], v[96:99]
    s_mov_b32 m0, s60
    ds_read_b64_tr_b16 a[194:195], v4 offset:1024
    v_mfma_f32_16x16x32_bf16 v[128:131], a[224:227], v[48:51], v[128:131]
    s_add_u32 s55, s58, 0
    buffer_load_dwordx4 v1, s[24:27], s55 offen offset:0 sc1 lds
    v_mfma_f32_16x16x32_bf16 v[160:163], a[224:227], v[52:55], v[160:163]
    s_add_u32 s60, s60, 16384
    ds_read_b128 v[16:19], v5 offset:0
    v_mfma_f32_16x16x32_bf16 v[192:195], a[224:227], v[56:59], v[192:195]
    s_cmp_ge_u32 s60, 163840
    s_cselect_b32 s56, 163840, 0
    ds_read_b128 v[20:23], v5 offset:2048
    v_mfma_f32_16x16x32_bf16 v[224:227], a[224:227], v[60:63], v[224:227]
    s_sub_u32 s60, s60, s56
    v_mfma_f32_16x16x32_bf16 v[68:71], a[228:231], v[40:43], v[68:71]
    s_lshr_b32 s56, s60, 14
    ds_read_b128 v[24:27], v5 offset:4096
    v_mfma_f32_16x16x32_bf16 v[100:103], a[228:231], v[44:47], v[100:103]
    s_cmp_eq_u32 s56, 3
    s_cselect_b32 s56, 81920, 0
    ds_read_b128 v[28:31], v8 offset:0
    v_mfma_f32_16x16x32_bf16 v[132:135], a[228:231], v[48:51], v[132:135]
    s_add_u32 s55, s58, 31744
    buffer_load_dwordx4 v1, s[24:27], s55 offen offset:1024 sc1 lds
    v_mfma_f32_16x16x32_bf16 v[164:167], a[228:231], v[52:55], v[164:167]
    s_add_u32 s60, s60, s56
    ds_read_b128 v[32:35], v8 offset:2048
    v_mfma_f32_16x16x32_bf16 v[196:199], a[228:231], v[56:59], v[196:199]
    ds_read_b128 v[36:39], v8 offset:4096
    v_mfma_f32_16x16x32_bf16 v[228:231], a[228:231], v[60:63], v[228:231]
    v_mfma_f32_16x16x32_bf16 v[72:75], a[232:235], v[40:43], v[72:75]
    ds_read_b64_tr_b16 a[196:197], v4 offset:8
    v_mfma_f32_16x16x32_bf16 v[104:107], a[232:235], v[44:47], v[104:107]
    ds_read_b64_tr_b16 a[198:199], v4 offset:1032
    v_mfma_f32_16x16x32_bf16 v[136:139], a[232:235], v[48:51], v[136:139]
    s_add_u32 s55, s58, 63488
    buffer_load_dwordx4 v1, s[24:27], s55 offen offset:2048 sc1 lds
    v_mfma_f32_16x16x32_bf16 v[168:171], a[232:235], v[52:55], v[168:171]
    s_add_u32 s62, s62, 16384
    ds_read_b64_tr_b16 a[200:201], v4 offset:256
    v_mfma_f32_16x16x32_bf16 v[200:203], a[232:235], v[56:59], v[200:203]
    s_cmp_ge_u32 s62, 163840
    s_cselect_b32 s81, 163840, 0
    ds_read_b64_tr_b16 a[202:203], v4 offset:1280
    v_mfma_f32_16x16x32_bf16 v[232:235], a[232:235], v[60:63], v[232:235]
    s_sub_u32 s62, s62, s81
    v_mfma_f32_16x16x32_bf16 v[76:79], a[236:239], v[40:43], v[76:79]
    s_lshr_b32 s81, s62, 14
    ds_read_b64_tr_b16 a[204:205], v4 offset:264
    v_mfma_f32_16x16x32_bf16 v[108:111], a[236:239], v[44:47], v[108:111]
    s_cmp_eq_u32 s81, 3
    s_cselect_b32 s81, 81920, 0
    ds_read_b64_tr_b16 a[206:207], v4 offset:1288
    v_mfma_f32_16x16x32_bf16 v[140:143], a[236:239], v[48:51], v[140:143]
    s_add_u32 s55, s58, 95232
    buffer_load_dwordx4 v1, s[24:27], s55 offen offset:3072 sc1 lds
    v_mfma_f32_16x16x32_bf16 v[172:175], a[236:239], v[52:55], v[172:175]
    s_add_u32 s58, s58, 262144
    ds_read_b64_tr_b16 a[208:209], v4 offset:512
    v_mfma_f32_16x16x32_bf16 v[204:207], a[236:239], v[56:59], v[204:207]
    s_add_u32 s62, s62, s81
    ds_read_b64_tr_b16 a[210:211], v4 offset:1536
    v_mfma_f32_16x16x32_bf16 v[236:239], a[236:239], v[60:63], v[236:239]
    v_mfma_f32_16x16x32_bf16 v[80:83], a[240:243], v[40:43], v[80:83]
    ds_read_b64_tr_b16 a[212:213], v4 offset:520
    v_mfma_f32_16x16x32_bf16 v[112:115], a[240:243], v[44:47], v[112:115]
    s_add_u32 m0, s65, -65536
    ds_read_b64_tr_b16 a[214:215], v4 offset:1544
    v_mfma_f32_16x16x32_bf16 v[144:147], a[240:243], v[48:51], v[144:147]
    s_mov_b32 s55, 0
    buffer_load_dwordx4 v3, s[44:47], s55 offen offset:0 sc0 nt sc1 lds
    v_mfma_f32_16x16x32_bf16 v[176:179], a[240:243], v[52:55], v[176:179]
    ds_read_b64_tr_b16 a[216:217], v4 offset:768
    v_mfma_f32_16x16x32_bf16 v[208:211], a[240:243], v[56:59], v[208:211]
    ds_read_b64_tr_b16 a[218:219], v4 offset:1792
    v_mfma_f32_16x16x32_bf16 v[240:243], a[240:243], v[60:63], v[240:243]
    v_mfma_f32_16x16x32_bf16 v[84:87], a[244:247], v[40:43], v[84:87]
    ds_read_b64_tr_b16 a[220:221], v4 offset:776
    v_mfma_f32_16x16x32_bf16 v[116:119], a[244:247], v[44:47], v[116:119]
    ds_read_b64_tr_b16 a[222:223], v4 offset:1800
    v_mfma_f32_16x16x32_bf16 v[148:151], a[244:247], v[48:51], v[148:151]
    v_mfma_f32_16x16x32_bf16 v[180:183], a[244:247], v[52:55], v[180:183]
    v_mfma_f32_16x16x32_bf16 v[212:215], a[244:247], v[56:59], v[212:215]
    v_mfma_f32_16x16x32_bf16 v[244:247], a[244:247], v[60:63], v[244:247]
    v_mfma_f32_16x16x32_bf16 v[88:91], a[248:251], v[40:43], v[88:91]
    v_mfma_f32_16x16x32_bf16 v[120:123], a[248:251], v[44:47], v[120:123]
    v_mfma_f32_16x16x32_bf16 v[152:155], a[248:251], v[48:51], v[152:155]
    s_mov_b32 s55, 0
    buffer_load_dwordx4 v3, s[44:47], s55 offen offset:1024 sc0 nt sc1 lds
    v_mfma_f32_16x16x32_bf16 v[184:187], a[248:251], v[52:55], v[184:187]
    v_mfma_f32_16x16x32_bf16 v[216:219], a[248:251], v[56:59], v[216:219]
    v_mfma_f32_16x16x32_bf16 v[248:251], a[248:251], v[60:63], v[248:251]
    v_mfma_f32_16x16x32_bf16 v[92:95], a[252:255], v[40:43], v[92:95]
    v_add_u32 v4, s62, v13
    v_mfma_f32_16x16x32_bf16 v[124:127], a[252:255], v[44:47], v[124:127]
    v_mfma_f32_16x16x32_bf16 v[156:159], a[252:255], v[48:51], v[156:159]
    v_mfma_f32_16x16x32_bf16 v[188:191], a[252:255], v[52:55], v[188:191]
    v_mfma_f32_16x16x32_bf16 v[220:223], a[252:255], v[56:59], v[220:223]
    v_mfma_f32_16x16x32_bf16 v[252:255], a[252:255], v[60:63], v[252:255]
    s_waitcnt lgkmcnt(0)
    v_mfma_f32_16x16x32_bf16 v[64:67], a[192:195], v[16:19], v[64:67]
    ds_read_b64_tr_b16 a[224:225], v4 offset:0
    v_mfma_f32_16x16x32_bf16 v[96:99], a[192:195], v[20:23], v[96:99]
    s_add_u32 m0, s65, -57344
    ds_read_b64_tr_b16 a[226:227], v4 offset:1024
    v_mfma_f32_16x16x32_bf16 v[128:131], a[192:195], v[24:27], v[128:131]
    s_mov_b32 s55, 262144
    buffer_load_dwordx4 v3, s[44:47], s55 offen offset:0 sc0 nt sc1 lds
    v_mfma_f32_16x16x32_bf16 v[160:163], a[192:195], v[28:31], v[160:163]
    ds_read_b128 v[40:43], v6 offset:0
    v_mfma_f32_16x16x32_bf16 v[192:195], a[192:195], v[32:35], v[192:195]
    ds_read_b128 v[44:47], v6 offset:2048
    v_mfma_f32_16x16x32_bf16 v[224:227], a[192:195], v[36:39], v[224:227]
    v_mfma_f32_16x16x32_bf16 v[68:71], a[196:199], v[16:19], v[68:71]
    ds_read_b128 v[48:51], v6 offset:4096
    v_mfma_f32_16x16x32_bf16 v[100:103], a[196:199], v[20:23], v[100:103]
    ds_read_b128 v[52:55], v9 offset:0
    v_mfma_f32_16x16x32_bf16 v[132:135], a[196:199], v[24:27], v[132:135]
    v_mfma_f32_16x16x32_bf16 v[164:167], a[196:199], v[28:31], v[164:167]
    s_add_u32 s63, s63, 24576
    ds_read_b128 v[56:59], v9 offset:2048
    v_mfma_f32_16x16x32_bf16 v[196:199], a[196:199], v[32:35], v[196:199]
    s_cmp_ge_u32 s63, 122880
    s_cselect_b32 s81, 73728, 0
    ds_read_b128 v[60:63], v9 offset:4096
    v_mfma_f32_16x16x32_bf16 v[228:231], a[196:199], v[36:39], v[228:231]
    s_sub_u32 s63, s63, s81
    v_mfma_f32_16x16x32_bf16 v[72:75], a[200:203], v[16:19], v[72:75]
    ds_read_b64_tr_b16 a[228:229], v4 offset:8
    v_mfma_f32_16x16x32_bf16 v[104:107], a[200:203], v[20:23], v[104:107]
    ds_read_b64_tr_b16 a[230:231], v4 offset:1032
    v_mfma_f32_16x16x32_bf16 v[136:139], a[200:203], v[24:27], v[136:139]
    s_mov_b32 s55, 262144
    buffer_load_dwordx4 v3, s[44:47], s55 offen offset:1024 sc0 nt sc1 lds
    v_mfma_f32_16x16x32_bf16 v[168:171], a[200:203], v[28:31], v[168:171]
    s_add_u32 s62, s62, 16384
    ds_read_b64_tr_b16 a[232:233], v4 offset:256
    v_mfma_f32_16x16x32_bf16 v[200:203], a[200:203], v[32:35], v[200:203]
    s_cmp_ge_u32 s62, 163840
    s_cselect_b32 s81, 163840, 0
    ds_read_b64_tr_b16 a[234:235], v4 offset:1280
    v_mfma_f32_16x16x32_bf16 v[232:235], a[200:203], v[36:39], v[232:235]
    s_sub_u32 s62, s62, s81
    v_mfma_f32_16x16x32_bf16 v[76:79], a[204:207], v[16:19], v[76:79]
    s_lshr_b32 s81, s62, 14
    ds_read_b64_tr_b16 a[236:237], v4 offset:264
    v_mfma_f32_16x16x32_bf16 v[108:111], a[204:207], v[20:23], v[108:111]
    s_cmp_eq_u32 s81, 3
    s_cselect_b32 s81, 81920, 0
    ds_read_b64_tr_b16 a[238:239], v4 offset:1288
    v_mfma_f32_16x16x32_bf16 v[140:143], a[204:207], v[24:27], v[140:143]
    v_mfma_f32_16x16x32_bf16 v[172:175], a[204:207], v[28:31], v[172:175]
    ds_read_b64_tr_b16 a[240:241], v4 offset:512
    v_mfma_f32_16x16x32_bf16 v[204:207], a[204:207], v[32:35], v[204:207]
    s_add_u32 s62, s62, s81
    ds_read_b64_tr_b16 a[242:243], v4 offset:1536
    v_mfma_f32_16x16x32_bf16 v[236:239], a[204:207], v[36:39], v[236:239]
    v_mfma_f32_16x16x32_bf16 v[80:83], a[208:211], v[16:19], v[80:83]
    ds_read_b64_tr_b16 a[244:245], v4 offset:520
    v_mfma_f32_16x16x32_bf16 v[112:115], a[208:211], v[20:23], v[112:115]
    s_add_u32 m0, s65, 0
    ds_read_b64_tr_b16 a[246:247], v4 offset:1544
    v_mfma_f32_16x16x32_bf16 v[144:147], a[208:211], v[24:27], v[144:147]
    buffer_load_dwordx4 v3, s[28:31], s66 offen offset:0 sc0 nt sc1 lds
    v_mfma_f32_16x16x32_bf16 v[176:179], a[208:211], v[28:31], v[176:179]
    ds_read_b64_tr_b16 a[248:249], v4 offset:768
    v_mfma_f32_16x16x32_bf16 v[208:211], a[208:211], v[32:35], v[208:211]
    ds_read_b64_tr_b16 a[250:251], v4 offset:1792
    v_mfma_f32_16x16x32_bf16 v[240:243], a[208:211], v[36:39], v[240:243]
    v_mfma_f32_16x16x32_bf16 v[84:87], a[212:215], v[16:19], v[84:87]
    ds_read_b64_tr_b16 a[252:253], v4 offset:776
    v_mfma_f32_16x16x32_bf16 v[116:119], a[212:215], v[20:23], v[116:119]
    ds_read_b64_tr_b16 a[254:255], v4 offset:1800
    v_mfma_f32_16x16x32_bf16 v[148:151], a[212:215], v[24:27], v[148:151]
    v_mfma_f32_16x16x32_bf16 v[180:183], a[212:215], v[28:31], v[180:183]
    v_mfma_f32_16x16x32_bf16 v[212:215], a[212:215], v[32:35], v[212:215]
    v_mfma_f32_16x16x32_bf16 v[244:247], a[212:215], v[36:39], v[244:247]
    v_mfma_f32_16x16x32_bf16 v[88:91], a[216:219], v[16:19], v[88:91]
    v_mfma_f32_16x16x32_bf16 v[120:123], a[216:219], v[20:23], v[120:123]
    v_mfma_f32_16x16x32_bf16 v[152:155], a[216:219], v[24:27], v[152:155]
    buffer_load_dwordx4 v3, s[28:31], s66 offen offset:1024 sc0 nt sc1 lds
    v_mfma_f32_16x16x32_bf16 v[184:187], a[216:219], v[28:31], v[184:187]
    v_mfma_f32_16x16x32_bf16 v[216:219], a[216:219], v[32:35], v[216:219]
    v_mfma_f32_16x16x32_bf16 v[248:251], a[216:219], v[36:39], v[248:251]
    v_mfma_f32_16x16x32_bf16 v[92:95], a[220:223], v[16:19], v[92:95]
    v_add_u32 v4, s62, v13
    v_mfma_f32_16x16x32_bf16 v[124:127], a[220:223], v[20:23], v[124:127]
    v_add_u32 v5, s63, v14
    v_mfma_f32_16x16x32_bf16 v[156:159], a[220:223], v[24:27], v[156:159]
    v_xor_b32 v6, 64, v5
    v_mfma_f32_16x16x32_bf16 v[188:191], a[220:223], v[28:31], v[188:191]
    v_add_u32 v8, s79, v5
    v_mfma_f32_16x16x32_bf16 v[220:223], a[220:223], v[32:35], v[220:223]
    v_add_u32 v9, s79, v6
    v_mfma_f32_16x16x32_bf16 v[252:255], a[220:223], v[36:39], v[252:255]
    s_waitcnt vmcnt(6) lgkmcnt(0)
    s_barrier
    v_mfma_f32_16x16x32_bf16 v[64:67], a[224:227], v[40:43], v[64:67]
    ds_read_b64_tr_b16 a[192:193], v4 offset:0
    v_mfma_f32_16x16x32_bf16 v[96:99], a[224:227], v[44:47], v[96:99]
    s_add_u32 m0, s65, 8192
    ds_read_b64_tr_b16 a[194:195], v4 offset:1024
    v_mfma_f32_16x16x32_bf16 v[128:131], a[224:227], v[48:51], v[128:131]
    buffer_load_dwordx4 v3, s[32:35], s66 offen offset:0 sc0 nt sc1 lds
    v_mfma_f32_16x16x32_bf16 v[160:163], a[224:227], v[52:55], v[160:163]
    ds_read_b128 v[16:19], v5 offset:0
    v_mfma_f32_16x16x32_bf16 v[192:195], a[224:227], v[56:59], v[192:195]
    ds_read_b128 v[20:23], v5 offset:2048
    v_mfma_f32_16x16x32_bf16 v[224:227], a[224:227], v[60:63], v[224:227]
    v_mfma_f32_16x16x32_bf16 v[68:71], a[228:231], v[40:43], v[68:71]
    ds_read_b128 v[24:27], v5 offset:4096
    v_mfma_f32_16x16x32_bf16 v[100:103], a[228:231], v[44:47], v[100:103]
    ds_read_b128 v[28:31], v8 offset:0
    v_mfma_f32_16x16x32_bf16 v[132:135], a[228:231], v[48:51], v[132:135]
    v_mfma_f32_16x16x32_bf16 v[164:167], a[228:231], v[52:55], v[164:167]
    ds_read_b128 v[32:35], v8 offset:2048
    v_mfma_f32_16x16x32_bf16 v[196:199], a[228:231], v[56:59], v[196:199]
    ds_read_b128 v[36:39], v8 offset:4096
    v_mfma_f32_16x16x32_bf16 v[228:231], a[228:231], v[60:63], v[228:231]
    v_mfma_f32_16x16x32_bf16 v[72:75], a[232:235], v[40:43], v[72:75]
    ds_read_b64_tr_b16 a[196:197], v4 offset:8
    v_mfma_f32_16x16x32_bf16 v[104:107], a[232:235], v[44:47], v[104:107]
    ds_read_b64_tr_b16 a[198:199], v4 offset:1032
    v_mfma_f32_16x16x32_bf16 v[136:139], a[232:235], v[48:51], v[136:139]
    v_mfma_f32_16x16x32_bf16 v[168:171], a[232:235], v[52:55], v[168:171]
    s_add_u32 s62, s62, 16384
    ds_read_b64_tr_b16 a[200:201], v4 offset:256
    v_mfma_f32_16x16x32_bf16 v[200:203], a[232:235], v[56:59], v[200:203]
    s_cmp_ge_u32 s62, 163840
    s_cselect_b32 s81, 163840, 0
    ds_read_b64_tr_b16 a[202:203], v4 offset:1280
    v_mfma_f32_16x16x32_bf16 v[232:235], a[232:235], v[60:63], v[232:235]
    s_sub_u32 s62, s62, s81
    buffer_load_dwordx4 v3, s[32:35], s66 offen offset:1024 sc0 nt sc1 lds
    v_mfma_f32_16x16x32_bf16 v[76:79], a[236:239], v[40:43], v[76:79]
    s_lshr_b32 s81, s62, 14
    ds_read_b64_tr_b16 a[204:205], v4 offset:264
    v_mfma_f32_16x16x32_bf16 v[108:111], a[236:239], v[44:47], v[108:111]
    s_cmp_eq_u32 s81, 3
    s_cselect_b32 s81, 81920, 0
    ds_read_b64_tr_b16 a[206:207], v4 offset:1288
    v_mfma_f32_16x16x32_bf16 v[140:143], a[236:239], v[48:51], v[140:143]
    v_mfma_f32_16x16x32_bf16 v[172:175], a[236:239], v[52:55], v[172:175]
    ds_read_b64_tr_b16 a[208:209], v4 offset:512
    v_mfma_f32_16x16x32_bf16 v[204:207], a[236:239], v[56:59], v[204:207]
    s_add_u32 s62, s62, s81
    ds_read_b64_tr_b16 a[210:211], v4 offset:1536
    v_mfma_f32_16x16x32_bf16 v[236:239], a[236:239], v[60:63], v[236:239]
    v_mfma_f32_16x16x32_bf16 v[80:83], a[240:243], v[40:43], v[80:83]
    ds_read_b64_tr_b16 a[212:213], v4 offset:520
    v_mfma_f32_16x16x32_bf16 v[112:115], a[240:243], v[44:47], v[112:115]
    ds_read_b64_tr_b16 a[214:215], v4 offset:1544
    v_mfma_f32_16x16x32_bf16 v[144:147], a[240:243], v[48:51], v[144:147]
    v_mfma_f32_16x16x32_bf16 v[176:179], a[240:243], v[52:55], v[176:179]
    ds_read_b64_tr_b16 a[216:217], v4 offset:768
    v_mfma_f32_16x16x32_bf16 v[208:211], a[240:243], v[56:59], v[208:211]
    ds_read_b64_tr_b16 a[218:219], v4 offset:1792
    v_mfma_f32_16x16x32_bf16 v[240:243], a[240:243], v[60:63], v[240:243]
    v_mfma_f32_16x16x32_bf16 v[84:87], a[244:247], v[40:43], v[84:87]
    ds_read_b64_tr_b16 a[220:221], v4 offset:776
    v_mfma_f32_16x16x32_bf16 v[116:119], a[244:247], v[44:47], v[116:119]
    s_add_u32 m0, s65, 16384
    ds_read_b64_tr_b16 a[222:223], v4 offset:1800
    v_mfma_f32_16x16x32_bf16 v[148:151], a[244:247], v[48:51], v[148:151]
    buffer_load_dwordx4 v3, s[36:39], s66 offen offset:0 sc0 nt sc1 lds
    v_mfma_f32_16x16x32_bf16 v[180:183], a[244:247], v[52:55], v[180:183]
    v_mfma_f32_16x16x32_bf16 v[212:215], a[244:247], v[56:59], v[212:215]
    v_mfma_f32_16x16x32_bf16 v[244:247], a[244:247], v[60:63], v[244:247]
    v_mfma_f32_16x16x32_bf16 v[88:91], a[248:251], v[40:43], v[88:91]
    v_mfma_f32_16x16x32_bf16 v[120:123], a[248:251], v[44:47], v[120:123]
    v_mfma_f32_16x16x32_bf16 v[152:155], a[248:251], v[48:51], v[152:155]
    v_mfma_f32_16x16x32_bf16 v[184:187], a[248:251], v[52:55], v[184:187]
    v_mfma_f32_16x16x32_bf16 v[216:219], a[248:251], v[56:59], v[216:219]
    v_mfma_f32_16x16x32_bf16 v[248:251], a[248:251], v[60:63], v[248:251]
    v_mfma_f32_16x16x32_bf16 v[92:95], a[252:255], v[40:43], v[92:95]
    v_add_u32 v4, s62, v13
    v_mfma_f32_16x16x32_bf16 v[124:127], a[252:255], v[44:47], v[124:127]
    v_mfma_f32_16x16x32_bf16 v[156:159], a[252:255], v[48:51], v[156:159]
    v_mfma_f32_16x16x32_bf16 v[188:191], a[252:255], v[52:55], v[188:191]
    v_mfma_f32_16x16x32_bf16 v[220:223], a[252:255], v[56:59], v[220:223]
    v_mfma_f32_16x16x32_bf16 v[252:255], a[252:255], v[60:63], v[252:255]
    s_waitcnt lgkmcnt(0)
    buffer_load_dwordx4 v3, s[36:39], s66 offen offset:1024 sc0 nt sc1 lds
    v_mfma_f32_16x16x32_bf16 v[64:67], a[192:195], v[16:19], v[64:67]
    ds_read_b64_tr_b16 a[224:225], v4 offset:0
    v_mfma_f32_16x16x32_bf16 v[96:99], a[192:195], v[20:23], v[96:99]
    ds_read_b64_tr_b16 a[226:227], v4 offset:1024
    v_mfma_f32_16x16x32_bf16 v[128:131], a[192:195], v[24:27], v[128:131]
    v_mfma_f32_16x16x32_bf16 v[160:163], a[192:195], v[28:31], v[160:163]
    ds_read_b128 v[40:43], v6 offset:0
    v_mfma_f32_16x16x32_bf16 v[192:195], a[192:195], v[32:35], v[192:195]
    ds_read_b128 v[44:47], v6 offset:2048
    v_mfma_f32_16x16x32_bf16 v[224:227], a[192:195], v[36:39], v[224:227]
    v_mfma_f32_16x16x32_bf16 v[68:71], a[196:199], v[16:19], v[68:71]
    ds_read_b128 v[48:51], v6 offset:4096
    v_mfma_f32_16x16x32_bf16 v[100:103], a[196:199], v[20:23], v[100:103]
    ds_read_b128 v[52:55], v9 offset:0
    v_mfma_f32_16x16x32_bf16 v[132:135], a[196:199], v[24:27], v[132:135]
    v_mfma_f32_16x16x32_bf16 v[164:167], a[196:199], v[28:31], v[164:167]
    s_add_u32 s63, s63, 24576
    ds_read_b128 v[56:59], v9 offset:2048
    v_mfma_f32_16x16x32_bf16 v[196:199], a[196:199], v[32:35], v[196:199]
    s_cmp_ge_u32 s63, 122880
    s_cselect_b32 s81, 73728, 0
    ds_read_b128 v[60:63], v9 offset:4096
    v_mfma_f32_16x16x32_bf16 v[228:231], a[196:199], v[36:39], v[228:231]
    s_sub_u32 s63, s63, s81
    v_mfma_f32_16x16x32_bf16 v[72:75], a[200:203], v[16:19], v[72:75]
    ds_read_b64_tr_b16 a[228:229], v4 offset:8
    v_mfma_f32_16x16x32_bf16 v[104:107], a[200:203], v[20:23], v[104:107]
    s_add_u32 m0, s65, 24576
    ds_read_b64_tr_b16 a[230:231], v4 offset:1032
    v_mfma_f32_16x16x32_bf16 v[136:139], a[200:203], v[24:27], v[136:139]
    buffer_load_dwordx4 v3, s[40:43], s66 offen offset:0 sc0 nt sc1 lds
    v_mfma_f32_16x16x32_bf16 v[168:171], a[200:203], v[28:31], v[168:171]
    s_add_u32 s62, s62, 16384
    ds_read_b64_tr_b16 a[232:233], v4 offset:256
    v_mfma_f32_16x16x32_bf16 v[200:203], a[200:203], v[32:35], v[200:203]
    s_cmp_ge_u32 s62, 163840
    s_cselect_b32 s81, 163840, 0
    ds_read_b64_tr_b16 a[234:235], v4 offset:1280
    v_mfma_f32_16x16x32_bf16 v[232:235], a[200:203], v[36:39], v[232:235]
    s_sub_u32 s62, s62, s81
    v_mfma_f32_16x16x32_bf16 v[76:79], a[204:207], v[16:19], v[76:79]
    s_lshr_b32 s81, s62, 14
    ds_read_b64_tr_b16 a[236:237], v4 offset:264
    v_mfma_f32_16x16x32_bf16 v[108:111], a[204:207], v[20:23], v[108:111]
    s_cmp_eq_u32 s81, 3
    s_cselect_b32 s81, 81920, 0
    ds_read_b64_tr_b16 a[238:239], v4 offset:1288
    v_mfma_f32_16x16x32_bf16 v[140:143], a[204:207], v[24:27], v[140:143]
    v_mfma_f32_16x16x32_bf16 v[172:175], a[204:207], v[28:31], v[172:175]
    ds_read_b64_tr_b16 a[240:241], v4 offset:512
    v_mfma_f32_16x16x32_bf16 v[204:207], a[204:207], v[32:35], v[204:207]
    s_add_u32 s62, s62, s81
    ds_read_b64_tr_b16 a[242:243], v4 offset:1536
    v_mfma_f32_16x16x32_bf16 v[236:239], a[204:207], v[36:39], v[236:239]
    v_mfma_f32_16x16x32_bf16 v[80:83], a[208:211], v[16:19], v[80:83]
    ds_read_b64_tr_b16 a[244:245], v4 offset:520
    v_mfma_f32_16x16x32_bf16 v[112:115], a[208:211], v[20:23], v[112:115]
    ds_read_b64_tr_b16 a[246:247], v4 offset:1544
    v_mfma_f32_16x16x32_bf16 v[144:147], a[208:211], v[24:27], v[144:147]
    v_mfma_f32_16x16x32_bf16 v[176:179], a[208:211], v[28:31], v[176:179]
    ds_read_b64_tr_b16 a[248:249], v4 offset:768
    v_mfma_f32_16x16x32_bf16 v[208:211], a[208:211], v[32:35], v[208:211]
    ds_read_b64_tr_b16 a[250:251], v4 offset:1792
    v_mfma_f32_16x16x32_bf16 v[240:243], a[208:211], v[36:39], v[240:243]
    buffer_load_dwordx4 v3, s[40:43], s66 offen offset:1024 sc0 nt sc1 lds
    v_mfma_f32_16x16x32_bf16 v[84:87], a[212:215], v[16:19], v[84:87]
    ds_read_b64_tr_b16 a[252:253], v4 offset:776
    v_mfma_f32_16x16x32_bf16 v[116:119], a[212:215], v[20:23], v[116:119]
    ds_read_b64_tr_b16 a[254:255], v4 offset:1800
    v_mfma_f32_16x16x32_bf16 v[148:151], a[212:215], v[24:27], v[148:151]
    v_mfma_f32_16x16x32_bf16 v[180:183], a[212:215], v[28:31], v[180:183]
    v_mfma_f32_16x16x32_bf16 v[212:215], a[212:215], v[32:35], v[212:215]
    v_mfma_f32_16x16x32_bf16 v[244:247], a[212:215], v[36:39], v[244:247]
    v_mfma_f32_16x16x32_bf16 v[88:91], a[216:219], v[16:19], v[88:91]
    v_mfma_f32_16x16x32_bf16 v[120:123], a[216:219], v[20:23], v[120:123]
    v_mfma_f32_16x16x32_bf16 v[152:155], a[216:219], v[24:27], v[152:155]
    v_mfma_f32_16x16x32_bf16 v[184:187], a[216:219], v[28:31], v[184:187]
    v_mfma_f32_16x16x32_bf16 v[216:219], a[216:219], v[32:35], v[216:219]
    v_mfma_f32_16x16x32_bf16 v[248:251], a[216:219], v[36:39], v[248:251]
    v_mfma_f32_16x16x32_bf16 v[92:95], a[220:223], v[16:19], v[92:95]
    v_add_u32 v4, s62, v13
    v_mfma_f32_16x16x32_bf16 v[124:127], a[220:223], v[20:23], v[124:127]
    v_add_u32 v5, s63, v14
    v_mfma_f32_16x16x32_bf16 v[156:159], a[220:223], v[24:27], v[156:159]
    v_xor_b32 v6, 64, v5
    v_mfma_f32_16x16x32_bf16 v[188:191], a[220:223], v[28:31], v[188:191]
    s_add_u32 s66, s66, 8192
    s_add_u32 s65, s65, 32768
    s_cmp_ge_u32 s65, 163840
    s_cselect_b32 s56, 98304, 0
    s_sub_u32 s65, s65, s56
    v_add_u32 v8, s79, v5
    v_mfma_f32_16x16x32_bf16 v[220:223], a[220:223], v[32:35], v[220:223]
    v_add_u32 v9, s79, v6
    v_mfma_f32_16x16x32_bf16 v[252:255], a[220:223], v[36:39], v[252:255]
    s_waitcnt vmcnt(8) lgkmcnt(0)
    s_barrier
    v_mfma_f32_16x16x32_bf16 v[64:67], a[224:227], v[40:43], v[64:67]
    ds_read_b128 a[192:195], v7 offset:0
    v_accvgpr_read_b32 v1, a0
    v_mfma_f32_16x16x32_bf16 v[68:71], a[228:231], v[40:43], v[68:71]
    v_accvgpr_read_b32 v4, a2
    v_accvgpr_read_b32 v5, a3
    v_mfma_f32_16x16x32_bf16 v[72:75], a[232:235], v[40:43], v[72:75]
    s_add_u32 m0, s65, 0
    ds_read_b128 a[196:199], v7 offset:256
    v_accvgpr_read_b32 v6, a4
    v_mfma_f32_16x16x32_bf16 v[76:79], a[236:239], v[40:43], v[76:79]
    buffer_load_dwordx4 v3, s[28:31], s66 offen offset:0 sc0 nt sc1 lds
    v_accvgpr_read_b32 v13, a5
    v_mfma_f32_16x16x32_bf16 v[80:83], a[240:243], v[40:43], v[80:83]
    ds_read_b128 a[200:203], v7 offset:512
    v_accvgpr_read_b32 v14, a6
    v_mfma_f32_16x16x32_bf16 v[84:87], a[244:247], v[40:43], v[84:87]
    v_accvgpr_read_b32 v15, a7
    v_mov_b32 v16, 0
    v_mfma_f32_16x16x32_bf16 v[88:91], a[248:251], v[40:43], v[88:91]
    ds_read_b128 a[204:207], v7 offset:768
    v_mov_b32 v17, 0
    v_mfma_f32_16x16x32_bf16 v[92:95], a[252:255], v[40:43], v[92:95]
    v_mov_b32 v18, 0
    v_mov_b32 v19, 0
    v_mfma_f32_16x16x32_bf16 v[96:99], a[224:227], v[44:47], v[96:99]
    ds_read_b128 a[208:211], v7 offset:4096
    v_mfma_f32_16x16x32_bf16 v[100:103], a[228:231], v[44:47], v[100:103]
    v_mfma_f32_16x16x32_bf16 v[104:107], a[232:235], v[44:47], v[104:107]
    ds_read_b128 a[212:215], v7 offset:4352
    v_mul_f32 v64, s68, v64
    v_mfma_f32_16x16x32_bf16 v[108:111], a[236:239], v[44:47], v[108:111]
    v_mul_f32 v65, s68, v65
    v_mul_f32 v66, s68, v66
    v_mfma_f32_16x16x32_bf16 v[112:115], a[240:243], v[44:47], v[112:115]
    ds_read_b128 a[216:219], v7 offset:4608
    v_mul_f32 v67, s68, v67
    v_mfma_f32_16x16x32_bf16 v[116:119], a[244:247], v[44:47], v[116:119]
    v_mul_f32 v68, s68, v68
    v_mul_f32 v69, s68, v69
    v_mfma_f32_16x16x32_bf16 v[120:123], a[248:251], v[44:47], v[120:123]
    ds_read_b128 a[220:223], v7 offset:4864
    v_mul_f32 v70, s68, v70
    v_mfma_f32_16x16x32_bf16 v[124:127], a[252:255], v[44:47], v[124:127]
    buffer_load_dwordx4 v3, s[28:31], s66 offen offset:1024 sc0 nt sc1 lds
    v_mul_f32 v71, s68, v71
    v_mfma_f32_16x16x32_bf16 v[128:131], a[224:227], v[48:51], v[128:131]
    v_cvt_pk_bf16_f32 v64, v64, v65
    v_cvt_pk_bf16_f32 v65, v66, v67
    v_mfma_f32_16x16x32_bf16 v[132:135], a[228:231], v[48:51], v[132:135]
    v_cvt_pk_bf16_f32 v66, v68, v69
    v_cvt_pk_bf16_f32 v67, v70, v71
    v_mfma_f32_16x16x32_bf16 v[136:139], a[232:235], v[48:51], v[136:139]
    v_mul_f32 v72, s68, v72
    v_mul_f32 v73, s68, v73
    v_mfma_f32_16x16x32_bf16 v[140:143], a[236:239], v[48:51], v[140:143]
    v_mul_f32 v74, s68, v74
    v_mul_f32 v75, s68, v75
    v_mfma_f32_16x16x32_bf16 v[144:147], a[240:243], v[48:51], v[144:147]
    v_mul_f32 v76, s68, v76
    v_mul_f32 v77, s68, v77
    v_mfma_f32_16x16x32_bf16 v[148:151], a[244:247], v[48:51], v[148:151]
    v_mul_f32 v78, s68, v78
    v_mul_f32 v79, s68, v79
    v_mfma_f32_16x16x32_bf16 v[152:155], a[248:251], v[48:51], v[152:155]
    v_cvt_pk_bf16_f32 v68, v72, v73
    v_cvt_pk_bf16_f32 v69, v74, v75
    v_mfma_f32_16x16x32_bf16 v[156:159], a[252:255], v[48:51], v[156:159]
    v_cvt_pk_bf16_f32 v70, v76, v77
    v_cvt_pk_bf16_f32 v71, v78, v79
    v_mfma_f32_16x16x32_bf16 v[160:163], a[224:227], v[52:55], v[160:163]
    v_mul_f32 v80, s68, v80
    v_mul_f32 v81, s68, v81
    v_mfma_f32_16x16x32_bf16 v[164:167], a[228:231], v[52:55], v[164:167]
    v_mul_f32 v82, s68, v82
    v_mul_f32 v83, s68, v83
    v_mfma_f32_16x16x32_bf16 v[168:171], a[232:235], v[52:55], v[168:171]
    s_add_u32 m0, s65, 8192
    v_mul_f32 v84, s68, v84
    v_mul_f32 v85, s68, v85
    v_mfma_f32_16x16x32_bf16 v[172:175], a[236:239], v[52:55], v[172:175]
    buffer_load_dwordx4 v3, s[32:35], s66 offen offset:0 sc0 nt sc1 lds
    v_mul_f32 v86, s68, v86
    v_mfma_f32_16x16x32_bf16 v[176:179], a[240:243], v[52:55], v[176:179]
    v_mul_f32 v87, s68, v87
    v_cvt_pk_bf16_f32 v72, v80, v81
    v_mfma_f32_16x16x32_bf16 v[180:183], a[244:247], v[52:55], v[180:183]
    v_cvt_pk_bf16_f32 v73, v82, v83
    v_cvt_pk_bf16_f32 v74, v84, v85
    v_mfma_f32_16x16x32_bf16 v[184:187], a[248:251], v[52:55], v[184:187]
    v_cvt_pk_bf16_f32 v75, v86, v87
    v_mul_f32 v88, s68, v88
    v_mfma_f32_16x16x32_bf16 v[188:191], a[252:255], v[52:55], v[188:191]
    v_mul_f32 v89, s68, v89
    v_mul_f32 v90, s68, v90
    v_mfma_f32_16x16x32_bf16 v[192:195], a[224:227], v[56:59], v[192:195]
    v_mul_f32 v91, s68, v91
    v_mul_f32 v92, s68, v92
    v_mfma_f32_16x16x32_bf16 v[196:199], a[228:231], v[56:59], v[196:199]
    v_mul_f32 v93, s68, v93
    v_mul_f32 v94, s68, v94
    v_mfma_f32_16x16x32_bf16 v[200:203], a[232:235], v[56:59], v[200:203]
    v_mul_f32 v95, s68, v95
    v_cvt_pk_bf16_f32 v76, v88, v89
    v_mfma_f32_16x16x32_bf16 v[204:207], a[236:239], v[56:59], v[204:207]
    v_cvt_pk_bf16_f32 v77, v90, v91
    v_cvt_pk_bf16_f32 v78, v92, v93
    v_mfma_f32_16x16x32_bf16 v[208:211], a[240:243], v[56:59], v[208:211]
    v_cvt_pk_bf16_f32 v79, v94, v95
    v_mul_f32 v96, s68, v96
    v_mfma_f32_16x16x32_bf16 v[212:215], a[244:247], v[56:59], v[212:215]
    v_mul_f32 v97, s68, v97
    v_mul_f32 v98, s68, v98
    v_mfma_f32_16x16x32_bf16 v[216:219], a[248:251], v[56:59], v[216:219]
    v_mul_f32 v99, s68, v99
    v_mul_f32 v100, s68, v100
    v_mfma_f32_16x16x32_bf16 v[220:223], a[252:255], v[56:59], v[220:223]
    buffer_load_dwordx4 v3, s[32:35], s66 offen offset:1024 sc0 nt sc1 lds
    v_mul_f32 v101, s68, v101
    v_mfma_f32_16x16x32_bf16 v[224:227], a[224:227], v[60:63], v[224:227]
    v_mul_f32 v102, s68, v102
    v_mul_f32 v103, s68, v103
    v_mfma_f32_16x16x32_bf16 v[228:231], a[228:231], v[60:63], v[228:231]
    v_cvt_pk_bf16_f32 v80, v96, v97
    v_cvt_pk_bf16_f32 v81, v98, v99
    v_mfma_f32_16x16x32_bf16 v[232:235], a[232:235], v[60:63], v[232:235]
    v_cvt_pk_bf16_f32 v82, v100, v101
    v_cvt_pk_bf16_f32 v83, v102, v103
    v_mfma_f32_16x16x32_bf16 v[236:239], a[236:239], v[60:63], v[236:239]
    v_mfma_f32_16x16x32_bf16 v[240:243], a[240:243], v[60:63], v[240:243]
    v_mfma_f32_16x16x32_bf16 v[244:247], a[244:247], v[60:63], v[244:247]
    v_mfma_f32_16x16x32_bf16 v[248:251], a[248:251], v[60:63], v[248:251]
    v_mfma_f32_16x16x32_bf16 v[252:255], a[252:255], v[60:63], v[252:255]
    s_mul_i32 s59, s52, 9216
    v_pk_mul_f32 v[104:105], v[104:105], s[68:69]
    v_pk_mul_f32 v[106:107], v[106:107], s[68:69]
    v_pk_mul_f32 v[108:109], v[108:109], s[68:69]
    v_pk_mul_f32 v[110:111], v[110:111], s[68:69]
    v_cvt_pk_bf16_f32 v84, v104, v105
    v_cvt_pk_bf16_f32 v85, v106, v107
    v_cvt_pk_bf16_f32 v86, v108, v109
    v_cvt_pk_bf16_f32 v87, v110, v111
    s_add_u32 m0, s65, 16384
    s_nop 0
    buffer_load_dwordx4 v3, s[36:39], s66 offen offset:0 sc0 nt sc1 lds
    v_pk_mul_f32 v[112:113], v[112:113], s[68:69]
    v_pk_mul_f32 v[114:115], v[114:115], s[68:69]
    v_pk_mul_f32 v[116:117], v[116:117], s[68:69]
    v_pk_mul_f32 v[118:119], v[118:119], s[68:69]
    v_cvt_pk_bf16_f32 v88, v112, v113
    v_cvt_pk_bf16_f32 v89, v114, v115
    v_cvt_pk_bf16_f32 v90, v116, v117
    v_cvt_pk_bf16_f32 v91, v118, v119
    v_pk_mul_f32 v[120:121], v[120:121], s[68:69]
    v_pk_mul_f32 v[122:123], v[122:123], s[68:69]
    v_pk_mul_f32 v[124:125], v[124:125], s[68:69]
    v_pk_mul_f32 v[126:127], v[126:127], s[68:69]
    v_cvt_pk_bf16_f32 v92, v120, v121
    v_cvt_pk_bf16_f32 v93, v122, v123
    v_cvt_pk_bf16_f32 v94, v124, v125
    v_cvt_pk_bf16_f32 v95, v126, v127
    v_pk_mul_f32 v[128:129], v[128:129], s[68:69]
    v_pk_mul_f32 v[130:131], v[130:131], s[68:69]
    v_pk_mul_f32 v[132:133], v[132:133], s[68:69]
    v_pk_mul_f32 v[134:135], v[134:135], s[68:69]
    v_cvt_pk_bf16_f32 v96, v128, v129
    v_cvt_pk_bf16_f32 v97, v130, v131
    v_cvt_pk_bf16_f32 v98, v132, v133
    v_cvt_pk_bf16_f32 v99, v134, v135
    v_pk_mul_f32 v[136:137], v[136:137], s[68:69]
    v_pk_mul_f32 v[138:139], v[138:139], s[68:69]
    v_pk_mul_f32 v[140:141], v[140:141], s[68:69]
    v_pk_mul_f32 v[142:143], v[142:143], s[68:69]
    v_cvt_pk_bf16_f32 v100, v136, v137
    v_cvt_pk_bf16_f32 v101, v138, v139
    v_cvt_pk_bf16_f32 v102, v140, v141
    v_cvt_pk_bf16_f32 v103, v142, v143
    buffer_load_dwordx4 v3, s[36:39], s66 offen offset:1024 sc0 nt sc1 lds
    v_pk_mul_f32 v[144:145], v[144:145], s[68:69]
    v_pk_mul_f32 v[146:147], v[146:147], s[68:69]
    v_pk_mul_f32 v[148:149], v[148:149], s[68:69]
    v_pk_mul_f32 v[150:151], v[150:151], s[68:69]
    v_cvt_pk_bf16_f32 v104, v144, v145
    v_cvt_pk_bf16_f32 v105, v146, v147
    v_cvt_pk_bf16_f32 v106, v148, v149
    v_cvt_pk_bf16_f32 v107, v150, v151
    v_pk_mul_f32 v[152:153], v[152:153], s[68:69]
    v_pk_mul_f32 v[154:155], v[154:155], s[68:69]
    v_pk_mul_f32 v[156:157], v[156:157], s[68:69]
    v_pk_mul_f32 v[158:159], v[158:159], s[68:69]
    v_cvt_pk_bf16_f32 v108, v152, v153
    v_cvt_pk_bf16_f32 v109, v154, v155
    v_cvt_pk_bf16_f32 v110, v156, v157
    v_cvt_pk_bf16_f32 v111, v158, v159
    v_pk_mul_f32 v[160:161], v[160:161], s[68:69]
    v_pk_mul_f32 v[162:163], v[162:163], s[68:69]
    v_pk_mul_f32 v[164:165], v[164:165], s[68:69]
    v_pk_mul_f32 v[166:167], v[166:167], s[68:69]
    v_cvt_pk_bf16_f32 v112, v160, v161
    v_cvt_pk_bf16_f32 v113, v162, v163
    v_cvt_pk_bf16_f32 v114, v164, v165
    v_cvt_pk_bf16_f32 v115, v166, v167
    v_pk_mul_f32 v[168:169], v[168:169], s[68:69]
    v_pk_mul_f32 v[170:171], v[170:171], s[68:69]
    v_pk_mul_f32 v[172:173], v[172:173], s[68:69]
    v_pk_mul_f32 v[174:175], v[174:175], s[68:69]
    v_cvt_pk_bf16_f32 v116, v168, v169
    v_cvt_pk_bf16_f32 v117, v170, v171
    v_cvt_pk_bf16_f32 v118, v172, v173
    v_cvt_pk_bf16_f32 v119, v174, v175
    s_add_u32 m0, s65, 24576
    s_nop 0
    buffer_load_dwordx4 v3, s[40:43], s66 offen offset:0 sc0 nt sc1 lds
    v_pk_mul_f32 v[176:177], v[176:177], s[68:69]
    v_pk_mul_f32 v[178:179], v[178:179], s[68:69]
    v_pk_mul_f32 v[180:181], v[180:181], s[68:69]
    v_pk_mul_f32 v[182:183], v[182:183], s[68:69]
    v_cvt_pk_bf16_f32 v120, v176, v177
    v_cvt_pk_bf16_f32 v121, v178, v179
    v_cvt_pk_bf16_f32 v122, v180, v181
    v_cvt_pk_bf16_f32 v123, v182, v183
    v_pk_mul_f32 v[184:185], v[184:185], s[68:69]
    v_pk_mul_f32 v[186:187], v[186:187], s[68:69]
    v_pk_mul_f32 v[188:189], v[188:189], s[68:69]
    v_pk_mul_f32 v[190:191], v[190:191], s[68:69]
    v_cvt_pk_bf16_f32 v124, v184, v185
    v_cvt_pk_bf16_f32 v125, v186, v187
    v_cvt_pk_bf16_f32 v126, v188, v189
    v_cvt_pk_bf16_f32 v127, v190, v191
    v_pk_mul_f32 v[192:193], v[192:193], s[68:69]
    v_pk_mul_f32 v[194:195], v[194:195], s[68:69]
    v_pk_mul_f32 v[196:197], v[196:197], s[68:69]
    v_pk_mul_f32 v[198:199], v[198:199], s[68:69]
    v_cvt_pk_bf16_f32 v128, v192, v193
    v_cvt_pk_bf16_f32 v129, v194, v195
    v_cvt_pk_bf16_f32 v130, v196, v197
    v_cvt_pk_bf16_f32 v131, v198, v199
    v_pk_mul_f32 v[200:201], v[200:201], s[68:69]
    v_pk_mul_f32 v[202:203], v[202:203], s[68:69]
    v_pk_mul_f32 v[204:205], v[204:205], s[68:69]
    v_pk_mul_f32 v[206:207], v[206:207], s[68:69]
    v_cvt_pk_bf16_f32 v132, v200, v201
    v_cvt_pk_bf16_f32 v133, v202, v203
    v_cvt_pk_bf16_f32 v134, v204, v205
    v_cvt_pk_bf16_f32 v135, v206, v207
    buffer_load_dwordx4 v3, s[40:43], s66 offen offset:1024 sc0 nt sc1 lds
    v_pk_mul_f32 v[208:209], v[208:209], s[68:69]
    v_pk_mul_f32 v[210:211], v[210:211], s[68:69]
    v_pk_mul_f32 v[212:213], v[212:213], s[68:69]
    v_pk_mul_f32 v[214:215], v[214:215], s[68:69]
    v_cvt_pk_bf16_f32 v136, v208, v209
    v_cvt_pk_bf16_f32 v137, v210, v211
    v_cvt_pk_bf16_f32 v138, v212, v213
    v_cvt_pk_bf16_f32 v139, v214, v215
    v_pk_mul_f32 v[216:217], v[216:217], s[68:69]
    v_pk_mul_f32 v[218:219], v[218:219], s[68:69]
    v_pk_mul_f32 v[220:221], v[220:221], s[68:69]
    v_pk_mul_f32 v[222:223], v[222:223], s[68:69]
    v_cvt_pk_bf16_f32 v140, v216, v217
    v_cvt_pk_bf16_f32 v141, v218, v219
    v_cvt_pk_bf16_f32 v142, v220, v221
    v_cvt_pk_bf16_f32 v143, v222, v223
    v_pk_mul_f32 v[224:225], v[224:225], s[68:69]
    v_pk_mul_f32 v[226:227], v[226:227], s[68:69]
    v_pk_mul_f32 v[228:229], v[228:229], s[68:69]
    v_pk_mul_f32 v[230:231], v[230:231], s[68:69]
    v_cvt_pk_bf16_f32 v144, v224, v225
    v_cvt_pk_bf16_f32 v145, v226, v227
    v_cvt_pk_bf16_f32 v146, v228, v229
    v_cvt_pk_bf16_f32 v147, v230, v231
    v_pk_mul_f32 v[232:233], v[232:233], s[68:69]
    v_pk_mul_f32 v[234:235], v[234:235], s[68:69]
    v_pk_mul_f32 v[236:237], v[236:237], s[68:69]
    v_pk_mul_f32 v[238:239], v[238:239], s[68:69]
    v_cvt_pk_bf16_f32 v148, v232, v233
    v_cvt_pk_bf16_f32 v149, v234, v235
    v_cvt_pk_bf16_f32 v150, v236, v237
    v_cvt_pk_bf16_f32 v151, v238, v239
    s_add_u32 s66, s66, 8192
    s_add_u32 s65, s65, 32768
    s_cmp_ge_u32 s65, 163840
    s_cselect_b32 s56, 98304, 0
    s_sub_u32 s65, s65, s56
    v_pk_mul_f32 v[240:241], v[240:241], s[68:69]
    v_pk_mul_f32 v[242:243], v[242:243], s[68:69]
    v_pk_mul_f32 v[244:245], v[244:245], s[68:69]
    v_pk_mul_f32 v[246:247], v[246:247], s[68:69]
    v_cvt_pk_bf16_f32 v152, v240, v241
    v_cvt_pk_bf16_f32 v153, v242, v243
    v_cvt_pk_bf16_f32 v154, v244, v245
    v_cvt_pk_bf16_f32 v155, v246, v247
    v_pk_mul_f32 v[248:249], v[248:249], s[68:69]
    v_pk_mul_f32 v[250:251], v[250:251], s[68:69]
    v_pk_mul_f32 v[252:253], v[252:253], s[68:69]
    v_pk_mul_f32 v[254:255], v[254:255], s[68:69]
    v_cvt_pk_bf16_f32 v156, v248, v249
    v_cvt_pk_bf16_f32 v157, v250, v251
    v_cvt_pk_bf16_f32 v158, v252, v253
    v_cvt_pk_bf16_f32 v159, v254, v255
    s_waitcnt lgkmcnt(0)
    v_mfma_f32_16x16x32_bf16 v[184:187], a[192:195], v[64:67], 0
    v_add_u32 v7, 98304, v11
    v_add_u32 v8, 98304, v12
    v_mfma_f32_16x16x32_bf16 v[184:187], a[196:199], v[68:71], v[184:187]
    v_xor_b32 v9, 32, v8
    v_accvgpr_read_b32 v251, a8
    v_mfma_f32_16x16x32_bf16 v[184:187], a[200:203], v[72:75], v[184:187]
    v_accvgpr_read_b32 v2, a1
    v_mov_b32 v238, 0
    v_mfma_f32_16x16x32_bf16 v[184:187], a[204:207], v[76:79], v[184:187]
    v_mov_b32 v239, 0
    v_mov_b32 v240, 0
    v_mfma_f32_16x16x32_bf16 v[188:191], a[192:195], v[80:83], 0
    v_mov_b32 v241, 0
    v_mov_b32 v242, 0
    v_mfma_f32_16x16x32_bf16 v[188:191], a[196:199], v[84:87], v[188:191]
    v_mov_b32 v243, 0
    v_mfma_f32_16x16x32_bf16 v[188:191], a[200:203], v[88:91], v[188:191]
    v_mfma_f32_16x16x32_bf16 v[188:191], a[204:207], v[92:95], v[188:191]
    v_mfma_f32_16x16x32_bf16 v[192:195], a[192:195], v[96:99], 0
    v_mfma_f32_16x16x32_bf16 v[192:195], a[196:199], v[100:103], v[192:195]
    v_mfma_f32_16x16x32_bf16 v[192:195], a[200:203], v[104:107], v[192:195]
    v_mfma_f32_16x16x32_bf16 v[192:195], a[204:207], v[108:111], v[192:195]
    v_mfma_f32_16x16x32_bf16 v[196:199], a[192:195], v[112:115], 0
    v_mfma_f32_16x16x32_bf16 v[196:199], a[196:199], v[116:119], v[196:199]
    v_mfma_f32_16x16x32_bf16 v[196:199], a[200:203], v[120:123], v[196:199]
    v_mfma_f32_16x16x32_bf16 v[196:199], a[204:207], v[124:127], v[196:199]
    v_max3_f32 v160, v184, v185, v186
    v_max3_f32 v164, v188, v189, v190
    v_mfma_f32_16x16x32_bf16 v[200:203], a[192:195], v[128:131], 0
    s_nop 0
    v_max3_f32 v168, v192, v193, v194
    v_max_f32 v160, v160, v187
    v_mfma_f32_16x16x32_bf16 v[200:203], a[196:199], v[132:135], v[200:203]
    v_max_f32 v164, v164, v191
    v_max_f32 v168, v168, v195
    v_mfma_f32_16x16x32_bf16 v[200:203], a[200:203], v[136:139], v[200:203]
    v_mov_b32 v161, v160
    v_mov_b32 v165, v164
    v_mfma_f32_16x16x32_bf16 v[200:203], a[204:207], v[140:143], v[200:203]
    v_mov_b32 v169, v168
    v_permlane16_swap_b32 v160, v161
    v_mfma_f32_16x16x32_bf16 v[204:207], a[192:195], v[144:147], 0
    v_permlane16_swap_b32 v164, v165
    v_permlane16_swap_b32 v168, v169
    v_mfma_f32_16x16x32_bf16 v[204:207], a[196:199], v[148:151], v[204:207]
    v_max_f32 v160, v160, v161
    v_max_f32 v164, v164, v165
    v_mfma_f32_16x16x32_bf16 v[204:207], a[200:203], v[152:155], v[204:207]
    v_max_f32 v168, v168, v169
    v_mov_b32 v161, v160
    v_mfma_f32_16x16x32_bf16 v[204:207], a[204:207], v[156:159], v[204:207]
    v_mov_b32 v165, v164
    v_mov_b32 v169, v168
    v_mfma_f32_32x32x16_bf16 a[0:15], v[16:19], v[16:19], 0
    v_permlane32_swap_b32 v160, v161
    v_permlane32_swap_b32 v164, v165
    v_permlane32_swap_b32 v168, v169
    v_max_f32 v160, v160, v161
    v_max_f32 v164, v164, v165
    v_max_f32 v168, v168, v169
    v_mfma_f32_32x32x16_bf16 a[16:31], v[16:19], v[16:19], 0
    v_sub_f32 v184, v184, v160
    v_sub_f32 v188, v188, v164
    v_sub_f32 v192, v192, v168
    v_sub_f32 v185, v185, v160
    v_sub_f32 v189, v189, v164
    v_sub_f32 v193, v193, v168
    v_sub_f32 v186, v186, v160
    v_sub_f32 v190, v190, v164
    v_sub_f32 v194, v194, v168
    v_sub_f32 v187, v187, v160
    v_sub_f32 v191, v191, v164
    v_sub_f32 v195, v195, v168
    v_sub_f32 v163, 0, v160
    v_sub_f32 v167, 0, v164
    v_sub_f32 v171, 0, v168
    v_sub_f32 v162, 0, v160
    v_sub_f32 v166, 0, v164
    v_sub_f32 v170, 0, v168
    v_sub_f32 v161, 0, v160
    v_sub_f32 v165, 0, v164
    v_sub_f32 v169, 0, v168
    v_sub_f32 v160, 0, v160
    v_sub_f32 v164, 0, v164
    v_sub_f32 v168, 0, v168
    v_max3_f32 v172, v196, v197, v198
    v_max3_f32 v176, v200, v201, v202
    v_max3_f32 v180, v204, v205, v206
    v_max_f32 v172, v172, v199
    v_max_f32 v176, v176, v203
    v_max_f32 v180, v180, v207
    v_mov_b32 v173, v172
    v_mov_b32 v177, v176
    v_mov_b32 v181, v180
    v_permlane16_swap_b32 v172, v173
    v_permlane16_swap_b32 v176, v177
    v_permlane16_swap_b32 v180, v181
    v_max_f32 v172, v172, v173
    v_max_f32 v176, v176, v177
    v_max_f32 v180, v180, v181
    v_mov_b32 v173, v172
    v_mov_b32 v177, v176
    v_mov_b32 v181, v180
    v_permlane32_swap_b32 v172, v173
    v_permlane32_swap_b32 v176, v177
    v_permlane32_swap_b32 v180, v181
    v_max_f32 v172, v172, v173
    v_max_f32 v176, v176, v177
    v_max_f32 v180, v180, v181
    v_sub_f32 v196, v196, v172
    v_sub_f32 v200, v200, v176
    v_sub_f32 v204, v204, v180
    v_sub_f32 v197, v197, v172
    v_sub_f32 v201, v201, v176
    v_sub_f32 v205, v205, v180
    v_sub_f32 v198, v198, v172
    v_sub_f32 v202, v202, v176
    v_sub_f32 v206, v206, v180
    v_sub_f32 v199, v199, v172
    v_sub_f32 v203, v203, v176
    v_sub_f32 v207, v207, v180
    v_sub_f32 v175, 0, v172
    v_sub_f32 v179, 0, v176
    v_sub_f32 v183, 0, v180
    v_sub_f32 v174, 0, v172
    v_sub_f32 v178, 0, v176
    v_sub_f32 v182, 0, v180
    v_sub_f32 v173, 0, v172
    v_sub_f32 v177, 0, v176
    v_sub_f32 v181, 0, v180
    v_sub_f32 v172, 0, v172
    v_sub_f32 v176, 0, v176
    v_sub_f32 v180, 0, v180
    v_exp_f32 v244, v184
    v_exp_f32 v245, v185
    v_add_f32 v232, v238, v244
    v_add_f32 v232, v232, v245
    v_exp_f32 v246, v186
    v_cvt_pk_bf16_f32 v16, v244, v245
    v_exp_f32 v247, v187
    v_add_f32 v232, v232, v246
    v_add_f32 v232, v232, v247
    v_exp_f32 v244, v188
    v_cvt_pk_bf16_f32 v17, v246, v247
    v_exp_f32 v245, v189
    v_add_f32 v233, v239, v244
    v_add_f32 v233, v233, v245
    v_exp_f32 v246, v190
    v_cvt_pk_bf16_f32 v20, v244, v245
    v_exp_f32 v247, v191
    v_add_f32 v233, v233, v246
    v_add_f32 v233, v233, v247
    v_exp_f32 v244, v192
    v_cvt_pk_bf16_f32 v21, v246, v247
    v_exp_f32 v245, v193
    v_add_f32 v234, v240, v244
    v_add_f32 v234, v234, v245
    v_exp_f32 v246, v194
    v_cvt_pk_bf16_f32 v24, v244, v245
    v_exp_f32 v247, v195
    v_add_f32 v234, v234, v246
    v_add_f32 v234, v234, v247
    v_exp_f32 v244, v196
    v_cvt_pk_bf16_f32 v25, v246, v247
    v_exp_f32 v245, v197
    v_add_f32 v235, v241, v244
    v_add_f32 v235, v235, v245
    v_exp_f32 v246, v198
    v_cvt_pk_bf16_f32 v28, v244, v245
    v_exp_f32 v247, v199
    v_add_f32 v235, v235, v246
    v_add_f32 v235, v235, v247
    v_exp_f32 v244, v200
    v_cvt_pk_bf16_f32 v29, v246, v247
    v_exp_f32 v245, v201
    v_add_f32 v236, v242, v244
    v_add_f32 v236, v236, v245
    v_exp_f32 v246, v202
    v_cvt_pk_bf16_f32 v32, v244, v245
    v_exp_f32 v247, v203
    v_add_f32 v236, v236, v246
    v_add_f32 v236, v236, v247
    v_mfma_f32_16x16x32_bf16 v[208:211], a[208:211], v[64:67], v[160:163]
    s_waitcnt vmcnt(8) lgkmcnt(0)
    s_barrier
    v_exp_f32 v244, v204
    v_mfma_f32_16x16x32_bf16 v[208:211], a[212:215], v[68:71], v[208:211]
    ds_read_b128 a[192:195], v7 offset:0
    v_cvt_pk_bf16_f32 v33, v246, v247
    v_mfma_f32_16x16x32_bf16 v[208:211], a[216:219], v[72:75], v[208:211]
    s_add_u32 m0, s65, 0
    v_exp_f32 v245, v205
    v_mfma_f32_16x16x32_bf16 v[208:211], a[220:223], v[76:79], v[208:211]
    buffer_load_dwordx4 v3, s[28:31], s66 offen offset:0 sc0 nt sc1 lds
    v_add_f32 v237, v243, v244
    v_add_f32 v237, v237, v245
    v_exp_f32 v246, v206
    ds_read_b128 a[196:199], v7 offset:256
    v_cvt_pk_bf16_f32 v36, v244, v245
    v_exp_f32 v247, v207
    buffer_load_dwordx4 v3, s[28:31], s66 offen offset:1024 sc0 nt sc1 lds
    v_add_f32 v237, v237, v246
    v_add_f32 v237, v237, v247
    v_mfma_f32_16x16x32_bf16 v[212:215], a[208:211], v[80:83], v[164:167]
    v_exp_f32 v244, v208
    v_mfma_f32_16x16x32_bf16 v[212:215], a[212:215], v[84:87], v[212:215]
    ds_read_b128 a[200:203], v7 offset:512
    v_cvt_pk_bf16_f32 v37, v246, v247
    v_mfma_f32_16x16x32_bf16 v[212:215], a[216:219], v[88:91], v[212:215]
    s_add_u32 m0, s65, 8192
    v_exp_f32 v245, v209
    v_mfma_f32_16x16x32_bf16 v[212:215], a[220:223], v[92:95], v[212:215]
    buffer_load_dwordx4 v3, s[32:35], s66 offen offset:0 sc0 nt sc1 lds
    v_add_f32 v232, v232, v244
    v_add_f32 v232, v232, v245
    v_exp_f32 v246, v210
    ds_read_b128 a[204:207], v7 offset:768
    v_cvt_pk_bf16_f32 v18, v244, v245
    v_exp_f32 v247, v211
    buffer_load_dwordx4 v3, s[32:35], s66 offen offset:1024 sc0 nt sc1 lds
    v_add_f32 v232, v232, v246
    v_add_f32 v232, v232, v247
    v_mfma_f32_16x16x32_bf16 v[216:219], a[208:211], v[96:99], v[168:171]
    v_exp_f32 v244, v212
    v_mfma_f32_16x16x32_bf16 v[216:219], a[212:215], v[100:103], v[216:219]
    ds_read_b64_tr_b16 a[224:225], v8 offset:8192
    v_cvt_pk_bf16_f32 v19, v246, v247
    v_mfma_f32_16x16x32_bf16 v[216:219], a[216:219], v[104:107], v[216:219]
    s_add_u32 m0, s65, 16384
    v_exp_f32 v245, v213
    v_mfma_f32_16x16x32_bf16 v[216:219], a[220:223], v[108:111], v[216:219]
    buffer_load_dwordx4 v3, s[36:39], s66 offen offset:0 sc0 nt sc1 lds
    v_add_f32 v233, v233, v244
    v_add_f32 v233, v233, v245
    v_exp_f32 v246, v214
    ds_read_b64_tr_b16 a[226:227], v8 offset:12288
    v_cvt_pk_bf16_f32 v22, v244, v245
    v_exp_f32 v247, v215
    buffer_load_dwordx4 v3, s[36:39], s66 offen offset:1024 sc0 nt sc1 lds
    v_add_f32 v233, v233, v246
    v_add_f32 v233, v233, v247
    v_mfma_f32_16x16x32_bf16 v[220:223], a[208:211], v[112:115], v[172:175]
    v_exp_f32 v244, v216
    v_mfma_f32_16x16x32_bf16 v[220:223], a[212:215], v[116:119], v[220:223]
    ds_read_b64_tr_b16 a[228:229], v9 offset:8192
    v_cvt_pk_bf16_f32 v23, v246, v247
    v_mfma_f32_16x16x32_bf16 v[220:223], a[216:219], v[120:123], v[220:223]
    s_add_u32 m0, s65, 24576
    v_exp_f32 v245, v217
    v_mfma_f32_16x16x32_bf16 v[220:223], a[220:223], v[124:127], v[220:223]
    buffer_load_dwordx4 v3, s[40:43], s66 offen offset:0 sc0 nt sc1 lds
    v_add_f32 v234, v234, v244
    v_add_f32 v234, v234, v245
    v_exp_f32 v246, v218
    ds_read_b64_tr_b16 a[230:231], v9 offset:12288
    v_cvt_pk_bf16_f32 v26, v244, v245
    v_exp_f32 v247, v219
    buffer_load_dwordx4 v3, s[40:43], s66 offen offset:1024 sc0 nt sc1 lds
    v_add_f32 v234, v234, v246
    v_add_f32 v234, v234, v247
    v_mfma_f32_16x16x32_bf16 v[224:227], a[208:211], v[128:131], v[176:179]
    v_exp_f32 v244, v220
    v_mfma_f32_16x16x32_bf16 v[224:227], a[212:215], v[132:135], v[224:227]
    ds_read_b64_tr_b16 a[232:233], v8 offset:8448
    v_cvt_pk_bf16_f32 v27, v246, v247
    v_mfma_f32_16x16x32_bf16 v[224:227], a[216:219], v[136:139], v[224:227]
    v_exp_f32 v245, v221
    v_max3_f32 v248, v232, v233, v234
    v_mfma_f32_16x16x32_bf16 v[224:227], a[220:223], v[140:143], v[224:227]
    v_add_f32 v235, v235, v244
    v_add_f32 v235, v235, v245
    v_exp_f32 v246, v222
    v_cmp_lt_f32 vcc, s67, v248
    ds_read_b64_tr_b16 a[234:235], v8 offset:12544
    v_cvt_pk_bf16_f32 v30, v244, v245
    s_mov_b32 s58, s78
    s_lshl_b32 s58, s58, 3
    s_add_u32 s58, s58, s52
    s_add_u32 s58, s58, 0
    s_mul_i32 s58, s58, 36864
    s_add_u32 m0, s59, 0
    v_exp_f32 v247, v223
    s_cbranch_vccnz L_stub0
L_back0:
    buffer_load_dwordx4 v1, s[72:75], s58 offen sc1 lds
    v_add_f32 v235, v235, v246
    v_add_f32 v235, v235, v247
    v_mfma_f32_16x16x32_bf16 v[228:231], a[208:211], v[144:147], v[180:183]
    v_exp_f32 v244, v224
    v_mfma_f32_16x16x32_bf16 v[228:231], a[212:215], v[148:151], v[228:231]
    ds_read_b64_tr_b16 a[236:237], v9 offset:8448
    v_cvt_pk_bf16_f32 v31, v246, v247
    v_mfma_f32_16x16x32_bf16 v[228:231], a[216:219], v[152:155], v[228:231]
    s_add_u32 m0, s59, 1024
    v_exp_f32 v245, v225
    v_mfma_f32_16x16x32_bf16 v[228:231], a[220:223], v[156:159], v[228:231]
    buffer_load_dwordx4 v2, s[72:75], s58 offen sc1 lds
    v_add_f32 v236, v236, v244
    v_add_f32 v236, v236, v245
    v_exp_f32 v246, v226
    ds_read_b64_tr_b16 a[238:239], v9 offset:12544
    v_cvt_pk_bf16_f32 v34, v244, v245
    s_add_u32 m0, s59, 2048
    v_exp_f32 v247, v227
    s_waitcnt lgkmcnt(0)
    buffer_load_dwordx4 v4, s[72:75], s58 offen sc1 lds
    v_add_f32 v236, v236, v246
    v_add_f32 v236, v236, v247
    v_mfma_f32_16x16x32_bf16 v[184:187], a[192:195], v[64:67], v[160:163]
    v_exp_f32 v244, v228
    v_mfma_f32_16x16x32_bf16 v[184:187], a[196:199], v[68:71], v[184:187]
    ds_read_b128 a[208:211], v7 offset:4096
    v_cvt_pk_bf16_f32 v35, v246, v247
    v_mfma_f32_16x16x32_bf16 v[184:187], a[200:203], v[72:75], v[184:187]
    s_add_u32 m0, s59, 3072
    v_exp_f32 v245, v229
    v_mfma_f32_16x16x32_bf16 v[184:187], a[204:207], v[76:79], v[184:187]
    buffer_load_dwordx4 v5, s[72:75], s58 offen sc1 lds
    v_add_f32 v237, v237, v244
    v_add_f32 v237, v237, v245
    v_mfma_f32_16x16x32_bf16 a[0:3], a[224:227], v[16:19], a[0:3]
    v_exp_f32 v246, v230
    v_mfma_f32_16x16x32_bf16 a[4:7], a[228:231], v[16:19], a[4:7]
    ds_read_b128 a[212:215], v7 offset:4352
    v_cvt_pk_bf16_f32 v38, v244, v245
    v_mfma_f32_16x16x32_bf16 a[8:11], a[232:235], v[16:19], a[8:11]
    s_add_u32 m0, s59, 4096
    v_exp_f32 v247, v231
    v_mfma_f32_16x16x32_bf16 a[12:15], a[236:239], v[16:19], a[12:15]
    buffer_load_dwordx4 v6, s[72:75], s58 offen sc1 lds
    v_add_f32 v237, v237, v246
    v_add_f32 v237, v237, v247
    v_mfma_f32_16x16x32_bf16 v[188:191], a[192:195], v[80:83], v[164:167]
    v_exp_f32 v244, v184
    v_mfma_f32_16x16x32_bf16 v[188:191], a[196:199], v[84:87], v[188:191]
    ds_read_b128 a[216:219], v7 offset:4608
    v_cvt_pk_bf16_f32 v39, v246, v247
    v_mfma_f32_16x16x32_bf16 v[188:191], a[200:203], v[88:91], v[188:191]
    s_add_u32 m0, s59, 5120
    v_exp_f32 v245, v185
    v_max3_f32 v248, v235, v236, v237
    v_mfma_f32_16x16x32_bf16 v[188:191], a[204:207], v[92:95], v[188:191]
    buffer_load_dwordx4 v13, s[72:75], s58 offen sc1 lds
    v_add_f32 v238, v232, v244
    v_add_f32 v238, v238, v245
    v_mfma_f32_16x16x32_bf16 a[32:35], a[224:227], v[20:23], a[32:35]
    v_exp_f32 v246, v186
    v_cmp_lt_f32 vcc, s67, v248
    v_mfma_f32_16x16x32_bf16 a[36:39], a[228:231], v[20:23], a[36:39]
    ds_read_b128 a[220:223], v7 offset:4864
    v_cvt_pk_bf16_f32 v40, v244, v245
    v_mfma_f32_16x16x32_bf16 a[40:43], a[232:235], v[20:23], a[40:43]
    s_add_u32 m0, s59, 6144
    v_exp_f32 v247, v187
    v_mfma_f32_16x16x32_bf16 a[44:47], a[236:239], v[20:23], a[44:47]
    s_cbranch_vccnz L_stub1
L_back1:
    buffer_load_dwordx4 v14, s[72:75], s58 offen sc1 lds
    v_add_f32 v238, v238, v246
    v_add_f32 v238, v238, v247
    v_mfma_f32_16x16x32_bf16 v[192:195], a[192:195], v[96:99], v[168:171]
    v_exp_f32 v244, v188
    v_mfma_f32_16x16x32_bf16 v[192:195], a[196:199], v[100:103], v[192:195]
    ds_read_b64_tr_b16 a[240:241], v8 offset:8704
    v_cvt_pk_bf16_f32 v41, v246, v247
    v_mfma_f32_16x16x32_bf16 v[192:195], a[200:203], v[104:107], v[192:195]
    s_add_u32 m0, s59, 7168
    v_exp_f32 v245, v189
    v_mfma_f32_16x16x32_bf16 v[192:195], a[204:207], v[108:111], v[192:195]
    buffer_load_dwordx4 v15, s[72:75], s58 offen sc1 lds
    v_add_f32 v239, v233, v244
    v_add_f32 v239, v239, v245
    v_mfma_f32_16x16x32_bf16 a[64:67], a[224:227], v[24:27], a[64:67]
    v_exp_f32 v246, v190
    v_mfma_f32_16x16x32_bf16 a[68:71], a[228:231], v[24:27], a[68:71]
    ds_read_b64_tr_b16 a[242:243], v8 offset:12800
    v_cvt_pk_bf16_f32 v44, v244, v245
    v_mfma_f32_16x16x32_bf16 a[72:75], a[232:235], v[24:27], a[72:75]
    s_add_u32 m0, s59, 8192
    v_exp_f32 v247, v191
    v_mfma_f32_16x16x32_bf16 a[76:79], a[236:239], v[24:27], a[76:79]
    buffer_load_dwordx4 v251, s[72:75], s58 offen sc1 lds
    v_add_f32 v239, v239, v246
    v_add_f32 v239, v239, v247
    v_mfma_f32_16x16x32_bf16 v[196:199], a[192:195], v[112:115], v[172:175]
    v_exp_f32 v244, v192
    v_mfma_f32_16x16x32_bf16 v[196:199], a[196:199], v[116:119], v[196:199]
    ds_read_b64_tr_b16 a[244:245], v9 offset:8704
    v_cvt_pk_bf16_f32 v45, v246, v247
    v_mfma_f32_16x16x32_bf16 v[196:199], a[200:203], v[120:123], v[196:199]
    v_exp_f32 v245, v193
    v_mfma_f32_16x16x32_bf16 v[196:199], a[204:207], v[124:127], v[196:199]
    v_add_f32 v240, v234, v244
    v_add_f32 v240, v240, v245
    v_mfma_f32_16x16x32_bf16 a[96:99], a[224:227], v[28:31], a[96:99]
    v_exp_f32 v246, v194
    v_mfma_f32_16x16x32_bf16 a[100:103], a[228:231], v[28:31], a[100:103]
    s_add_u32 s65, s65, 32768
    ds_read_b64_tr_b16 a[246:247], v9 offset:12800
    v_cvt_pk_bf16_f32 v48, v244, v245
    v_mfma_f32_16x16x32_bf16 a[104:107], a[232:235], v[28:31], a[104:107]
    s_cmp_ge_u32 s65, 163840
    v_exp_f32 v247, v195
    v_mfma_f32_16x16x32_bf16 a[108:111], a[236:239], v[28:31], a[108:111]
    s_cselect_b32 s56, 98304, 0
    v_add_f32 v240, v240, v246
    v_add_f32 v240, v240, v247
    v_mfma_f32_16x16x32_bf16 v[200:203], a[192:195], v[128:131], v[176:179]
    s_sub_u32 s65, s65, s56
    v_exp_f32 v244, v196
    v_mfma_f32_16x16x32_bf16 v[200:203], a[196:199], v[132:135], v[200:203]
    ds_read_b64_tr_b16 a[248:249], v8 offset:8960
    v_cvt_pk_bf16_f32 v49, v246, v247
    v_mfma_f32_16x16x32_bf16 v[200:203], a[200:203], v[136:139], v[200:203]
    v_exp_f32 v245, v197
    v_mfma_f32_16x16x32_bf16 v[200:203], a[204:207], v[140:143], v[200:203]
    v_add_f32 v241, v235, v244
    v_add_f32 v241, v241, v245
    v_mfma_f32_16x16x32_bf16 a[128:131], a[224:227], v[32:35], a[128:131]
    v_exp_f32 v246, v198
    v_mfma_f32_16x16x32_bf16 a[132:135], a[228:231], v[32:35], a[132:135]
    ds_read_b64_tr_b16 a[250:251], v8 offset:13056
    v_cvt_pk_bf16_f32 v52, v244, v245
    v_mfma_f32_16x16x32_bf16 a[136:139], a[232:235], v[32:35], a[136:139]
    s_add_u32 s64, s64, 32768
    v_exp_f32 v247, v199
    v_mfma_f32_16x16x32_bf16 a[140:143], a[236:239], v[32:35], a[140:143]
    s_cmp_ge_u32 s64, 163840
    v_add_f32 v241, v241, v246
    v_add_f32 v241, v241, v247
    v_mfma_f32_16x16x32_bf16 v[204:207], a[192:195], v[144:147], v[180:183]
    s_cselect_b32 s81, 98304, 0
    v_exp_f32 v244, v200
    v_mfma_f32_16x16x32_bf16 v[204:207], a[196:199], v[148:151], v[204:207]
    s_sub_u32 s64, s64, s81
    ds_read_b64_tr_b16 a[252:253], v9 offset:8960
    v_cvt_pk_bf16_f32 v53, v246, v247
    v_mfma_f32_16x16x32_bf16 v[204:207], a[200:203], v[152:155], v[204:207]
    v_exp_f32 v245, v201
    v_mfma_f32_16x16x32_bf16 v[204:207], a[204:207], v[156:159], v[204:207]
    s_add_u32 s66, s66, 8192
    v_add_f32 v242, v236, v244
    v_add_f32 v242, v242, v245
    v_mfma_f32_16x16x32_bf16 a[160:163], a[224:227], v[36:39], a[160:163]
    v_exp_f32 v246, v202
    v_mfma_f32_16x16x32_bf16 a[164:167], a[228:231], v[36:39], a[164:167]
    ds_read_b64_tr_b16 a[254:255], v9 offset:13056
    v_cvt_pk_bf16_f32 v56, v244, v245
    v_add_u32 v7, s64, v11
    v_mfma_f32_16x16x32_bf16 a[168:171], a[232:235], v[36:39], a[168:171]
    v_exp_f32 v247, v203
    v_add_u32 v8, s64, v12
    v_mfma_f32_16x16x32_bf16 a[172:175], a[236:239], v[36:39], a[172:175]
    s_waitcnt lgkmcnt(8)
    v_add_f32 v242, v242, v246
    v_add_f32 v242, v242, v247
    v_xor_b32 v9, 32, v8
    s_mov_b32 s57, 15
.p2align 6
L_aloop:
    v_mfma_f32_16x16x32_bf16 v[208:211], a[208:211], v[64:67], v[160:163]
    s_waitcnt vmcnt(8) lgkmcnt(0)
    s_barrier
    v_exp_f32 v244, v204
    v_mfma_f32_16x16x32_bf16 v[208:211], a[212:215], v[68:71], v[208:211]
    s_cmp_eq_u32 s57, s80
    s_cbranch_scc1 L_sigw
L_sigw_back:
    ds_read_b128 a[192:195], v7 offset:0
    v_cvt_pk_bf16_f32 v57, v246, v247
    v_mfma_f32_16x16x32_bf16 v[208:211], a[216:219], v[72:75], v[208:211]
    s_add_u32 m0, s65, 0
    v_exp_f32 v245, v205
    v_mfma_f32_16x16x32_bf16 v[208:211], a[220:223], v[76:79], v[208:211]
    s_waitcnt vmcnt(3)
    buffer_load_dwordx4 v3, s[28:31], s66 offen offset:0 sc0 nt sc1 lds
    v_add_f32 v243, v237, v244
    v_add_f32 v243, v243, v245
    v_mfma_f32_16x16x32_bf16 a[16:19], a[240:243], v[16:19], a[16:19]
    s_cmp_eq_u32 s57, s3
    s_cbranch_scc1 L_ldw
L_ldw_back:
    v_exp_f32 v246, v206
    v_mfma_f32_16x16x32_bf16 a[20:23], a[244:247], v[16:19], a[20:23]
    ds_read_b128 a[196:199], v7 offset:256
    v_cvt_pk_bf16_f32 v60, v244, v245
    v_mfma_f32_16x16x32_bf16 a[24:27], a[248:251], v[16:19], a[24:27]
    v_exp_f32 v247, v207
    v_mfma_f32_16x16x32_bf16 a[28:31], a[252:255], v[16:19], a[28:31]
    v_add_f32 v243, v243, v246
    v_add_f32 v243, v243, v247
    v_mfma_f32_16x16x32_bf16 v[212:215], a[208:211], v[80:83], v[164:167]
    s_cmp_eq_u32 s57, 2
    s_cbranch_scc1 L_ctt
L_ctt_back:
    v_exp_f32 v244, v208
    v_mfma_f32_16x16x32_bf16 v[212:215], a[212:215], v[84:87], v[212:215]
    ds_read_b128 a[200:203], v7 offset:512
    v_cvt_pk_bf16_f32 v61, v246, v247
    v_mfma_f32_16x16x32_bf16 v[212:215], a[216:219], v[88:91], v[212:215]
    v_exp_f32 v245, v209
    v_mfma_f32_16x16x32_bf16 v[212:215], a[220:223], v[92:95], v[212:215]
    v_add_f32 v238, v238, v244
    v_add_f32 v238, v238, v245
    v_mfma_f32_16x16x32_bf16 a[48:51], a[240:243], v[20:23], a[48:51]
    v_exp_f32 v246, v210
    v_mfma_f32_16x16x32_bf16 a[52:55], a[244:247], v[20:23], a[52:55]
    ds_read_b128 a[204:207], v7 offset:768
    v_cvt_pk_bf16_f32 v42, v244, v245
    v_mfma_f32_16x16x32_bf16 a[56:59], a[248:251], v[20:23], a[56:59]
    v_exp_f32 v247, v211
    v_mfma_f32_16x16x32_bf16 a[60:63], a[252:255], v[20:23], a[60:63]
    s_waitcnt vmcnt(4)
    buffer_load_dwordx4 v3, s[28:31], s66 offen offset:1024 sc0 nt sc1 lds
    v_add_f32 v238, v238, v246
    v_add_f32 v238, v238, v247
    v_mfma_f32_16x16x32_bf16 v[216:219], a[208:211], v[96:99], v[168:171]
    v_exp_f32 v244, v212
    v_mfma_f32_16x16x32_bf16 v[216:219], a[212:215], v[100:103], v[216:219]
    ds_read_b64_tr_b16 a[224:225], v8 offset:8192
    v_cvt_pk_bf16_f32 v43, v246, v247
    v_mfma_f32_16x16x32_bf16 v[216:219], a[216:219], v[104:107], v[216:219]
    v_exp_f32 v245, v213
    v_mfma_f32_16x16x32_bf16 v[216:219], a[220:223], v[108:111], v[216:219]
    v_add_f32 v239, v239, v244
    v_add_f32 v239, v239, v245
    v_mfma_f32_16x16x32_bf16 a[80:83], a[240:243], v[24:27], a[80:83]
    v_exp_f32 v246, v214
    v_mfma_f32_16x16x32_bf16 a[84:87], a[244:247], v[24:27], a[84:87]
    ds_read_b64_tr_b16 a[226:227], v8 offset:12288
    v_cvt_pk_bf16_f32 v46, v244, v245
    v_mfma_f32_16x16x32_bf16 a[88:91], a[248:251], v[24:27], a[88:91]
    v_exp_f32 v247, v215
    v_mfma_f32_16x16x32_bf16 a[92:95], a[252:255], v[24:27], a[92:95]
    v_add_f32 v239, v239, v246
    v_add_f32 v239, v239, v247
    v_mfma_f32_16x16x32_bf16 v[220:223], a[208:211], v[112:115], v[172:175]
    v_exp_f32 v244, v216
    v_mfma_f32_16x16x32_bf16 v[220:223], a[212:215], v[116:119], v[220:223]
    ds_read_b64_tr_b16 a[228:229], v9 offset:8192
    v_cvt_pk_bf16_f32 v47, v246, v247
    v_mfma_f32_16x16x32_bf16 v[220:223], a[216:219], v[120:123], v[220:223]
    s_add_u32 m0, s65, 8192
    v_exp_f32 v245, v217
    v_mfma_f32_16x16x32_bf16 v[220:223], a[220:223], v[124:127], v[220:223]
    s_waitcnt vmcnt(3)
    buffer_load_dwordx4 v3, s[32:35], s66 offen offset:0 sc0 nt sc1 lds
    v_add_f32 v240, v240, v244
    v_add_f32 v240, v240, v245
    v_mfma_f32_16x16x32_bf16 a[112:115], a[240:243], v[28:31], a[112:115]
    v_exp_f32 v246, v218
    v_mfma_f32_16x16x32_bf16 a[116:119], a[244:247], v[28:31], a[116:119]
    ds_read_b64_tr_b16 a[230:231], v9 offset:12288
    v_cvt_pk_bf16_f32 v50, v244, v245
    v_mfma_f32_16x16x32_bf16 a[120:123], a[248:251], v[28:31], a[120:123]
    v_exp_f32 v247, v219
    v_mfma_f32_16x16x32_bf16 a[124:127], a[252:255], v[28:31], a[124:127]
    v_add_f32 v240, v240, v246
    v_add_f32 v240, v240, v247
    v_mfma_f32_16x16x32_bf16 v[224:227], a[208:211], v[128:131], v[176:179]
    v_exp_f32 v244, v220
    v_mfma_f32_16x16x32_bf16 v[224:227], a[212:215], v[132:135], v[224:227]
    ds_read_b64_tr_b16 a[232:233], v8 offset:8448
    v_cvt_pk_bf16_f32 v51, v246, v247
    v_mfma_f32_16x16x32_bf16 v[224:227], a[216:219], v[136:139], v[224:227]
    v_exp_f32 v245, v221
    v_max3_f32 v248, v238, v239, v240
    v_mfma_f32_16x16x32_bf16 v[224:227], a[220:223], v[140:143], v[224:227]
    v_add_f32 v241, v241, v244
    v_add_f32 v241, v241, v245
    v_mfma_f32_16x16x32_bf16 a[144:147], a[240:243], v[32:35], a[144:147]
    v_exp_f32 v246, v222
    v_cmp_lt_f32 vcc, s67, v248
    v_mfma_f32_16x16x32_bf16 a[148:151], a[244:247], v[32:35], a[148:151]
    ds_read_b64_tr_b16 a[234:235], v8 offset:12544
    v_cvt_pk_bf16_f32 v54, v244, v245
    v_mfma_f32_16x16x32_bf16 a[152:155], a[248:251], v[32:35], a[152:155]
    v_exp_f32 v247, v223
    v_mfma_f32_16x16x32_bf16 a[156:159], a[252:255], v[32:35], a[156:159]
    s_cbranch_vccnz L_stub2
L_back2:
    s_waitcnt vmcnt(4)
    buffer_load_dwordx4 v3, s[32:35], s66 offen offset:1024 sc0 nt sc1 lds
    v_add_f32 v241, v241, v246
    v_add_f32 v241, v241, v247
    v_mfma_f32_16x16x32_bf16 v[228:231], a[208:211], v[144:147], v[180:183]
    v_exp_f32 v244, v224
    v_mfma_f32_16x16x32_bf16 v[228:231], a[212:215], v[148:151], v[228:231]
    ds_read_b64_tr_b16 a[236:237], v9 offset:8448
    v_cvt_pk_bf16_f32 v55, v246, v247
    v_mfma_f32_16x16x32_bf16 v[228:231], a[216:219], v[152:155], v[228:231]
    v_exp_f32 v245, v225
    v_mfma_f32_16x16x32_bf16 v[228:231], a[220:223], v[156:159], v[228:231]
    v_add_f32 v242, v242, v244
    v_add_f32 v242, v242, v245
    v_mfma_f32_16x16x32_bf16 a[176:179], a[240:243], v[36:39], a[176:179]
    v_exp_f32 v246, v226
    v_mfma_f32_16x16x32_bf16 a[180:183], a[244:247], v[36:39], a[180:183]
    ds_read_b64_tr_b16 a[238:239], v9 offset:12544
    v_cvt_pk_bf16_f32 v58, v244, v245
    v_mfma_f32_16x16x32_bf16 a[184:187], a[248:251], v[36:39], a[184:187]
    v_exp_f32 v247, v227
    v_mfma_f32_16x16x32_bf16 a[188:191], a[252:255], v[36:39], a[188:191]
    s_waitcnt lgkmcnt(8)
    v_add_f32 v242, v242, v246
    v_add_f32 v242, v242, v247
    v_mfma_f32_16x16x32_bf16 v[184:187], a[192:195], v[64:67], v[160:163]
    v_exp_f32 v244, v228
    v_mfma_f32_16x16x32_bf16 v[184:187], a[196:199], v[68:71], v[184:187]
    ds_read_b128 a[208:211], v7 offset:4096
    v_cvt_pk_bf16_f32 v59, v246, v247
    v_mfma_f32_16x16x32_bf16 v[184:187], a[200:203], v[72:75], v[184:187]
    s_waitcnt lgkmcnt(3)
    s_add_u32 m0, s65, 16384
    v_exp_f32 v245, v229
    v_mfma_f32_16x16x32_bf16 v[184:187], a[204:207], v[76:79], v[184:187]
    s_waitcnt vmcnt(3)
    buffer_load_dwordx4 v3, s[36:39], s66 offen offset:0 sc0 nt sc1 lds
    v_add_f32 v243, v243, v244
    v_add_f32 v243, v243, v245
    v_mfma_f32_16x16x32_bf16 a[0:3], a[224:227], v[40:43], a[0:3]
    v_exp_f32 v246, v230
    v_mfma_f32_16x16x32_bf16 a[4:7], a[228:231], v[40:43], a[4:7]
    ds_read_b128 a[212:215], v7 offset:4352
    v_cvt_pk_bf16_f32 v62, v244, v245
    v_mfma_f32_16x16x32_bf16 a[8:11], a[232:235], v[40:43], a[8:11]
    s_waitcnt lgkmcnt(2)
    v_exp_f32 v247, v231
    v_mfma_f32_16x16x32_bf16 a[12:15], a[236:239], v[40:43], a[12:15]
    v_add_f32 v243, v243, v246
    v_add_f32 v243, v243, v247
    v_mfma_f32_16x16x32_bf16 v[188:191], a[192:195], v[80:83], v[164:167]
    v_exp_f32 v244, v184
    v_mfma_f32_16x16x32_bf16 v[188:191], a[196:199], v[84:87], v[188:191]
    ds_read_b128 a[216:219], v7 offset:4608
    v_cvt_pk_bf16_f32 v63, v246, v247
    v_mfma_f32_16x16x32_bf16 v[188:191], a[200:203], v[88:91], v[188:191]
    v_exp_f32 v245, v185
    v_max3_f32 v248, v241, v242, v243
    v_mfma_f32_16x16x32_bf16 v[188:191], a[204:207], v[92:95], v[188:191]
    v_add_f32 v232, v238, v244
    v_add_f32 v232, v232, v245
    v_mfma_f32_16x16x32_bf16 a[32:35], a[224:227], v[44:47], a[32:35]
    v_exp_f32 v246, v186
    v_cmp_lt_f32 vcc, s67, v248
    v_mfma_f32_16x16x32_bf16 a[36:39], a[228:231], v[44:47], a[36:39]
    ds_read_b128 a[220:223], v7 offset:4864
    v_cvt_pk_bf16_f32 v16, v244, v245
    v_mfma_f32_16x16x32_bf16 a[40:43], a[232:235], v[44:47], a[40:43]
    v_exp_f32 v247, v187
    v_mfma_f32_16x16x32_bf16 a[44:47], a[236:239], v[44:47], a[44:47]
    s_cbranch_vccnz L_stub3
L_back3:
    s_waitcnt vmcnt(4)
    buffer_load_dwordx4 v3, s[36:39], s66 offen offset:1024 sc0 nt sc1 lds
    v_add_f32 v232, v232, v246
    v_add_f32 v232, v232, v247
    v_mfma_f32_16x16x32_bf16 v[192:195], a[192:195], v[96:99], v[168:171]
    v_exp_f32 v244, v188
    v_mfma_f32_16x16x32_bf16 v[192:195], a[196:199], v[100:103], v[192:195]
    ds_read_b64_tr_b16 a[240:241], v8 offset:8704
    v_cvt_pk_bf16_f32 v17, v246, v247
    v_mfma_f32_16x16x32_bf16 v[192:195], a[200:203], v[104:107], v[192:195]
    v_exp_f32 v245, v189
    v_mfma_f32_16x16x32_bf16 v[192:195], a[204:207], v[108:111], v[192:195]
    v_add_f32 v233, v239, v244
    v_add_f32 v233, v233, v245
    v_mfma_f32_16x16x32_bf16 a[64:67], a[224:227], v[48:51], a[64:67]
    v_exp_f32 v246, v190
    v_mfma_f32_16x16x32_bf16 a[68:71], a[228:231], v[48:51], a[68:71]
    ds_read_b64_tr_b16 a[242:243], v8 offset:12800
    v_cvt_pk_bf16_f32 v20, v244, v245
    v_mfma_f32_16x16x32_bf16 a[72:75], a[232:235], v[48:51], a[72:75]
    v_exp_f32 v247, v191
    v_mfma_f32_16x16x32_bf16 a[76:79], a[236:239], v[48:51], a[76:79]
    v_add_f32 v233, v233, v246
    v_add_f32 v233, v233, v247
    v_mfma_f32_16x16x32_bf16 v[196:199], a[192:195], v[112:115], v[172:175]
    v_exp_f32 v244, v192
    v_mfma_f32_16x16x32_bf16 v[196:199], a[196:199], v[116:119], v[196:199]
    ds_read_b64_tr_b16 a[244:245], v9 offset:8704
    v_cvt_pk_bf16_f32 v21, v246, v247
    v_mfma_f32_16x16x32_bf16 v[196:199], a[200:203], v[120:123], v[196:199]
    s_add_u32 m0, s65, 24576
    v_exp_f32 v245, v193
    v_mfma_f32_16x16x32_bf16 v[196:199], a[204:207], v[124:127], v[196:199]
    s_waitcnt vmcnt(3)
    buffer_load_dwordx4 v3, s[40:43], s66 offen offset:0 sc0 nt sc1 lds
    v_add_f32 v234, v240, v244
    v_add_f32 v234, v234, v245
    v_mfma_f32_16x16x32_bf16 a[96:99], a[224:227], v[52:55], a[96:99]
    v_exp_f32 v246, v194
    v_mfma_f32_16x16x32_bf16 a[100:103], a[228:231], v[52:55], a[100:103]
    s_add_u32 s65, s65, 32768
    ds_read_b64_tr_b16 a[246:247], v9 offset:12800
    v_cvt_pk_bf16_f32 v24, v244, v245
    v_mfma_f32_16x16x32_bf16 a[104:107], a[232:235], v[52:55], a[104:107]
    s_cmp_ge_u32 s65, 163840
    v_exp_f32 v247, v195
    v_mfma_f32_16x16x32_bf16 a[108:111], a[236:239], v[52:55], a[108:111]
    s_cselect_b32 s56, 98304, 0
    v_add_f32 v234, v234, v246
    v_add_f32 v234, v234, v247
    v_mfma_f32_16x16x32_bf16 v[200:203], a[192:195], v[128:131], v[176:179]
    s_sub_u32 s65, s65, s56
    v_exp_f32 v244, v196
    v_mfma_f32_16x16x32_bf16 v[200:203], a[196:199], v[132:135], v[200:203]
    ds_read_b64_tr_b16 a[248:249], v8 offset:8960
    v_cvt_pk_bf16_f32 v25, v246, v247
    v_mfma_f32_16x16x32_bf16 v[200:203], a[200:203], v[136:139], v[200:203]
    v_exp_f32 v245, v197
    v_mfma_f32_16x16x32_bf16 v[200:203], a[204:207], v[140:143], v[200:203]
    v_add_f32 v235, v241, v244
    v_add_f32 v235, v235, v245
    v_mfma_f32_16x16x32_bf16 a[128:131], a[224:227], v[56:59], a[128:131]
    v_exp_f32 v246, v198
    v_mfma_f32_16x16x32_bf16 a[132:135], a[228:231], v[56:59], a[132:135]
    ds_read_b64_tr_b16 a[250:251], v8 offset:13056
    v_cvt_pk_bf16_f32 v28, v244, v245
    v_mfma_f32_16x16x32_bf16 a[136:139], a[232:235], v[56:59], a[136:139]
    s_add_u32 s64, s64, 32768
    v_exp_f32 v247, v199
    v_mfma_f32_16x16x32_bf16 a[140:143], a[236:239], v[56:59], a[140:143]
    s_cmp_ge_u32 s64, 163840
    s_waitcnt vmcnt(4)
    buffer_load_dwordx4 v3, s[40:43], s66 offen offset:1024 sc0 nt sc1 lds
    v_add_f32 v235, v235, v246
    v_add_f32 v235, v235, v247
    v_mfma_f32_16x16x32_bf16 v[204:207], a[192:195], v[144:147], v[180:183]
    s_cselect_b32 s81, 98304, 0
    v_exp_f32 v244, v200
    v_mfma_f32_16x16x32_bf16 v[204:207], a[196:199], v[148:151], v[204:207]
    s_sub_u32 s64, s64, s81
    ds_read_b64_tr_b16 a[252:253], v9 offset:8960
    v_cvt_pk_bf16_f32 v29, v246, v247
    v_mfma_f32_16x16x32_bf16 v[204:207], a[200:203], v[152:155], v[204:207]
    v_exp_f32 v245, v201
    v_mfma_f32_16x16x32_bf16 v[204:207], a[204:207], v[156:159], v[204:207]
    s_add_u32 s66, s66, 8192
    v_add_f32 v236, v242, v244
    v_add_f32 v236, v236, v245
    v_mfma_f32_16x16x32_bf16 a[160:163], a[224:227], v[60:63], a[160:163]
    v_exp_f32 v246, v202
    v_mfma_f32_16x16x32_bf16 a[164:167], a[228:231], v[60:63], a[164:167]
    ds_read_b64_tr_b16 a[254:255], v9 offset:13056
    v_cvt_pk_bf16_f32 v32, v244, v245
    v_add_u32 v7, s64, v11
    v_mfma_f32_16x16x32_bf16 a[168:171], a[232:235], v[60:63], a[168:171]
    v_exp_f32 v247, v203
    v_add_u32 v8, s64, v12
    v_mfma_f32_16x16x32_bf16 a[172:175], a[236:239], v[60:63], a[172:175]
    s_waitcnt lgkmcnt(8)
    v_add_f32 v236, v236, v246
    v_add_f32 v236, v236, v247
    v_xor_b32 v9, 32, v8
    v_mfma_f32_16x16x32_bf16 v[208:211], a[208:211], v[64:67], v[160:163]
    s_waitcnt vmcnt(8) lgkmcnt(0)
    s_cmp_eq_u32 s57, s3
    s_cbranch_scc1 L_chkw
L_chkw_back:
    s_barrier
    v_exp_f32 v244, v204
    v_mfma_f32_16x16x32_bf16 v[208:211], a[212:215], v[68:71], v[208:211]
    ds_read_b128 a[192:195], v7 offset:0
    v_cvt_pk_bf16_f32 v33, v246, v247
    v_mfma_f32_16x16x32_bf16 v[208:211], a[216:219], v[72:75], v[208:211]
    s_add_u32 m0, s65, 0
    v_exp_f32 v245, v205
    v_mfma_f32_16x16x32_bf16 v[208:211], a[220:223], v[76:79], v[208:211]
    s_waitcnt vmcnt(3)
    buffer_load_dwordx4 v3, s[28:31], s66 offen offset:0 sc0 nt sc1 lds
    v_add_f32 v237, v243, v244
    v_add_f32 v237, v237, v245
    v_mfma_f32_16x16x32_bf16 a[16:19], a[240:243], v[40:43], a[16:19]
    v_exp_f32 v246, v206
    v_mfma_f32_16x16x32_bf16 a[20:23], a[244:247], v[40:43], a[20:23]
    ds_read_b128 a[196:199], v7 offset:256
    v_cvt_pk_bf16_f32 v36, v244, v245
    v_mfma_f32_16x16x32_bf16 a[24:27], a[248:251], v[40:43], a[24:27]
    v_exp_f32 v247, v207
    v_mfma_f32_16x16x32_bf16 a[28:31], a[252:255], v[40:43], a[28:31]
    v_add_f32 v237, v237, v246
    v_add_f32 v237, v237, v247
    v_mfma_f32_16x16x32_bf16 v[212:215], a[208:211], v[80:83], v[164:167]
    v_exp_f32 v244, v208
    v_mfma_f32_16x16x32_bf16 v[212:215], a[212:215], v[84:87], v[212:215]
    ds_read_b128 a[200:203], v7 offset:512
    v_cvt_pk_bf16_f32 v37, v246, v247
    v_mfma_f32_16x16x32_bf16 v[212:215], a[216:219], v[88:91], v[212:215]
    v_exp_f32 v245, v209
    v_mfma_f32_16x16x32_bf16 v[212:215], a[220:223], v[92:95], v[212:215]
    v_add_f32 v232, v232, v244
    v_add_f32 v232, v232, v245
    v_mfma_f32_16x16x32_bf16 a[48:51], a[240:243], v[44:47], a[48:51]
    v_exp_f32 v246, v210
    v_mfma_f32_16x16x32_bf16 a[52:55], a[244:247], v[44:47], a[52:55]
    ds_read_b128 a[204:207], v7 offset:768
    v_cvt_pk_bf16_f32 v18, v244, v245
    v_mfma_f32_16x16x32_bf16 a[56:59], a[248:251], v[44:47], a[56:59]
    v_exp_f32 v247, v211
    v_mfma_f32_16x16x32_bf16 a[60:63], a[252:255], v[44:47], a[60:63]
    s_waitcnt vmcnt(4)
    buffer_load_dwordx4 v3, s[28:31], s66 offen offset:1024 sc0 nt sc1 lds
    v_add_f32 v232, v232, v246
    v_add_f32 v232, v232, v247
    v_mfma_f32_16x16x32_bf16 v[216:219], a[208:211], v[96:99], v[168:171]
    v_exp_f32 v244, v212
    v_mfma_f32_16x16x32_bf16 v[216:219], a[212:215], v[100:103], v[216:219]
    ds_read_b64_tr_b16 a[224:225], v8 offset:8192
    v_cvt_pk_bf16_f32 v19, v246, v247
    v_mfma_f32_16x16x32_bf16 v[216:219], a[216:219], v[104:107], v[216:219]
    v_exp_f32 v245, v213
    v_mfma_f32_16x16x32_bf16 v[216:219], a[220:223], v[108:111], v[216:219]
    v_add_f32 v233, v233, v244
    v_add_f32 v233, v233, v245
    v_mfma_f32_16x16x32_bf16 a[80:83], a[240:243], v[48:51], a[80:83]
    v_exp_f32 v246, v214
    v_mfma_f32_16x16x32_bf16 a[84:87], a[244:247], v[48:51], a[84:87]
    ds_read_b64_tr_b16 a[226:227], v8 offset:12288
    v_cvt_pk_bf16_f32 v22, v244, v245
    v_mfma_f32_16x16x32_bf16 a[88:91], a[248:251], v[48:51], a[88:91]
    v_exp_f32 v247, v215
    v_mfma_f32_16x16x32_bf16 a[92:95], a[252:255], v[48:51], a[92:95]
    v_add_f32 v233, v233, v246
    v_add_f32 v233, v233, v247
    v_mfma_f32_16x16x32_bf16 v[220:223], a[208:211], v[112:115], v[172:175]
    v_exp_f32 v244, v216
    v_mfma_f32_16x16x32_bf16 v[220:223], a[212:215], v[116:119], v[220:223]
    ds_read_b64_tr_b16 a[228:229], v9 offset:8192
    v_cvt_pk_bf16_f32 v23, v246, v247
    v_mfma_f32_16x16x32_bf16 v[220:223], a[216:219], v[120:123], v[220:223]
    s_add_u32 m0, s65, 8192
    v_exp_f32 v245, v217
    v_mfma_f32_16x16x32_bf16 v[220:223], a[220:223], v[124:127], v[220:223]
    s_waitcnt vmcnt(3)
    buffer_load_dwordx4 v3, s[32:35], s66 offen offset:0 sc0 nt sc1 lds
    v_add_f32 v234, v234, v244
    v_add_f32 v234, v234, v245
    v_mfma_f32_16x16x32_bf16 a[112:115], a[240:243], v[52:55], a[112:115]
    v_exp_f32 v246, v218
    v_mfma_f32_16x16x32_bf16 a[116:119], a[244:247], v[52:55], a[116:119]
    ds_read_b64_tr_b16 a[230:231], v9 offset:12288
    v_cvt_pk_bf16_f32 v26, v244, v245
    v_mfma_f32_16x16x32_bf16 a[120:123], a[248:251], v[52:55], a[120:123]
    v_exp_f32 v247, v219
    v_mfma_f32_16x16x32_bf16 a[124:127], a[252:255], v[52:55], a[124:127]
    v_add_f32 v234, v234, v246
    v_add_f32 v234, v234, v247
    v_mfma_f32_16x16x32_bf16 v[224:227], a[208:211], v[128:131], v[176:179]
    v_exp_f32 v244, v220
    v_mfma_f32_16x16x32_bf16 v[224:227], a[212:215], v[132:135], v[224:227]
    ds_read_b64_tr_b16 a[232:233], v8 offset:8448
    v_cvt_pk_bf16_f32 v27, v246, v247
    v_mfma_f32_16x16x32_bf16 v[224:227], a[216:219], v[136:139], v[224:227]
    v_exp_f32 v245, v221
    v_max3_f32 v248, v232, v233, v234
    v_mfma_f32_16x16x32_bf16 v[224:227], a[220:223], v[140:143], v[224:227]
    v_add_f32 v235, v235, v244
    v_add_f32 v235, v235, v245
    v_mfma_f32_16x16x32_bf16 a[144:147], a[240:243], v[56:59], a[144:147]
    v_exp_f32 v246, v222
    v_cmp_lt_f32 vcc, s67, v248
    v_mfma_f32_16x16x32_bf16 a[148:151], a[244:247], v[56:59], a[148:151]
    ds_read_b64_tr_b16 a[234:235], v8 offset:12544
    v_cvt_pk_bf16_f32 v30, v244, v245
    v_mfma_f32_16x16x32_bf16 a[152:155], a[248:251], v[56:59], a[152:155]
    v_exp_f32 v247, v223
    v_mfma_f32_16x16x32_bf16 a[156:159], a[252:255], v[56:59], a[156:159]
    s_cbranch_vccnz L_stub4
L_back4:
    s_waitcnt vmcnt(4)
    buffer_load_dwordx4 v3, s[32:35], s66 offen offset:1024 sc0 nt sc1 lds
    v_add_f32 v235, v235, v246
    v_add_f32 v235, v235, v247
    v_mfma_f32_16x16x32_bf16 v[228:231], a[208:211], v[144:147], v[180:183]
    v_exp_f32 v244, v224
    v_mfma_f32_16x16x32_bf16 v[228:231], a[212:215], v[148:151], v[228:231]
    ds_read_b64_tr_b16 a[236:237], v9 offset:8448
    v_cvt_pk_bf16_f32 v31, v246, v247
    v_mfma_f32_16x16x32_bf16 v[228:231], a[216:219], v[152:155], v[228:231]
    v_exp_f32 v245, v225
    v_mfma_f32_16x16x32_bf16 v[228:231], a[220:223], v[156:159], v[228:231]
    v_add_f32 v236, v236, v244
    v_add_f32 v236, v236, v245
    v_mfma_f32_16x16x32_bf16 a[176:179], a[240:243], v[60:63], a[176:179]
    v_exp_f32 v246, v226
    v_mfma_f32_16x16x32_bf16 a[180:183], a[244:247], v[60:63], a[180:183]
    ds_read_b64_tr_b16 a[238:239], v9 offset:12544
    v_cvt_pk_bf16_f32 v34, v244, v245
    v_mfma_f32_16x16x32_bf16 a[184:187], a[248:251], v[60:63], a[184:187]
    v_exp_f32 v247, v227
    v_mfma_f32_16x16x32_bf16 a[188:191], a[252:255], v[60:63], a[188:191]
    s_waitcnt lgkmcnt(8)
    v_add_f32 v236, v236, v246
    v_add_f32 v236, v236, v247
    v_mfma_f32_16x16x32_bf16 v[184:187], a[192:195], v[64:67], v[160:163]
    v_exp_f32 v244, v228
    v_mfma_f32_16x16x32_bf16 v[184:187], a[196:199], v[68:71], v[184:187]
    ds_read_b128 a[208:211], v7 offset:4096
    v_cvt_pk_bf16_f32 v35, v246, v247
    v_mfma_f32_16x16x32_bf16 v[184:187], a[200:203], v[72:75], v[184:187]
    s_waitcnt lgkmcnt(3)
    s_add_u32 m0, s65, 16384
    v_exp_f32 v245, v229
    v_mfma_f32_16x16x32_bf16 v[184:187], a[204:207], v[76:79], v[184:187]
    s_waitcnt vmcnt(3)
    buffer_load_dwordx4 v3, s[36:39], s66 offen offset:0 sc0 nt sc1 lds
    v_add_f32 v237, v237, v244
    v_add_f32 v237, v237, v245
    v_mfma_f32_16x16x32_bf16 a[0:3], a[224:227], v[16:19], a[0:3]
    v_exp_f32 v246, v230
    v_mfma_f32_16x16x32_bf16 a[4:7], a[228:231], v[16:19], a[4:7]
    ds_read_b128 a[212:215], v7 offset:4352
    v_cvt_pk_bf16_f32 v38, v244, v245
    v_mfma_f32_16x16x32_bf16 a[8:11], a[232:235], v[16:19], a[8:11]
    s_waitcnt lgkmcnt(2)
    v_exp_f32 v247, v231
    v_mfma_f32_16x16x32_bf16 a[12:15], a[236:239], v[16:19], a[12:15]
    v_add_f32 v237, v237, v246
    v_add_f32 v237, v237, v247
    v_mfma_f32_16x16x32_bf16 v[188:191], a[192:195], v[80:83], v[164:167]
    v_exp_f32 v244, v184
    v_mfma_f32_16x16x32_bf16 v[188:191], a[196:199], v[84:87], v[188:191]
    ds_read_b128 a[216:219], v7 offset:4608
    v_cvt_pk_bf16_f32 v39, v246, v247
    v_mfma_f32_16x16x32_bf16 v[188:191], a[200:203], v[88:91], v[188:191]
    v_exp_f32 v245, v185
    v_max3_f32 v248, v235, v236, v237
    v_mfma_f32_16x16x32_bf16 v[188:191], a[204:207], v[92:95], v[188:191]
    v_add_f32 v238, v232, v244
    v_add_f32 v238, v238, v245
    v_mfma_f32_16x16x32_bf16 a[32:35], a[224:227], v[20:23], a[32:35]
    v_exp_f32 v246, v186
    v_cmp_lt_f32 vcc, s67, v248
    v_mfma_f32_16x16x32_bf16 a[36:39], a[228:231], v[20:23], a[36:39]
    ds_read_b128 a[220:223], v7 offset:4864
    v_cvt_pk_bf16_f32 v40, v244, v245
    v_mfma_f32_16x16x32_bf16 a[40:43], a[232:235], v[20:23], a[40:43]
    v_exp_f32 v247, v187
    v_mfma_f32_16x16x32_bf16 a[44:47], a[236:239], v[20:23], a[44:47]
    s_cbranch_vccnz L_stub5
L_back5:
    s_waitcnt vmcnt(4)
    buffer_load_dwordx4 v3, s[36:39], s66 offen offset:1024 sc0 nt sc1 lds
    v_add_f32 v238, v238, v246
    v_add_f32 v238, v238, v247
    v_mfma_f32_16x16x32_bf16 v[192:195], a[192:195], v[96:99], v[168:171]
    v_exp_f32 v244, v188
    v_mfma_f32_16x16x32_bf16 v[192:195], a[196:199], v[100:103], v[192:195]
    ds_read_b64_tr_b16 a[240:241], v8 offset:8704
    v_cvt_pk_bf16_f32 v41, v246, v247
    v_mfma_f32_16x16x32_bf16 v[192:195], a[200:203], v[104:107], v[192:195]
    v_exp_f32 v245, v189
    v_mfma_f32_16x16x32_bf16 v[192:195], a[204:207], v[108:111], v[192:195]
    v_add_f32 v239, v233, v244
    v_add_f32 v239, v239, v245
    v_mfma_f32_16x16x32_bf16 a[64:67], a[224:227], v[24:27], a[64:67]
    v_exp_f32 v246, v190
    v_mfma_f32_16x16x32_bf16 a[68:71], a[228:231], v[24:27], a[68:71]
    ds_read_b64_tr_b16 a[242:243], v8 offset:12800
    v_cvt_pk_bf16_f32 v44, v244, v245
    v_mfma_f32_16x16x32_bf16 a[72:75], a[232:235], v[24:27], a[72:75]
    v_exp_f32 v247, v191
    v_mfma_f32_16x16x32_bf16 a[76:79], a[236:239], v[24:27], a[76:79]
    v_add_f32 v239, v239, v246
    v_add_f32 v239, v239, v247
    v_mfma_f32_16x16x32_bf16 v[196:199], a[192:195], v[112:115], v[172:175]
    v_exp_f32 v244, v192
    v_mfma_f32_16x16x32_bf16 v[196:199], a[196:199], v[116:119], v[196:199]
    ds_read_b64_tr_b16 a[244:245], v9 offset:8704
    v_cvt_pk_bf16_f32 v45, v246, v247
    v_mfma_f32_16x16x32_bf16 v[196:199], a[200:203], v[120:123], v[196:199]
    s_add_u32 m0, s65, 24576
    v_exp_f32 v245, v193
    v_mfma_f32_16x16x32_bf16 v[196:199], a[204:207], v[124:127], v[196:199]
    s_waitcnt vmcnt(3)
    buffer_load_dwordx4 v3, s[40:43], s66 offen offset:0 sc0 nt sc1 lds
    v_add_f32 v240, v234, v244
    v_add_f32 v240, v240, v245
    v_mfma_f32_16x16x32_bf16 a[96:99], a[224:227], v[28:31], a[96:99]
    v_exp_f32 v246, v194
    v_mfma_f32_16x16x32_bf16 a[100:103], a[228:231], v[28:31], a[100:103]
    s_add_u32 s65, s65, 32768
    ds_read_b64_tr_b16 a[246:247], v9 offset:12800
    v_cvt_pk_bf16_f32 v48, v244, v245
    v_mfma_f32_16x16x32_bf16 a[104:107], a[232:235], v[28:31], a[104:107]
    s_cmp_ge_u32 s65, 163840
    v_exp_f32 v247, v195
    v_mfma_f32_16x16x32_bf16 a[108:111], a[236:239], v[28:31], a[108:111]
    s_cselect_b32 s56, 98304, 0
    v_add_f32 v240, v240, v246
    v_add_f32 v240, v240, v247
    v_mfma_f32_16x16x32_bf16 v[200:203], a[192:195], v[128:131], v[176:179]
    s_sub_u32 s65, s65, s56
    v_exp_f32 v244, v196
    v_mfma_f32_16x16x32_bf16 v[200:203], a[196:199], v[132:135], v[200:203]
    ds_read_b64_tr_b16 a[248:249], v8 offset:8960
    v_cvt_pk_bf16_f32 v49, v246, v247
    v_mfma_f32_16x16x32_bf16 v[200:203], a[200:203], v[136:139], v[200:203]
    v_exp_f32 v245, v197
    v_mfma_f32_16x16x32_bf16 v[200:203], a[204:207], v[140:143], v[200:203]
    v_add_f32 v241, v235, v244
    v_add_f32 v241, v241, v245
    v_mfma_f32_16x16x32_bf16 a[128:131], a[224:227], v[32:35], a[128:131]
    v_exp_f32 v246, v198
    v_mfma_f32_16x16x32_bf16 a[132:135], a[228:231], v[32:35], a[132:135]
    ds_read_b64_tr_b16 a[250:251], v8 offset:13056
    v_cvt_pk_bf16_f32 v52, v244, v245
    v_mfma_f32_16x16x32_bf16 a[136:139], a[232:235], v[32:35], a[136:139]
    s_add_u32 s64, s64, 32768
    v_exp_f32 v247, v199
    v_mfma_f32_16x16x32_bf16 a[140:143], a[236:239], v[32:35], a[140:143]
    s_cmp_ge_u32 s64, 163840
    s_waitcnt vmcnt(4)
    buffer_load_dwordx4 v3, s[40:43], s66 offen offset:1024 sc0 nt sc1 lds
    v_add_f32 v241, v241, v246
    v_add_f32 v241, v241, v247
    v_mfma_f32_16x16x32_bf16 v[204:207], a[192:195], v[144:147], v[180:183]
    s_cselect_b32 s81, 98304, 0
    v_exp_f32 v244, v200
    v_mfma_f32_16x16x32_bf16 v[204:207], a[196:199], v[148:151], v[204:207]
    s_sub_u32 s64, s64, s81
    ds_read_b64_tr_b16 a[252:253], v9 offset:8960
    v_cvt_pk_bf16_f32 v53, v246, v247
    v_mfma_f32_16x16x32_bf16 v[204:207], a[200:203], v[152:155], v[204:207]
    v_exp_f32 v245, v201
    v_mfma_f32_16x16x32_bf16 v[204:207], a[204:207], v[156:159], v[204:207]
    s_add_u32 s66, s66, 8192
    v_add_f32 v242, v236, v244
    v_add_f32 v242, v242, v245
    v_mfma_f32_16x16x32_bf16 a[160:163], a[224:227], v[36:39], a[160:163]
    s_sub_u32 s57, s57, 1
    v_exp_f32 v246, v202
    v_mfma_f32_16x16x32_bf16 a[164:167], a[228:231], v[36:39], a[164:167]
    s_cmp_lg_u32 s57, 0
    ds_read_b64_tr_b16 a[254:255], v9 offset:13056
    v_cvt_pk_bf16_f32 v56, v244, v245
    v_add_u32 v7, s64, v11
    v_mfma_f32_16x16x32_bf16 a[168:171], a[232:235], v[36:39], a[168:171]
    v_exp_f32 v247, v203
    v_add_u32 v8, s64, v12
    v_mfma_f32_16x16x32_bf16 a[172:175], a[236:239], v[36:39], a[172:175]
    s_waitcnt lgkmcnt(8)
    v_add_f32 v242, v242, v246
    v_add_f32 v242, v242, v247
    v_xor_b32 v9, 32, v8
    s_cbranch_scc1 L_aloop
L_tail0:
    s_lshr_b32 s20, s54, 2
    s_lshr_b32 s24, s52, 1
    v_lshlrev_b32 v10, 4, v0
    s_lshl_b32 s79, s24, 1
    s_add_u32 s79, s79, s52
    v_mfma_f32_16x16x32_bf16 v[208:211], a[208:211], v[64:67], v[160:163]
    s_waitcnt vmcnt(0) lgkmcnt(0)
    s_barrier
    v_exp_f32 v244, v204
    v_mfma_f32_16x16x32_bf16 v[208:211], a[212:215], v[68:71], v[208:211]
    ds_read_b64_tr_b16 a[224:225], v8 offset:8192
    v_cvt_pk_bf16_f32 v57, v246, v247
    v_mfma_f32_16x16x32_bf16 v[208:211], a[216:219], v[72:75], v[208:211]
    s_mov_b32 s58, s78
    s_lshl_b32 s58, s58, 3
    s_add_u32 s58, s58, s52
    s_add_u32 s58, s58, 4
    s_mul_i32 s58, s58, 36864
    s_add_u32 m0, s59, 36864
    v_exp_f32 v245, v205
    v_mfma_f32_16x16x32_bf16 v[208:211], a[220:223], v[76:79], v[208:211]
    s_lshl_b32 s55, s53, 3
    buffer_load_dwordx4 v1, s[72:75], s58 offen sc1 lds
    v_add_f32 v243, v237, v244
    v_add_f32 v243, v243, v245
    v_mfma_f32_16x16x32_bf16 a[16:19], a[240:243], v[16:19], a[16:19]
    s_add_u32 s22, s55, s20
    v_exp_f32 v246, v206
    v_mfma_f32_16x16x32_bf16 a[20:23], a[244:247], v[16:19], a[20:23]
    s_lshl_b32 s22, s22, 7
    ds_read_b64_tr_b16 a[226:227], v8 offset:12288
    v_cvt_pk_bf16_f32 v60, v244, v245
    v_mfma_f32_16x16x32_bf16 a[24:27], a[248:251], v[16:19], a[24:27]
    s_add_u32 m0, s59, 37888
    v_exp_f32 v247, v207
    v_mfma_f32_16x16x32_bf16 a[28:31], a[252:255], v[16:19], a[28:31]
    s_add_u32 s23, s55, s78
    buffer_load_dwordx4 v2, s[72:75], s58 offen sc1 lds
    v_add_f32 v243, v243, v246
    v_add_f32 v243, v243, v247
    v_mfma_f32_16x16x32_bf16 v[212:215], a[208:211], v[80:83], v[164:167]
    s_lshl_b32 s23, s23, 7
    v_exp_f32 v244, v208
    v_mfma_f32_16x16x32_bf16 v[212:215], a[212:215], v[84:87], v[212:215]
    s_add_u32 s23, s23, 512
    ds_read_b64_tr_b16 a[228:229], v9 offset:8192
    v_cvt_pk_bf16_f32 v61, v246, v247
    v_mfma_f32_16x16x32_bf16 v[212:215], a[216:219], v[88:91], v[212:215]
    s_add_u32 m0, s59, 38912
    v_exp_f32 v245, v209
    v_mfma_f32_16x16x32_bf16 v[212:215], a[220:223], v[92:95], v[212:215]
    s_lshl_b32 s55, s53, 2
    buffer_load_dwordx4 v4, s[72:75], s58 offen sc1 lds
    v_add_f32 v238, v238, v244
    v_add_f32 v238, v238, v245
    v_mfma_f32_16x16x32_bf16 a[48:51], a[240:243], v[20:23], a[48:51]
    s_add_u32 s55, s55, s78
    v_exp_f32 v246, v210
    v_mfma_f32_16x16x32_bf16 a[52:55], a[244:247], v[20:23], a[52:55]
    s_mul_i32 s56, s55, 172032
    ds_read_b64_tr_b16 a[230:231], v9 offset:12288
    v_cvt_pk_bf16_f32 v42, v244, v245
    v_mfma_f32_16x16x32_bf16 a[56:59], a[248:251], v[20:23], a[56:59]
    s_add_u32 m0, s59, 39936
    v_exp_f32 v247, v211
    v_mfma_f32_16x16x32_bf16 a[60:63], a[252:255], v[20:23], a[60:63]
    s_add_u32 s56, s56, 33554432
    buffer_load_dwordx4 v5, s[72:75], s58 offen sc1 lds
    v_add_f32 v238, v238, v246
    v_add_f32 v238, v238, v247
    v_mfma_f32_16x16x32_bf16 v[216:219], a[208:211], v[96:99], v[168:171]
    s_add_u32 s28, s18, s56
    s_addc_u32 s29, s19, 0
    v_exp_f32 v244, v212
    v_mfma_f32_16x16x32_bf16 v[216:219], a[212:215], v[100:103], v[216:219]
    s_mov_b32 s30, 172032
    ds_read_b64_tr_b16 a[232:233], v8 offset:8448
    v_cvt_pk_bf16_f32 v43, v246, v247
    v_mfma_f32_16x16x32_bf16 v[216:219], a[216:219], v[104:107], v[216:219]
    s_add_u32 m0, s59, 40960
    v_exp_f32 v245, v213
    v_mfma_f32_16x16x32_bf16 v[216:219], a[220:223], v[108:111], v[216:219]
    s_mov_b32 s31, 0x20000
    buffer_load_dwordx4 v6, s[72:75], s58 offen sc1 lds
    v_add_f32 v239, v239, v244
    v_add_f32 v239, v239, v245
    v_mfma_f32_16x16x32_bf16 a[80:83], a[240:243], v[24:27], a[80:83]
    s_mov_b32 s32, s14
    v_exp_f32 v246, v214
    v_mfma_f32_16x16x32_bf16 a[84:87], a[244:247], v[24:27], a[84:87]
    s_mov_b32 s33, s15
    ds_read_b64_tr_b16 a[234:235], v8 offset:12544
    v_cvt_pk_bf16_f32 v46, v244, v245
    v_mfma_f32_16x16x32_bf16 a[88:91], a[248:251], v[24:27], a[88:91]
    s_add_u32 m0, s59, 41984
    v_exp_f32 v247, v215
    v_mfma_f32_16x16x32_bf16 a[92:95], a[252:255], v[24:27], a[92:95]
    s_mov_b32 s34, 3538944
    buffer_load_dwordx4 v13, s[72:75], s58 offen sc1 lds
    v_add_f32 v239, v239, v246
    v_add_f32 v239, v239, v247
    v_mfma_f32_16x16x32_bf16 v[220:223], a[208:211], v[112:115], v[172:175]
    s_mov_b32 s35, 0x20000
    v_exp_f32 v244, v216
    v_mfma_f32_16x16x32_bf16 v[220:223], a[212:215], v[116:119], v[220:223]
    s_and_b32 s55, s52, 1
    ds_read_b64_tr_b16 a[236:237], v9 offset:8448
    v_cvt_pk_bf16_f32 v47, v246, v247
    v_mfma_f32_16x16x32_bf16 v[220:223], a[216:219], v[120:123], v[220:223]
    s_add_u32 m0, s59, 43008
    v_exp_f32 v245, v217
    v_mfma_f32_16x16x32_bf16 v[220:223], a[220:223], v[124:127], v[220:223]
    s_lshl_b32 s55, s55, 1
    buffer_load_dwordx4 v14, s[72:75], s58 offen sc1 lds
    v_add_f32 v240, v240, v244
    v_add_f32 v240, v240, v245
    v_mfma_f32_16x16x32_bf16 a[112:115], a[240:243], v[28:31], a[112:115]
    s_add_u32 s55, s55, s24
    v_exp_f32 v246, v218
    v_mfma_f32_16x16x32_bf16 a[116:119], a[244:247], v[28:31], a[116:119]
    s_mul_i32 s55, s55, 3
    ds_read_b64_tr_b16 a[238:239], v9 offset:12544
    v_cvt_pk_bf16_f32 v50, v244, v245
    v_mfma_f32_16x16x32_bf16 a[120:123], a[248:251], v[28:31], a[120:123]
    s_add_u32 m0, s59, 44032
    v_exp_f32 v247, v219
    v_mfma_f32_16x16x32_bf16 a[124:127], a[252:255], v[28:31], a[124:127]
    s_mul_i32 s25, s20, 393216
    buffer_load_dwordx4 v15, s[72:75], s58 offen sc1 lds
    v_add_f32 v240, v240, v246
    v_add_f32 v240, v240, v247
    v_mfma_f32_16x16x32_bf16 v[224:227], a[208:211], v[128:131], v[176:179]
    s_lshl_b32 s56, s55, 10
    v_exp_f32 v244, v220
    v_mfma_f32_16x16x32_bf16 v[224:227], a[212:215], v[132:135], v[224:227]
    s_add_u32 s25, s25, s56
    v_cvt_pk_bf16_f32 v51, v246, v247
    v_mfma_f32_16x16x32_bf16 v[224:227], a[216:219], v[136:139], v[224:227]
    s_add_u32 m0, s59, 45056
    v_exp_f32 v245, v221
    v_max3_f32 v248, v238, v239, v240
    v_mfma_f32_16x16x32_bf16 v[224:227], a[220:223], v[140:143], v[224:227]
    s_mul_i32 s56, s53, 12
    buffer_load_dwordx4 v251, s[72:75], s58 offen sc1 lds
    v_add_f32 v241, v241, v244
    v_add_f32 v241, v241, v245
    v_mfma_f32_16x16x32_bf16 a[144:147], a[240:243], v[32:35], a[144:147]
    s_add_u32 s55, s55, s56
    v_exp_f32 v246, v222
    v_cmp_lt_f32 vcc, s67, v248
    v_mfma_f32_16x16x32_bf16 a[148:151], a[244:247], v[32:35], a[148:151]
    s_mul_i32 s55, s55, 18432
    v_cvt_pk_bf16_f32 v54, v244, v245
    v_mfma_f32_16x16x32_bf16 a[152:155], a[248:251], v[32:35], a[152:155]
    s_cmp_le_u32 s78, 0
    s_cselect_b32 s58, 1, 0
    s_lshl_b32 s58, s58, 3
    s_add_u32 s58, s58, s79
    s_add_u32 s58, s58, 0
    s_mul_i32 s58, s58, 36864
    s_add_u32 m0, s59, 73728
    v_exp_f32 v247, v223
    v_mfma_f32_16x16x32_bf16 a[156:159], a[252:255], v[32:35], a[156:159]
    s_cbranch_vccnz L_stub6
L_back6:
    buffer_load_dwordx4 v1, s[72:75], s58 offen sc1 lds
    v_add_f32 v241, v241, v246
    v_add_f32 v241, v241, v247
    v_mfma_f32_16x16x32_bf16 v[228:231], a[208:211], v[144:147], v[180:183]
    s_mul_i32 s56, s78, 288
    v_exp_f32 v244, v224
    v_mfma_f32_16x16x32_bf16 v[228:231], a[212:215], v[148:151], v[228:231]
    s_add_u32 s55, s55, s56
    v_cvt_pk_bf16_f32 v55, v246, v247
    v_mfma_f32_16x16x32_bf16 v[228:231], a[216:219], v[152:155], v[228:231]
    s_add_u32 m0, s59, 74752
    v_exp_f32 v245, v225
    v_mfma_f32_16x16x32_bf16 v[228:231], a[220:223], v[156:159], v[228:231]
    s_add_u32 s43, s55, 256
    buffer_load_dwordx4 v2, s[72:75], s58 offen sc1 lds
    v_add_f32 v242, v242, v244
    v_add_f32 v242, v242, v245
    v_mfma_f32_16x16x32_bf16 a[176:179], a[240:243], v[36:39], a[176:179]
    s_lshl_b32 s56, s20, 6
    v_exp_f32 v246, v226
    v_mfma_f32_16x16x32_bf16 a[180:183], a[244:247], v[36:39], a[180:183]
    s_add_u32 s42, s55, s56
    v_cvt_pk_bf16_f32 v58, v244, v245
    v_mfma_f32_16x16x32_bf16 a[184:187], a[248:251], v[36:39], a[184:187]
    s_add_u32 s55, s20, 1
    v_exp_f32 v247, v227
    v_mfma_f32_16x16x32_bf16 a[188:191], a[252:255], v[36:39], a[188:191]
    s_waitcnt lgkmcnt(0)
    v_add_f32 v242, v242, v246
    v_add_f32 v242, v242, v247
    v_exp_f32 v244, v228
    ds_read_b64_tr_b16 a[240:241], v8 offset:8704
    v_cvt_pk_bf16_f32 v59, v246, v247
    v_exp_f32 v245, v229
    v_add_f32 v243, v243, v244
    v_add_f32 v243, v243, v245
    v_mfma_f32_16x16x32_bf16 a[0:3], a[224:227], v[40:43], a[0:3]
    s_and_b32 s55, s55, 3
    v_exp_f32 v246, v230
    v_mfma_f32_16x16x32_bf16 a[4:7], a[228:231], v[40:43], a[4:7]
    s_add_u32 m0, s59, 75776
    ds_read_b64_tr_b16 a[242:243], v8 offset:12800
    v_cvt_pk_bf16_f32 v62, v244, v245
    v_mfma_f32_16x16x32_bf16 a[8:11], a[232:235], v[40:43], a[8:11]
    s_mul_i32 s55, s55, 12
    buffer_load_dwordx4 v4, s[72:75], s58 offen sc1 lds
    v_exp_f32 v247, v231
    v_mfma_f32_16x16x32_bf16 a[12:15], a[236:239], v[40:43], a[12:15]
    s_add_u32 s55, s55, s52
    v_add_f32 v243, v243, v246
    v_add_f32 v243, v243, v247
    ds_read_b64_tr_b16 a[244:245], v9 offset:8704
    v_cvt_pk_bf16_f32 v63, v246, v247
    v_max3_f32 v248, v241, v242, v243
    v_mfma_f32_16x16x32_bf16 a[32:35], a[224:227], v[44:47], a[32:35]
    s_add_u32 s55, s55, 0
    v_cmp_lt_f32 vcc, s67, v248
    v_mov_b32 v32, v238
    v_mfma_f32_16x16x32_bf16 a[36:39], a[228:231], v[44:47], a[36:39]
    s_add_u32 m0, s59, 76800
    ds_read_b64_tr_b16 a[246:247], v9 offset:12800
    v_mov_b32 v33, v239
    v_mfma_f32_16x16x32_bf16 a[40:43], a[232:235], v[44:47], a[40:43]
    s_mul_i32 s36, s55, 3072
    buffer_load_dwordx4 v5, s[72:75], s58 offen sc1 lds
    v_mov_b32 v34, v240
    v_mfma_f32_16x16x32_bf16 a[44:47], a[236:239], v[44:47], a[44:47]
    s_cbranch_vccnz L_stub7
L_back7:
    v_permlane16_swap_b32 v32, v238
    v_permlane16_swap_b32 v33, v239
    ds_read_b64_tr_b16 a[248:249], v8 offset:8960
    v_mfma_f32_16x16x32_bf16 a[64:67], a[224:227], v[48:51], a[64:67]
    s_add_u32 s55, s20, 2
    v_permlane16_swap_b32 v34, v240
    v_add_f32 v32, v32, v238
    v_mfma_f32_16x16x32_bf16 a[68:71], a[228:231], v[48:51], a[68:71]
    s_add_u32 m0, s59, 77824
    ds_read_b64_tr_b16 a[250:251], v8 offset:13056
    v_add_f32 v33, v33, v239
    v_mfma_f32_16x16x32_bf16 a[72:75], a[232:235], v[48:51], a[72:75]
    s_and_b32 s55, s55, 3
    buffer_load_dwordx4 v6, s[72:75], s58 offen sc1 lds
    v_add_f32 v34, v34, v240
    v_mfma_f32_16x16x32_bf16 a[76:79], a[236:239], v[48:51], a[76:79]
    s_mul_i32 s55, s55, 12
    v_mov_b32 v238, v32
    v_mov_b32 v239, v33
    ds_read_b64_tr_b16 a[252:253], v9 offset:8960
    v_mfma_f32_16x16x32_bf16 a[96:99], a[224:227], v[52:55], a[96:99]
    s_add_u32 s55, s55, s52
    v_mov_b32 v240, v34
    v_permlane32_swap_b32 v32, v238
    v_mfma_f32_16x16x32_bf16 a[100:103], a[228:231], v[52:55], a[100:103]
    s_add_u32 m0, s59, 78848
    ds_read_b64_tr_b16 a[254:255], v9 offset:13056
    v_permlane32_swap_b32 v33, v239
    v_mfma_f32_16x16x32_bf16 a[104:107], a[232:235], v[52:55], a[104:107]
    s_add_u32 s55, s55, 4
    buffer_load_dwordx4 v13, s[72:75], s58 offen sc1 lds
    v_permlane32_swap_b32 v34, v240
    v_mfma_f32_16x16x32_bf16 a[108:111], a[236:239], v[52:55], a[108:111]
    s_mul_i32 s37, s55, 3072
    v_add_f32 v32, v32, v238
    v_add_f32 v33, v33, v239
    v_mfma_f32_16x16x32_bf16 a[128:131], a[224:227], v[56:59], a[128:131]
    s_add_u32 s55, s20, 3
    v_add_f32 v34, v34, v240
    v_rcp_f32 v32, v32
    v_mfma_f32_16x16x32_bf16 a[132:135], a[228:231], v[56:59], a[132:135]
    s_add_u32 m0, s59, 79872
    v_rcp_f32 v33, v33
    v_rcp_f32 v34, v34
    v_mfma_f32_16x16x32_bf16 a[136:139], a[232:235], v[56:59], a[136:139]
    s_and_b32 s55, s55, 3
    buffer_load_dwordx4 v14, s[72:75], s58 offen sc1 lds
    v_accvgpr_read_b32 v16, a0
    v_mfma_f32_16x16x32_bf16 a[140:143], a[236:239], v[56:59], a[140:143]
    s_mul_i32 s55, s55, 12
    v_accvgpr_read_b32 v17, a1
    v_accvgpr_read_b32 v18, a2
    v_mfma_f32_16x16x32_bf16 a[160:163], a[224:227], v[60:63], a[160:163]
    s_add_u32 s55, s55, s52
    v_accvgpr_read_b32 v19, a3
    v_accvgpr_read_b32 v20, a4
    v_mfma_f32_16x16x32_bf16 a[164:167], a[228:231], v[60:63], a[164:167]
    s_add_u32 s55, s55, 8
    v_accvgpr_read_b32 v21, a5
    v_accvgpr_read_b32 v22, a6
    v_mfma_f32_16x16x32_bf16 a[168:171], a[232:235], v[60:63], a[168:171]
    s_mul_i32 s38, s55, 3072
    v_accvgpr_read_b32 v23, a7
    v_mul_f32 v16, v16, v32
    v_mfma_f32_16x16x32_bf16 a[172:175], a[236:239], v[60:63], a[172:175]
    s_waitcnt lgkmcnt(0)
    s_barrier
    v_mul_f32 v17, v17, v32
    v_mul_f32 v18, v18, v32
    v_mfma_f32_16x16x32_bf16 a[16:19], a[240:243], v[40:43], a[16:19]
    s_mul_i32 s55, s20, 12
    v_mul_f32 v19, v19, v32
    v_mul_f32 v20, v20, v32
    v_mfma_f32_16x16x32_bf16 a[20:23], a[244:247], v[40:43], a[20:23]
    s_add_u32 m0, s59, 80896
    v_mul_f32 v21, v21, v32
    v_mul_f32 v22, v22, v32
    v_mfma_f32_16x16x32_bf16 a[24:27], a[248:251], v[40:43], a[24:27]
    s_add_u32 s55, s55, s52
    buffer_load_dwordx4 v15, s[72:75], s58 offen sc1 lds
    v_mul_f32 v23, v23, v32
    v_mfma_f32_16x16x32_bf16 a[28:31], a[252:255], v[40:43], a[28:31]
    s_mul_i32 s40, s55, 3072
    v_cvt_pk_bf16_f32 v64, v16, v17
    v_cvt_pk_bf16_f32 v65, v18, v19
    v_mfma_f32_16x16x32_bf16 a[48:51], a[240:243], v[44:47], a[48:51]
    s_sub_u32 s55, s52, s20
    v_cvt_pk_bf16_f32 v66, v20, v21
    v_cvt_pk_bf16_f32 v67, v22, v23
    v_mfma_f32_16x16x32_bf16 a[52:55], a[244:247], v[44:47], a[52:55]
    s_add_u32 m0, s59, 81920
    s_add_u32 s80, s100, 0
    buffer_store_dwordx4 v[64:67], v10, s[48:51], s80 offen sc1
    v_accvgpr_read_b32 v24, a32
    v_mfma_f32_16x16x32_bf16 a[56:59], a[248:251], v[44:47], a[56:59]
    s_add_u32 s55, s55, 3
    buffer_load_dwordx4 v251, s[72:75], s58 offen sc1 lds
    v_accvgpr_read_b32 v25, a33
    v_mfma_f32_16x16x32_bf16 a[60:63], a[252:255], v[44:47], a[60:63]
    s_and_b32 s55, s55, 3
    v_accvgpr_read_b32 v26, a34
    v_accvgpr_read_b32 v27, a35
    v_mfma_f32_16x16x32_bf16 a[80:83], a[240:243], v[48:51], a[80:83]
    s_mul_i32 s56, s52, 3
    v_accvgpr_read_b32 v28, a36
    v_accvgpr_read_b32 v29, a37
    v_mfma_f32_16x16x32_bf16 a[84:87], a[244:247], v[48:51], a[84:87]
    s_add_u32 s55, s55, s56
    v_accvgpr_read_b32 v30, a38
    v_accvgpr_read_b32 v31, a39
    v_mfma_f32_16x16x32_bf16 a[88:91], a[248:251], v[48:51], a[88:91]
    s_lshl_b32 s55, s55, 11
    v_mul_f32 v24, v24, v33
    v_mul_f32 v25, v25, v33
    v_mfma_f32_16x16x32_bf16 a[92:95], a[252:255], v[48:51], a[92:95]
    s_add_u32 s39, s55, 147456
    v_mul_f32 v26, v26, v33
    v_mul_f32 v27, v27, v33
    v_mfma_f32_16x16x32_bf16 a[112:115], a[240:243], v[52:55], a[112:115]
    s_lshl_b32 s56, s56, 11
    v_mul_f32 v28, v28, v33
    v_mul_f32 v29, v29, v33
    v_mfma_f32_16x16x32_bf16 a[116:119], a[244:247], v[52:55], a[116:119]
    s_add_u32 s41, s56, 147456
    v_mul_f32 v30, v30, v33
    v_mul_f32 v31, v31, v33
    v_mfma_f32_16x16x32_bf16 a[120:123], a[248:251], v[52:55], a[120:123]
    s_cmp_eq_u32 s20, s52
    s_cselect_b32 s39, 2147418112, s39
    s_cselect_b32 s41, s41, 2147418112
    s_cselect_b32 s43, s43, 2147418112
    v_cvt_pk_bf16_f32 v68, v24, v25
    v_cvt_pk_bf16_f32 v69, v26, v27
    v_mfma_f32_16x16x32_bf16 a[124:127], a[252:255], v[52:55], a[124:127]
    s_mov_b32 s27, 0
    v_cvt_pk_bf16_f32 v70, v28, v29
    v_cvt_pk_bf16_f32 v71, v30, v31
    v_mfma_f32_16x16x32_bf16 a[144:147], a[240:243], v[56:59], a[144:147]
    s_add_u32 s80, s100, 1024
    buffer_store_dwordx4 v[68:71], v10, s[48:51], s80 offen sc1
    v_mov_b32 v35, v241
    v_mfma_f32_16x16x32_bf16 a[148:151], a[244:247], v[56:59], a[148:151]
    v_mov_b32 v36, v242
    v_mov_b32 v37, v243
    v_mfma_f32_16x16x32_bf16 a[152:155], a[248:251], v[56:59], a[152:155]
    v_permlane16_swap_b32 v35, v241
    v_permlane16_swap_b32 v36, v242
    v_mfma_f32_16x16x32_bf16 a[156:159], a[252:255], v[56:59], a[156:159]
    v_permlane16_swap_b32 v37, v243
    v_add_f32 v35, v35, v241
    v_mfma_f32_16x16x32_bf16 a[176:179], a[240:243], v[60:63], a[176:179]
    v_add_f32 v36, v36, v242
    v_add_f32 v37, v37, v243
    v_mfma_f32_16x16x32_bf16 a[180:183], a[244:247], v[60:63], a[180:183]
    v_mov_b32 v241, v35
    v_mov_b32 v242, v36
    v_mfma_f32_16x16x32_bf16 a[184:187], a[248:251], v[60:63], a[184:187]
    v_mov_b32 v243, v37
    v_permlane32_swap_b32 v35, v241
    v_mfma_f32_16x16x32_bf16 a[188:191], a[252:255], v[60:63], a[188:191]
    v_permlane32_swap_b32 v36, v242
    v_permlane32_swap_b32 v37, v243
    v_add_f32 v35, v35, v241
    v_add_f32 v36, v36, v242
    v_add_f32 v37, v37, v243
    v_rcp_f32 v35, v35
    v_rcp_f32 v36, v36
    v_rcp_f32 v37, v37
L_tailcode:
    s_mul_i32 s55, s52, 12288
    s_add_u32 s55, s55, 110592
    v_add_u32 v244, s55, v10
    s_xor_b32 s55, s52, 2
    s_mul_i32 s55, s55, 12288
    s_add_u32 s55, s55, 110592
    v_add_u32 v245, s55, v10
    v_accvgpr_read_b32 v16, a64
    v_accvgpr_read_b32 v17, a65
    v_accvgpr_read_b32 v18, a66
    v_accvgpr_read_b32 v19, a67
    v_accvgpr_read_b32 v20, a68
    v_accvgpr_read_b32 v21, a69
    v_accvgpr_read_b32 v22, a70
    v_accvgpr_read_b32 v23, a71
    v_pk_mul_f32 v[16:17], v[16:17], v[34:35] op_sel:[0,0] op_sel_hi:[1,0]
    v_pk_mul_f32 v[18:19], v[18:19], v[34:35] op_sel:[0,0] op_sel_hi:[1,0]
    v_pk_mul_f32 v[20:21], v[20:21], v[34:35] op_sel:[0,0] op_sel_hi:[1,0]
    v_pk_mul_f32 v[22:23], v[22:23], v[34:35] op_sel:[0,0] op_sel_hi:[1,0]
    v_cvt_pk_bf16_f32 v72, v16, v17
    v_cvt_pk_bf16_f32 v73, v18, v19
    v_cvt_pk_bf16_f32 v74, v20, v21
    v_cvt_pk_bf16_f32 v75, v22, v23
    s_add_u32 s80, s100, 2048
    buffer_store_dwordx4 v[72:75], v10, s[48:51], s80 offen sc1
    v_accvgpr_read_b32 v24, a8
    v_accvgpr_read_b32 v25, a9
    v_accvgpr_read_b32 v26, a10
    v_accvgpr_read_b32 v27, a11
    v_accvgpr_read_b32 v28, a12
    v_accvgpr_read_b32 v29, a13
    v_accvgpr_read_b32 v30, a14
    v_accvgpr_read_b32 v31, a15
    v_pk_mul_f32 v[24:25], v[24:25], v[32:33] op_sel:[0,0] op_sel_hi:[1,0]
    v_pk_mul_f32 v[26:27], v[26:27], v[32:33] op_sel:[0,0] op_sel_hi:[1,0]
    v_pk_mul_f32 v[28:29], v[28:29], v[32:33] op_sel:[0,0] op_sel_hi:[1,0]
    v_pk_mul_f32 v[30:31], v[30:31], v[32:33] op_sel:[0,0] op_sel_hi:[1,0]
    v_cvt_pk_bf16_f32 v76, v24, v25
    v_cvt_pk_bf16_f32 v77, v26, v27
    v_cvt_pk_bf16_f32 v78, v28, v29
    v_cvt_pk_bf16_f32 v79, v30, v31
    s_add_u32 s80, s100, 12288
    buffer_store_dwordx4 v[76:79], v10, s[48:51], s80 offen sc1
    v_accvgpr_read_b32 v16, a40
    v_accvgpr_read_b32 v17, a41
    v_accvgpr_read_b32 v18, a42
    v_accvgpr_read_b32 v19, a43
    v_accvgpr_read_b32 v20, a44
    v_accvgpr_read_b32 v21, a45
    v_accvgpr_read_b32 v22, a46
    v_accvgpr_read_b32 v23, a47
    v_pk_mul_f32 v[16:17], v[16:17], v[32:33] op_sel:[0,1] op_sel_hi:[1,1]
    v_pk_mul_f32 v[18:19], v[18:19], v[32:33] op_sel:[0,1] op_sel_hi:[1,1]
    v_pk_mul_f32 v[20:21], v[20:21], v[32:33] op_sel:[0,1] op_sel_hi:[1,1]
    v_pk_mul_f32 v[22:23], v[22:23], v[32:33] op_sel:[0,1] op_sel_hi:[1,1]
    v_cvt_pk_bf16_f32 v80, v16, v17
    v_cvt_pk_bf16_f32 v81, v18, v19
    v_cvt_pk_bf16_f32 v82, v20, v21
    v_cvt_pk_bf16_f32 v83, v22, v23
    s_add_u32 s80, s100, 13312
    buffer_store_dwordx4 v[80:83], v10, s[48:51], s80 offen sc1
    v_accvgpr_read_b32 v24, a72
    v_accvgpr_read_b32 v25, a73
    v_accvgpr_read_b32 v26, a74
    v_accvgpr_read_b32 v27, a75
    v_accvgpr_read_b32 v28, a76
    v_accvgpr_read_b32 v29, a77
    v_accvgpr_read_b32 v30, a78
    v_accvgpr_read_b32 v31, a79
    v_pk_mul_f32 v[24:25], v[24:25], v[34:35] op_sel:[0,0] op_sel_hi:[1,0]
    v_pk_mul_f32 v[26:27], v[26:27], v[34:35] op_sel:[0,0] op_sel_hi:[1,0]
    v_pk_mul_f32 v[28:29], v[28:29], v[34:35] op_sel:[0,0] op_sel_hi:[1,0]
    v_pk_mul_f32 v[30:31], v[30:31], v[34:35] op_sel:[0,0] op_sel_hi:[1,0]
    v_cvt_pk_bf16_f32 v84, v24, v25
    v_cvt_pk_bf16_f32 v85, v26, v27
    v_cvt_pk_bf16_f32 v86, v28, v29
    v_cvt_pk_bf16_f32 v87, v30, v31
    s_add_u32 s80, s100, 14336
    buffer_store_dwordx4 v[84:87], v10, s[48:51], s80 offen sc1
    v_accvgpr_read_b32 v16, a96
    v_accvgpr_read_b32 v17, a97
    v_accvgpr_read_b32 v18, a98
    v_accvgpr_read_b32 v19, a99
    v_accvgpr_read_b32 v20, a100
    v_accvgpr_read_b32 v21, a101
    v_accvgpr_read_b32 v22, a102
    v_accvgpr_read_b32 v23, a103
    v_pk_mul_f32 v[16:17], v[16:17], v[34:35] op_sel:[0,1] op_sel_hi:[1,1]
    v_pk_mul_f32 v[18:19], v[18:19], v[34:35] op_sel:[0,1] op_sel_hi:[1,1]
    v_pk_mul_f32 v[20:21], v[20:21], v[34:35] op_sel:[0,1] op_sel_hi:[1,1]
    v_pk_mul_f32 v[22:23], v[22:23], v[34:35] op_sel:[0,1] op_sel_hi:[1,1]
    v_cvt_pk_bf16_f32 v160, v16, v17
    v_cvt_pk_bf16_f32 v161, v18, v19
    v_cvt_pk_bf16_f32 v162, v20, v21
    v_cvt_pk_bf16_f32 v163, v22, v23
    ds_write_b128 v244, v[160:163] offset:0
    s_add_u32 s80, s101, 0
    buffer_store_dwordx4 v[160:163], v10, s[48:51], s80 offen sc1
    v_accvgpr_read_b32 v24, a128
    v_accvgpr_read_b32 v25, a129
    v_accvgpr_read_b32 v26, a130
    v_accvgpr_read_b32 v27, a131
    v_accvgpr_read_b32 v28, a132
    v_accvgpr_read_b32 v29, a133
    v_accvgpr_read_b32 v30, a134
    v_accvgpr_read_b32 v31, a135
    v_pk_mul_f32 v[24:25], v[24:25], v[36:37] op_sel:[0,0] op_sel_hi:[1,0]
    v_pk_mul_f32 v[26:27], v[26:27], v[36:37] op_sel:[0,0] op_sel_hi:[1,0]
    v_pk_mul_f32 v[28:29], v[28:29], v[36:37] op_sel:[0,0] op_sel_hi:[1,0]
    v_pk_mul_f32 v[30:31], v[30:31], v[36:37] op_sel:[0,0] op_sel_hi:[1,0]
    v_cvt_pk_bf16_f32 v164, v24, v25
    v_cvt_pk_bf16_f32 v165, v26, v27
    v_cvt_pk_bf16_f32 v166, v28, v29
    v_cvt_pk_bf16_f32 v167, v30, v31
    ds_write_b128 v244, v[164:167] offset:1024
    s_add_u32 s80, s101, 1024
    buffer_store_dwordx4 v[164:167], v10, s[48:51], s80 offen sc1
    v_accvgpr_read_b32 v16, a160
    v_accvgpr_read_b32 v17, a161
    v_accvgpr_read_b32 v18, a162
    v_accvgpr_read_b32 v19, a163
    v_accvgpr_read_b32 v20, a164
    v_accvgpr_read_b32 v21, a165
    v_accvgpr_read_b32 v22, a166
    v_accvgpr_read_b32 v23, a167
    v_pk_mul_f32 v[16:17], v[16:17], v[36:37] op_sel:[0,1] op_sel_hi:[1,1]
    v_pk_mul_f32 v[18:19], v[18:19], v[36:37] op_sel:[0,1] op_sel_hi:[1,1]
    v_pk_mul_f32 v[20:21], v[20:21], v[36:37] op_sel:[0,1] op_sel_hi:[1,1]
    v_pk_mul_f32 v[22:23], v[22:23], v[36:37] op_sel:[0,1] op_sel_hi:[1,1]
    v_cvt_pk_bf16_f32 v168, v16, v17
    v_cvt_pk_bf16_f32 v169, v18, v19
    v_cvt_pk_bf16_f32 v170, v20, v21
    v_cvt_pk_bf16_f32 v171, v22, v23
    ds_write_b128 v244, v[168:171] offset:2048
    s_add_u32 s80, s101, 2048
    buffer_store_dwordx4 v[168:171], v10, s[48:51], s80 offen sc1
    v_accvgpr_read_b32 v24, a104
    v_accvgpr_read_b32 v25, a105
    v_accvgpr_read_b32 v26, a106
    v_accvgpr_read_b32 v27, a107
    v_accvgpr_read_b32 v28, a108
    v_accvgpr_read_b32 v29, a109
    v_accvgpr_read_b32 v30, a110
    v_accvgpr_read_b32 v31, a111
    v_pk_mul_f32 v[24:25], v[24:25], v[34:35] op_sel:[0,1] op_sel_hi:[1,1]
    v_pk_mul_f32 v[26:27], v[26:27], v[34:35] op_sel:[0,1] op_sel_hi:[1,1]
    v_pk_mul_f32 v[28:29], v[28:29], v[34:35] op_sel:[0,1] op_sel_hi:[1,1]
    v_pk_mul_f32 v[30:31], v[30:31], v[34:35] op_sel:[0,1] op_sel_hi:[1,1]
    v_cvt_pk_bf16_f32 v172, v24, v25
    v_cvt_pk_bf16_f32 v173, v26, v27
    v_cvt_pk_bf16_f32 v174, v28, v29
    v_cvt_pk_bf16_f32 v175, v30, v31
    ds_write_b128 v244, v[172:175] offset:3072
    s_add_u32 s80, s101, 12288
    buffer_store_dwordx4 v[172:175], v10, s[48:51], s80 offen sc1
    v_accvgpr_read_b32 v16, a136
    v_accvgpr_read_b32 v17, a137
    v_accvgpr_read_b32 v18, a138
    v_accvgpr_read_b32 v19, a139
    v_accvgpr_read_b32 v20, a140
    v_accvgpr_read_b32 v21, a141
    v_accvgpr_read_b32 v22, a142
    v_accvgpr_read_b32 v23, a143
    v_pk_mul_f32 v[16:17], v[16:17], v[36:37] op_sel:[0,0] op_sel_hi:[1,0]
    v_pk_mul_f32 v[18:19], v[18:19], v[36:37] op_sel:[0,0] op_sel_hi:[1,0]
    v_pk_mul_f32 v[20:21], v[20:21], v[36:37] op_sel:[0,0] op_sel_hi:[1,0]
    v_pk_mul_f32 v[22:23], v[22:23], v[36:37] op_sel:[0,0] op_sel_hi:[1,0]
    v_cvt_pk_bf16_f32 v176, v16, v17
    v_cvt_pk_bf16_f32 v177, v18, v19
    v_cvt_pk_bf16_f32 v178, v20, v21
    v_cvt_pk_bf16_f32 v179, v22, v23
    ds_write_b128 v244, v[176:179] offset:4096
    s_add_u32 s80, s101, 13312
    buffer_store_dwordx4 v[176:179], v10, s[48:51], s80 offen sc1
    v_accvgpr_read_b32 v24, a168
    v_accvgpr_read_b32 v25, a169
    v_accvgpr_read_b32 v26, a170
    v_accvgpr_read_b32 v27, a171
    v_accvgpr_read_b32 v28, a172
    v_accvgpr_read_b32 v29, a173
    v_accvgpr_read_b32 v30, a174
    v_accvgpr_read_b32 v31, a175
    v_pk_mul_f32 v[24:25], v[24:25], v[36:37] op_sel:[0,1] op_sel_hi:[1,1]
    v_pk_mul_f32 v[26:27], v[26:27], v[36:37] op_sel:[0,1] op_sel_hi:[1,1]
    v_pk_mul_f32 v[28:29], v[28:29], v[36:37] op_sel:[0,1] op_sel_hi:[1,1]
    v_pk_mul_f32 v[30:31], v[30:31], v[36:37] op_sel:[0,1] op_sel_hi:[1,1]
    v_cvt_pk_bf16_f32 v180, v24, v25
    v_cvt_pk_bf16_f32 v181, v26, v27
    v_cvt_pk_bf16_f32 v182, v28, v29
    v_cvt_pk_bf16_f32 v183, v30, v31
    ds_write_b128 v244, v[180:183] offset:5120
    s_add_u32 s80, s101, 14336
    buffer_store_dwordx4 v[180:183], v10, s[48:51], s80 offen sc1
    v_accvgpr_read_b32 v16, a112
    v_accvgpr_read_b32 v17, a113
    v_accvgpr_read_b32 v18, a114
    v_accvgpr_read_b32 v19, a115
    v_accvgpr_read_b32 v20, a116
    v_accvgpr_read_b32 v21, a117
    v_accvgpr_read_b32 v22, a118
    v_accvgpr_read_b32 v23, a119
    v_pk_mul_f32 v[16:17], v[16:17], v[34:35] op_sel:[0,1] op_sel_hi:[1,1]
    v_pk_mul_f32 v[18:19], v[18:19], v[34:35] op_sel:[0,1] op_sel_hi:[1,1]
    v_pk_mul_f32 v[20:21], v[20:21], v[34:35] op_sel:[0,1] op_sel_hi:[1,1]
    v_pk_mul_f32 v[22:23], v[22:23], v[34:35] op_sel:[0,1] op_sel_hi:[1,1]
    v_cvt_pk_bf16_f32 v184, v16, v17
    v_cvt_pk_bf16_f32 v185, v18, v19
    v_cvt_pk_bf16_f32 v186, v20, v21
    v_cvt_pk_bf16_f32 v187, v22, v23
    ds_write_b128 v244, v[184:187] offset:6144
    v_accvgpr_read_b32 v24, a144
    v_accvgpr_read_b32 v25, a145
    v_accvgpr_read_b32 v26, a146
    v_accvgpr_read_b32 v27, a147
    v_accvgpr_read_b32 v28, a148
    v_accvgpr_read_b32 v29, a149
    v_accvgpr_read_b32 v30, a150
    v_accvgpr_read_b32 v31, a151
    v_pk_mul_f32 v[24:25], v[24:25], v[36:37] op_sel:[0,0] op_sel_hi:[1,0]
    v_pk_mul_f32 v[26:27], v[26:27], v[36:37] op_sel:[0,0] op_sel_hi:[1,0]
    v_pk_mul_f32 v[28:29], v[28:29], v[36:37] op_sel:[0,0] op_sel_hi:[1,0]
    v_pk_mul_f32 v[30:31], v[30:31], v[36:37] op_sel:[0,0] op_sel_hi:[1,0]
    v_cvt_pk_bf16_f32 v188, v24, v25
    v_cvt_pk_bf16_f32 v189, v26, v27
    v_cvt_pk_bf16_f32 v190, v28, v29
    v_cvt_pk_bf16_f32 v191, v30, v31
    ds_write_b128 v244, v[188:191] offset:7168
    s_add_u32 s80, s101, 24576
    buffer_store_dwordx4 v[184:187], v10, s[48:51], s80 offen sc1
    v_accvgpr_read_b32 v16, a176
    v_accvgpr_read_b32 v17, a177
    v_accvgpr_read_b32 v18, a178
    v_accvgpr_read_b32 v19, a179
    v_accvgpr_read_b32 v20, a180
    v_accvgpr_read_b32 v21, a181
    v_accvgpr_read_b32 v22, a182
    v_accvgpr_read_b32 v23, a183
    v_pk_mul_f32 v[16:17], v[16:17], v[36:37] op_sel:[0,1] op_sel_hi:[1,1]
    v_pk_mul_f32 v[18:19], v[18:19], v[36:37] op_sel:[0,1] op_sel_hi:[1,1]
    v_pk_mul_f32 v[20:21], v[20:21], v[36:37] op_sel:[0,1] op_sel_hi:[1,1]
    v_pk_mul_f32 v[22:23], v[22:23], v[36:37] op_sel:[0,1] op_sel_hi:[1,1]
    v_cvt_pk_bf16_f32 v192, v16, v17
    v_cvt_pk_bf16_f32 v193, v18, v19
    v_cvt_pk_bf16_f32 v194, v20, v21
    v_cvt_pk_bf16_f32 v195, v22, v23
    ds_write_b128 v244, v[192:195] offset:8192
    v_accvgpr_read_b32 v24, a120
    v_accvgpr_read_b32 v25, a121
    v_accvgpr_read_b32 v26, a122
    v_accvgpr_read_b32 v27, a123
    v_accvgpr_read_b32 v28, a124
    v_accvgpr_read_b32 v29, a125
    v_accvgpr_read_b32 v30, a126
    v_accvgpr_read_b32 v31, a127
    v_pk_mul_f32 v[24:25], v[24:25], v[34:35] op_sel:[0,1] op_sel_hi:[1,1]
    v_pk_mul_f32 v[26:27], v[26:27], v[34:35] op_sel:[0,1] op_sel_hi:[1,1]
    v_pk_mul_f32 v[28:29], v[28:29], v[34:35] op_sel:[0,1] op_sel_hi:[1,1]
    v_pk_mul_f32 v[30:31], v[30:31], v[34:35] op_sel:[0,1] op_sel_hi:[1,1]
    v_cvt_pk_bf16_f32 v196, v24, v25
    v_cvt_pk_bf16_f32 v197, v26, v27
    v_cvt_pk_bf16_f32 v198, v28, v29
    v_cvt_pk_bf16_f32 v199, v30, v31
    ds_write_b128 v244, v[196:199] offset:9216
    v_accvgpr_read_b32 v16, a152
    v_accvgpr_read_b32 v17, a153
    v_accvgpr_read_b32 v18, a154
    v_accvgpr_read_b32 v19, a155
    v_accvgpr_read_b32 v20, a156
    v_accvgpr_read_b32 v21, a157
    v_accvgpr_read_b32 v22, a158
    v_accvgpr_read_b32 v23, a159
    v_pk_mul_f32 v[16:17], v[16:17], v[36:37] op_sel:[0,0] op_sel_hi:[1,0]
    v_pk_mul_f32 v[18:19], v[18:19], v[36:37] op_sel:[0,0] op_sel_hi:[1,0]
    v_pk_mul_f32 v[20:21], v[20:21], v[36:37] op_sel:[0,0] op_sel_hi:[1,0]
    v_pk_mul_f32 v[22:23], v[22:23], v[36:37] op_sel:[0,0] op_sel_hi:[1,0]
    v_cvt_pk_bf16_f32 v200, v16, v17
    v_cvt_pk_bf16_f32 v201, v18, v19
    v_cvt_pk_bf16_f32 v202, v20, v21
    v_cvt_pk_bf16_f32 v203, v22, v23
    ds_write_b128 v244, v[200:203] offset:10240
    s_add_u32 s80, s101, 25600
    buffer_store_dwordx4 v[188:191], v10, s[48:51], s80 offen sc1
    v_accvgpr_read_b32 v24, a184
    v_accvgpr_read_b32 v25, a185
    v_accvgpr_read_b32 v26, a186
    v_accvgpr_read_b32 v27, a187
    v_accvgpr_read_b32 v28, a188
    v_accvgpr_read_b32 v29, a189
    v_accvgpr_read_b32 v30, a190
    v_accvgpr_read_b32 v31, a191
    v_pk_mul_f32 v[24:25], v[24:25], v[36:37] op_sel:[0,1] op_sel_hi:[1,1]
    v_pk_mul_f32 v[26:27], v[26:27], v[36:37] op_sel:[0,1] op_sel_hi:[1,1]
    v_pk_mul_f32 v[28:29], v[28:29], v[36:37] op_sel:[0,1] op_sel_hi:[1,1]
    v_pk_mul_f32 v[30:31], v[30:31], v[36:37] op_sel:[0,1] op_sel_hi:[1,1]
    v_cvt_pk_bf16_f32 v204, v24, v25
    v_cvt_pk_bf16_f32 v205, v26, v27
    v_cvt_pk_bf16_f32 v206, v28, v29
    v_cvt_pk_bf16_f32 v207, v30, v31
    ds_write_b128 v244, v[204:207] offset:11264
    v_accvgpr_read_b32 v16, a16
    v_accvgpr_read_b32 v17, a17
    v_accvgpr_read_b32 v18, a18
    v_accvgpr_read_b32 v19, a19
    v_accvgpr_read_b32 v20, a20
    v_accvgpr_read_b32 v21, a21
    v_accvgpr_read_b32 v22, a22
    v_accvgpr_read_b32 v23, a23
    v_pk_mul_f32 v[16:17], v[16:17], v[32:33] op_sel:[0,0] op_sel_hi:[1,0]
    v_pk_mul_f32 v[18:19], v[18:19], v[32:33] op_sel:[0,0] op_sel_hi:[1,0]
    v_pk_mul_f32 v[20:21], v[20:21], v[32:33] op_sel:[0,0] op_sel_hi:[1,0]
    v_pk_mul_f32 v[22:23], v[22:23], v[32:33] op_sel:[0,0] op_sel_hi:[1,0]
    v_cvt_pk_bf16_f32 v88, v16, v17
    v_cvt_pk_bf16_f32 v89, v18, v19
    v_cvt_pk_bf16_f32 v90, v20, v21
    v_cvt_pk_bf16_f32 v91, v22, v23
    v_accvgpr_read_b32 v24, a48
    v_accvgpr_read_b32 v25, a49
    v_accvgpr_read_b32 v26, a50
    v_accvgpr_read_b32 v27, a51
    v_accvgpr_read_b32 v28, a52
    v_accvgpr_read_b32 v29, a53
    v_accvgpr_read_b32 v30, a54
    v_accvgpr_read_b32 v31, a55
    v_pk_mul_f32 v[24:25], v[24:25], v[32:33] op_sel:[0,1] op_sel_hi:[1,1]
    v_pk_mul_f32 v[26:27], v[26:27], v[32:33] op_sel:[0,1] op_sel_hi:[1,1]
    v_pk_mul_f32 v[28:29], v[28:29], v[32:33] op_sel:[0,1] op_sel_hi:[1,1]
    v_pk_mul_f32 v[30:31], v[30:31], v[32:33] op_sel:[0,1] op_sel_hi:[1,1]
    v_cvt_pk_bf16_f32 v92, v24, v25
    v_cvt_pk_bf16_f32 v93, v26, v27
    v_cvt_pk_bf16_f32 v94, v28, v29
    v_cvt_pk_bf16_f32 v95, v30, v31
    s_add_u32 s80, s101, 26624
    buffer_store_dwordx4 v[192:195], v10, s[48:51], s80 offen sc1
    s_waitcnt vmcnt(13) lgkmcnt(0)
    s_barrier
    ds_read_b128 v[112:115], v245 offset:0
    ds_read_b128 v[116:119], v245 offset:1024
    ds_read_b128 v[120:123], v245 offset:2048
    ds_read_b128 v[124:127], v245 offset:3072
    ds_read_b128 v[128:131], v245 offset:4096
    ds_read_b128 v[132:135], v245 offset:5120
    ds_read_b128 v[136:139], v245 offset:6144
    ds_read_b128 v[140:143], v245 offset:7168
    ds_read_b128 v[144:147], v245 offset:8192
    ds_read_b128 v[148:151], v245 offset:9216
    ds_read_b128 v[152:155], v245 offset:10240
    ds_read_b128 v[156:159], v245 offset:11264
    v_accvgpr_read_b32 v16, a80
    v_accvgpr_read_b32 v17, a81
    v_accvgpr_read_b32 v18, a82
    v_accvgpr_read_b32 v19, a83
    v_accvgpr_read_b32 v20, a84
    v_accvgpr_read_b32 v21, a85
    v_accvgpr_read_b32 v22, a86
    v_accvgpr_read_b32 v23, a87
    v_pk_mul_f32 v[16:17], v[16:17], v[34:35] op_sel:[0,0] op_sel_hi:[1,0]
    v_pk_mul_f32 v[18:19], v[18:19], v[34:35] op_sel:[0,0] op_sel_hi:[1,0]
    v_pk_mul_f32 v[20:21], v[20:21], v[34:35] op_sel:[0,0] op_sel_hi:[1,0]
    v_pk_mul_f32 v[22:23], v[22:23], v[34:35] op_sel:[0,0] op_sel_hi:[1,0]
    v_cvt_pk_bf16_f32 v96, v16, v17
    v_cvt_pk_bf16_f32 v97, v18, v19
    v_cvt_pk_bf16_f32 v98, v20, v21
    v_cvt_pk_bf16_f32 v99, v22, v23
    v_accvgpr_read_b32 v24, a24
    v_accvgpr_read_b32 v25, a25
    v_accvgpr_read_b32 v26, a26
    v_accvgpr_read_b32 v27, a27
    v_accvgpr_read_b32 v28, a28
    v_accvgpr_read_b32 v29, a29
    v_accvgpr_read_b32 v30, a30
    v_accvgpr_read_b32 v31, a31
    v_pk_mul_f32 v[24:25], v[24:25], v[32:33] op_sel:[0,0] op_sel_hi:[1,0]
    v_pk_mul_f32 v[26:27], v[26:27], v[32:33] op_sel:[0,0] op_sel_hi:[1,0]
    v_pk_mul_f32 v[28:29], v[28:29], v[32:33] op_sel:[0,0] op_sel_hi:[1,0]
    v_pk_mul_f32 v[30:31], v[30:31], v[32:33] op_sel:[0,0] op_sel_hi:[1,0]
    v_cvt_pk_bf16_f32 v100, v24, v25
    v_cvt_pk_bf16_f32 v101, v26, v27
    v_cvt_pk_bf16_f32 v102, v28, v29
    v_cvt_pk_bf16_f32 v103, v30, v31
    v_accvgpr_read_b32 v16, a56
    v_accvgpr_read_b32 v17, a57
    v_accvgpr_read_b32 v18, a58
    v_accvgpr_read_b32 v19, a59
    v_accvgpr_read_b32 v20, a60
    v_accvgpr_read_b32 v21, a61
    v_accvgpr_read_b32 v22, a62
    v_accvgpr_read_b32 v23, a63
    v_pk_mul_f32 v[16:17], v[16:17], v[32:33] op_sel:[0,1] op_sel_hi:[1,1]
    v_pk_mul_f32 v[18:19], v[18:19], v[32:33] op_sel:[0,1] op_sel_hi:[1,1]
    v_pk_mul_f32 v[20:21], v[20:21], v[32:33] op_sel:[0,1] op_sel_hi:[1,1]
    v_pk_mul_f32 v[22:23], v[22:23], v[32:33] op_sel:[0,1] op_sel_hi:[1,1]
    v_cvt_pk_bf16_f32 v104, v16, v17
    v_cvt_pk_bf16_f32 v105, v18, v19
    v_cvt_pk_bf16_f32 v106, v20, v21
    v_cvt_pk_bf16_f32 v107, v22, v23
    s_add_u32 s80, s101, 36864
    buffer_store_dwordx4 v[196:199], v10, s[48:51], s80 offen sc1
    v_accvgpr_read_b32 v24, a88
    v_accvgpr_read_b32 v25, a89
    v_accvgpr_read_b32 v26, a90
    v_accvgpr_read_b32 v27, a91
    v_accvgpr_read_b32 v28, a92
    v_accvgpr_read_b32 v29, a93
    v_accvgpr_read_b32 v30, a94
    v_accvgpr_read_b32 v31, a95
    v_pk_mul_f32 v[24:25], v[24:25], v[34:35] op_sel:[0,0] op_sel_hi:[1,0]
    v_pk_mul_f32 v[26:27], v[26:27], v[34:35] op_sel:[0,0] op_sel_hi:[1,0]
    v_pk_mul_f32 v[28:29], v[28:29], v[34:35] op_sel:[0,0] op_sel_hi:[1,0]
    v_pk_mul_f32 v[30:31], v[30:31], v[34:35] op_sel:[0,0] op_sel_hi:[1,0]
    v_cvt_pk_bf16_f32 v108, v24, v25
    v_cvt_pk_bf16_f32 v109, v26, v27
    v_cvt_pk_bf16_f32 v110, v28, v29
    v_cvt_pk_bf16_f32 v111, v30, v31
    v_lshrrev_b32 v246, 2, v0
    v_mul_u32_u24 v246, 288, v246
    v_and_b32 v12, 3, v0
    v_lshl_add_u32 v246, v12, 3, v246
    s_mul_i32 s55, s24, 36864
    v_add_u32 v7, s55, v246
    s_sub_u32 s55, 36864, s55
    v_add_u32 v8, s55, v246
    ds_read_b64_tr_b16 v[16:17], v7 offset:0
    ds_read_b64_tr_b16 v[18:19], v7 offset:4608
    ds_read_b64_tr_b16 v[20:21], v7 offset:32
    ds_read_b64_tr_b16 v[22:23], v7 offset:4640
    ds_read_b64_tr_b16 v[24:25], v7 offset:64
    ds_read_b64_tr_b16 v[26:27], v7 offset:4672
    ds_read_b64_tr_b16 v[28:29], v7 offset:96
    ds_read_b64_tr_b16 v[30:31], v7 offset:4704
    ds_read_b64_tr_b16 v[32:33], v7 offset:128
    ds_read_b64_tr_b16 v[34:35], v7 offset:4736
    ds_read_b64_tr_b16 v[36:37], v7 offset:160
    ds_read_b64_tr_b16 v[38:39], v7 offset:4768
    s_waitcnt  lgkmcnt(10)
    v_mfma_f32_16x16x32_bf16 a[0:3], v[16:19], v[64:67], 0
    ds_read_b64_tr_b16 v[40:41], v7 offset:192
    v_add_u32 v9, 73728, v246
    v_mfma_f32_16x16x32_bf16 a[36:39], v[16:19], v[68:71], 0
    v_add_u32 v11, 110592, v246
    v_min_u32 v12, 2, v0
    v_mfma_f32_16x16x32_bf16 a[72:75], v[16:19], v[72:75], 0
    s_waitcnt lgkmcnt(9)
    ds_read_b64_tr_b16 v[42:43], v7 offset:4800
    v_add_u32 v12, 1, v12
    v_mfma_f32_16x16x32_bf16 a[4:7], v[20:23], v[64:67], 0
    ds_read_b64_tr_b16 v[44:45], v7 offset:224
    v_add_u32 v254, s78, v12
    v_mfma_f32_16x16x32_bf16 a[40:43], v[20:23], v[68:71], 0
    v_and_b32 v254, 3, v254
    v_lshl_add_u32 v254, v254, 2, s22
    v_mfma_f32_16x16x32_bf16 a[76:79], v[20:23], v[72:75], 0
    s_waitcnt lgkmcnt(9)
    ds_read_b64_tr_b16 v[46:47], v7 offset:4832
    v_add_u32 v12, s20, v12
    v_mfma_f32_16x16x32_bf16 a[8:11], v[24:27], v[64:67], 0
    s_add_u32 s80, s101, 37888
    ds_read_b64_tr_b16 v[16:17], v7 offset:256
    v_and_b32 v12, 3, v12
    v_mfma_f32_16x16x32_bf16 a[44:47], v[24:27], v[68:71], 0
    buffer_store_dwordx4 v[200:203], v10, s[48:51], s80 offen sc1
    v_lshl_add_u32 v12, v12, 2, s23
    v_mfma_f32_16x16x32_bf16 a[80:83], v[24:27], v[72:75], 0
    s_waitcnt lgkmcnt(9)
    ds_read_b64_tr_b16 v[18:19], v7 offset:4864
    v_and_b32 v3, 15, v0
    s_barrier
    v_mfma_f32_16x16x32_bf16 a[12:15], v[28:31], v[64:67], 0
    ds_read_b64_tr_b16 v[20:21], v7 offset:9216
    v_mul_u32_u24 v3, 1152, v3
    v_mfma_f32_16x16x32_bf16 a[48:51], v[28:31], v[68:71], 0
    v_lshrrev_b32 v250, 4, v0
    v_lshl_add_u32 v3, v250, 3, v3
    v_mfma_f32_16x16x32_bf16 a[84:87], v[28:31], v[72:75], 0
    s_waitcnt lgkmcnt(9)
    ds_read_b64_tr_b16 v[22:23], v7 offset:13824
    v_mfma_f32_16x16x32_bf16 a[16:19], v[32:35], v[64:67], 0
    s_cmp_le_u32 s78, 1
    s_cselect_b32 s58, 2, 1
    s_lshl_b32 s58, s58, 3
    s_add_u32 s58, s58, s79
    s_add_u32 s58, s58, 0
    s_mul_i32 s58, s58, 36864
    s_add_u32 m0, s59, 110592
    ds_read_b64_tr_b16 v[24:25], v7 offset:9248
    v_mfma_f32_16x16x32_bf16 a[52:55], v[32:35], v[68:71], 0
    buffer_load_dwordx4 v1, s[72:75], s58 offen sc1 lds
    v_mfma_f32_16x16x32_bf16 a[88:91], v[32:35], v[72:75], 0
    s_waitcnt lgkmcnt(9)
    ds_read_b64_tr_b16 v[26:27], v7 offset:13856
    v_mfma_f32_16x16x32_bf16 a[20:23], v[36:39], v[64:67], 0
    s_add_u32 s80, s101, 38912
    ds_read_b64_tr_b16 v[28:29], v7 offset:9280
    v_mfma_f32_16x16x32_bf16 a[56:59], v[36:39], v[68:71], 0
    buffer_store_dwordx4 v[204:207], v10, s[48:51], s80 offen sc1
    v_mfma_f32_16x16x32_bf16 a[92:95], v[36:39], v[72:75], 0
    s_waitcnt lgkmcnt(9)
    ds_read_b64_tr_b16 v[30:31], v7 offset:13888
    v_mfma_f32_16x16x32_bf16 a[24:27], v[40:43], v[64:67], 0
    ds_read_b64_tr_b16 v[32:33], v7 offset:9312
    v_mfma_f32_16x16x32_bf16 a[60:63], v[40:43], v[68:71], 0
    v_mfma_f32_16x16x32_bf16 a[96:99], v[40:43], v[72:75], 0
    s_waitcnt lgkmcnt(9)
    ds_read_b64_tr_b16 v[34:35], v7 offset:13920
    v_mfma_f32_16x16x32_bf16 a[28:31], v[44:47], v[64:67], 0
    s_add_u32 m0, s59, 111616
    ds_read_b64_tr_b16 v[36:37], v7 offset:9344
    v_mfma_f32_16x16x32_bf16 a[64:67], v[44:47], v[68:71], 0
    buffer_load_dwordx4 v2, s[72:75], s58 offen sc1 lds
    v_mfma_f32_16x16x32_bf16 a[100:103], v[44:47], v[72:75], 0
    s_waitcnt lgkmcnt(9)
    ds_read_b64_tr_b16 v[38:39], v7 offset:13952
    v_mfma_f32_16x16x32_bf16 a[32:35], v[16:19], v[64:67], 0
    s_add_u32 s80, s100, 24576
    ds_read_b64_tr_b16 v[40:41], v7 offset:9376
    v_mfma_f32_16x16x32_bf16 a[68:71], v[16:19], v[68:71], 0
    buffer_store_dwordx4 v[88:91], v10, s[48:51], s80 offen sc1
    v_mfma_f32_16x16x32_bf16 a[104:107], v[16:19], v[72:75], 0
    s_waitcnt lgkmcnt(9)
    ds_read_b64_tr_b16 v[42:43], v7 offset:13984
    v_mfma_f32_16x16x32_bf16 a[0:3], v[20:23], v[76:79], a[0:3]
    ds_read_b64_tr_b16 v[44:45], v7 offset:9408
    v_mfma_f32_16x16x32_bf16 a[36:39], v[20:23], v[80:83], a[36:39]
    v_mfma_f32_16x16x32_bf16 a[72:75], v[20:23], v[84:87], a[72:75]
    s_waitcnt lgkmcnt(9)
    ds_read_b64_tr_b16 v[46:47], v7 offset:14016
    v_mfma_f32_16x16x32_bf16 a[4:7], v[24:27], v[76:79], a[4:7]
    s_add_u32 m0, s59, 112640
    ds_read_b64_tr_b16 v[16:17], v7 offset:9440
    v_mfma_f32_16x16x32_bf16 a[40:43], v[24:27], v[80:83], a[40:43]
    buffer_load_dwordx4 v4, s[72:75], s58 offen sc1 lds
    v_mfma_f32_16x16x32_bf16 a[76:79], v[24:27], v[84:87], a[76:79]
    s_waitcnt lgkmcnt(9)
    ds_read_b64_tr_b16 v[18:19], v7 offset:14048
    v_mfma_f32_16x16x32_bf16 a[8:11], v[28:31], v[76:79], a[8:11]
    s_add_u32 s80, s100, 25600
    ds_read_b64_tr_b16 v[20:21], v7 offset:9472
    v_mfma_f32_16x16x32_bf16 a[44:47], v[28:31], v[80:83], a[44:47]
    buffer_store_dwordx4 v[92:95], v10, s[48:51], s80 offen sc1
    v_mfma_f32_16x16x32_bf16 a[80:83], v[28:31], v[84:87], a[80:83]
    s_waitcnt lgkmcnt(9)
    ds_read_b64_tr_b16 v[22:23], v7 offset:14080
    s_waitcnt vmcnt(11)
    s_barrier
    s_cmp_eq_u32 s52, 0
    s_cbranch_scc1 L_flag1
L_flag1_back:
    v_mfma_f32_16x16x32_bf16 a[12:15], v[32:35], v[76:79], a[12:15]
    ds_read_b64_tr_b16 v[24:25], v7 offset:18432
    v_mfma_f32_16x16x32_bf16 a[48:51], v[32:35], v[80:83], a[48:51]
    v_mfma_f32_16x16x32_bf16 a[84:87], v[32:35], v[84:87], a[84:87]
    s_waitcnt lgkmcnt(9)
    ds_read_b64_tr_b16 v[26:27], v7 offset:23040
    v_mfma_f32_16x16x32_bf16 a[16:19], v[36:39], v[76:79], a[16:19]
    s_add_u32 m0, s59, 113664
    ds_read_b64_tr_b16 v[28:29], v7 offset:18464
    v_mfma_f32_16x16x32_bf16 a[52:55], v[36:39], v[80:83], a[52:55]
    buffer_load_dwordx4 v5, s[72:75], s58 offen sc1 lds
    v_mfma_f32_16x16x32_bf16 a[88:91], v[36:39], v[84:87], a[88:91]
    s_waitcnt lgkmcnt(9)
    ds_read_b64_tr_b16 v[30:31], v7 offset:23072
    v_mfma_f32_16x16x32_bf16 a[20:23], v[40:43], v[76:79], a[20:23]
    s_add_u32 s80, s100, 26624
    ds_read_b64_tr_b16 v[32:33], v7 offset:18496
    v_mfma_f32_16x16x32_bf16 a[56:59], v[40:43], v[80:83], a[56:59]
    buffer_store_dwordx4 v[96:99], v10, s[48:51], s80 offen sc1
    v_mfma_f32_16x16x32_bf16 a[92:95], v[40:43], v[84:87], a[92:95]
    s_waitcnt lgkmcnt(9)
    ds_read_b64_tr_b16 v[34:35], v7 offset:23104
    v_mfma_f32_16x16x32_bf16 a[24:27], v[44:47], v[76:79], a[24:27]
    ds_read_b64_tr_b16 v[36:37], v7 offset:18528
    v_mfma_f32_16x16x32_bf16 a[60:63], v[44:47], v[80:83], a[60:63]
    v_mfma_f32_16x16x32_bf16 a[96:99], v[44:47], v[84:87], a[96:99]
    s_waitcnt lgkmcnt(9)
    ds_read_b64_tr_b16 v[38:39], v7 offset:23136
    v_mfma_f32_16x16x32_bf16 a[28:31], v[16:19], v[76:79], a[28:31]
    s_add_u32 m0, s59, 114688
    ds_read_b64_tr_b16 v[40:41], v7 offset:18560
    v_mfma_f32_16x16x32_bf16 a[64:67], v[16:19], v[80:83], a[64:67]
    buffer_load_dwordx4 v6, s[72:75], s58 offen sc1 lds
    v_mfma_f32_16x16x32_bf16 a[100:103], v[16:19], v[84:87], a[100:103]
    s_waitcnt lgkmcnt(9)
    ds_read_b64_tr_b16 v[42:43], v7 offset:23168
    v_mfma_f32_16x16x32_bf16 a[32:35], v[20:23], v[76:79], a[32:35]
    s_add_u32 s80, s100, 36864
    ds_read_b64_tr_b16 v[44:45], v7 offset:18592
    v_mfma_f32_16x16x32_bf16 a[68:71], v[20:23], v[80:83], a[68:71]
    buffer_store_dwordx4 v[100:103], v10, s[48:51], s80 offen sc1
    v_mfma_f32_16x16x32_bf16 a[104:107], v[20:23], v[84:87], a[104:107]
    s_waitcnt lgkmcnt(9)
    ds_read_b64_tr_b16 v[46:47], v7 offset:23200
    v_mfma_f32_16x16x32_bf16 a[0:3], v[24:27], v[88:91], a[0:3]
    ds_read_b64_tr_b16 v[16:17], v7 offset:18624
    v_mfma_f32_16x16x32_bf16 a[36:39], v[24:27], v[92:95], a[36:39]
    v_mfma_f32_16x16x32_bf16 a[72:75], v[24:27], v[96:99], a[72:75]
    s_waitcnt lgkmcnt(9)
    ds_read_b64_tr_b16 v[18:19], v7 offset:23232
    v_mfma_f32_16x16x32_bf16 a[4:7], v[28:31], v[88:91], a[4:7]
    s_add_u32 m0, s59, 115712
    ds_read_b64_tr_b16 v[20:21], v7 offset:18656
    v_mfma_f32_16x16x32_bf16 a[40:43], v[28:31], v[92:95], a[40:43]
    buffer_load_dwordx4 v13, s[72:75], s58 offen sc1 lds
    v_mfma_f32_16x16x32_bf16 a[76:79], v[28:31], v[96:99], a[76:79]
    s_waitcnt lgkmcnt(9)
    ds_read_b64_tr_b16 v[22:23], v7 offset:23264
    v_mfma_f32_16x16x32_bf16 a[8:11], v[32:35], v[88:91], a[8:11]
    s_add_u32 s80, s100, 37888
    ds_read_b64_tr_b16 v[24:25], v7 offset:18688
    v_mfma_f32_16x16x32_bf16 a[44:47], v[32:35], v[92:95], a[44:47]
    buffer_store_dwordx4 v[104:107], v10, s[48:51], s80 offen sc1
    v_mfma_f32_16x16x32_bf16 a[80:83], v[32:35], v[96:99], a[80:83]
    s_waitcnt lgkmcnt(9)
    ds_read_b64_tr_b16 v[26:27], v7 offset:23296
    v_mfma_f32_16x16x32_bf16 a[12:15], v[36:39], v[88:91], a[12:15]
    ds_read_b64_tr_b16 v[28:29], v7 offset:27648
    v_mfma_f32_16x16x32_bf16 a[48:51], v[36:39], v[92:95], a[48:51]
    v_mfma_f32_16x16x32_bf16 a[84:87], v[36:39], v[96:99], a[84:87]
    s_waitcnt lgkmcnt(9)
    ds_read_b64_tr_b16 v[30:31], v7 offset:32256
    v_mfma_f32_16x16x32_bf16 a[16:19], v[40:43], v[88:91], a[16:19]
    s_add_u32 m0, s59, 116736
    ds_read_b64_tr_b16 v[32:33], v7 offset:27680
    v_mfma_f32_16x16x32_bf16 a[52:55], v[40:43], v[92:95], a[52:55]
    buffer_load_dwordx4 v14, s[72:75], s58 offen sc1 lds
    v_mfma_f32_16x16x32_bf16 a[88:91], v[40:43], v[96:99], a[88:91]
    s_waitcnt lgkmcnt(9)
    ds_read_b64_tr_b16 v[34:35], v7 offset:32288
    v_mfma_f32_16x16x32_bf16 a[20:23], v[44:47], v[88:91], a[20:23]
    s_add_u32 s80, s100, 38912
    ds_read_b64_tr_b16 v[36:37], v7 offset:27712
    v_mfma_f32_16x16x32_bf16 a[56:59], v[44:47], v[92:95], a[56:59]
    buffer_store_dwordx4 v[108:111], v10, s[48:51], s80 offen sc1
    v_mfma_f32_16x16x32_bf16 a[92:95], v[44:47], v[96:99], a[92:95]
    s_waitcnt lgkmcnt(9)
    ds_read_b64_tr_b16 v[38:39], v7 offset:32320
    v_mfma_f32_16x16x32_bf16 a[24:27], v[16:19], v[88:91], a[24:27]
    ds_read_b64_tr_b16 v[40:41], v7 offset:27744
    v_mfma_f32_16x16x32_bf16 a[60:63], v[16:19], v[92:95], a[60:63]
    v_mfma_f32_16x16x32_bf16 a[96:99], v[16:19], v[96:99], a[96:99]
    s_waitcnt lgkmcnt(9)
    ds_read_b64_tr_b16 v[42:43], v7 offset:32352
    v_mfma_f32_16x16x32_bf16 a[28:31], v[20:23], v[88:91], a[28:31]
    s_add_u32 m0, s59, 117760
    ds_read_b64_tr_b16 v[44:45], v7 offset:27776
    v_mfma_f32_16x16x32_bf16 a[64:67], v[20:23], v[92:95], a[64:67]
    buffer_load_dwordx4 v15, s[72:75], s58 offen sc1 lds
    v_mfma_f32_16x16x32_bf16 a[100:103], v[20:23], v[96:99], a[100:103]
    s_waitcnt lgkmcnt(9)
    ds_read_b64_tr_b16 v[46:47], v7 offset:32384
    v_mfma_f32_16x16x32_bf16 a[32:35], v[24:27], v[88:91], a[32:35]
    ds_read_b64_tr_b16 v[16:17], v7 offset:27808
    v_mfma_f32_16x16x32_bf16 a[68:71], v[24:27], v[92:95], a[68:71]
    v_mfma_f32_16x16x32_bf16 a[104:107], v[24:27], v[96:99], a[104:107]
    s_waitcnt lgkmcnt(9)
    ds_read_b64_tr_b16 v[18:19], v7 offset:32416
    v_mfma_f32_16x16x32_bf16 a[0:3], v[28:31], v[100:103], a[0:3]
    ds_read_b64_tr_b16 v[20:21], v7 offset:27840
    v_mfma_f32_16x16x32_bf16 a[36:39], v[28:31], v[104:107], a[36:39]
    v_mfma_f32_16x16x32_bf16 a[72:75], v[28:31], v[108:111], a[72:75]
    s_waitcnt lgkmcnt(9)
    ds_read_b64_tr_b16 v[22:23], v7 offset:32448
    v_mfma_f32_16x16x32_bf16 a[4:7], v[32:35], v[100:103], a[4:7]
    s_add_u32 m0, s59, 118784
    ds_read_b64_tr_b16 v[24:25], v7 offset:27872
    v_mfma_f32_16x16x32_bf16 a[40:43], v[32:35], v[104:107], a[40:43]
    buffer_load_dwordx4 v251, s[72:75], s58 offen sc1 lds
    v_mfma_f32_16x16x32_bf16 a[76:79], v[32:35], v[108:111], a[76:79]
    s_waitcnt lgkmcnt(9)
    ds_read_b64_tr_b16 v[26:27], v7 offset:32480
    v_mfma_f32_16x16x32_bf16 a[8:11], v[36:39], v[100:103], a[8:11]
    ds_read_b64_tr_b16 v[28:29], v7 offset:27904
    v_mfma_f32_16x16x32_bf16 a[44:47], v[36:39], v[104:107], a[44:47]
    v_mfma_f32_16x16x32_bf16 a[80:83], v[36:39], v[108:111], a[80:83]
    s_waitcnt lgkmcnt(9)
    ds_read_b64_tr_b16 v[30:31], v7 offset:32512
    v_mfma_f32_16x16x32_bf16 a[12:15], v[40:43], v[100:103], a[12:15]
    ds_read_b64_tr_b16 v[32:33], v8 offset:0
    v_mfma_f32_16x16x32_bf16 a[48:51], v[40:43], v[104:107], a[48:51]
    v_mfma_f32_16x16x32_bf16 a[84:87], v[40:43], v[108:111], a[84:87]
    s_waitcnt lgkmcnt(9)
    ds_read_b64_tr_b16 v[34:35], v8 offset:4608
    v_mfma_f32_16x16x32_bf16 a[16:19], v[44:47], v[100:103], a[16:19]
    ds_read_b64_tr_b16 v[36:37], v8 offset:32
    v_mfma_f32_16x16x32_bf16 a[52:55], v[44:47], v[104:107], a[52:55]
    v_mfma_f32_16x16x32_bf16 a[88:91], v[44:47], v[108:111], a[88:91]
    s_waitcnt lgkmcnt(9)
    ds_read_b64_tr_b16 v[38:39], v8 offset:4640
    v_mfma_f32_16x16x32_bf16 a[20:23], v[16:19], v[100:103], a[20:23]
    ds_read_b64_tr_b16 v[40:41], v8 offset:64
    v_mfma_f32_16x16x32_bf16 a[56:59], v[16:19], v[104:107], a[56:59]
    global_load_dword v255, v254, s[76:77] sc1
    v_mfma_f32_16x16x32_bf16 a[92:95], v[16:19], v[108:111], a[92:95]
    s_waitcnt lgkmcnt(9)
    ds_read_b64_tr_b16 v[42:43], v8 offset:4672
    v_mfma_f32_16x16x32_bf16 a[24:27], v[20:23], v[100:103], a[24:27]
    ds_read_b64_tr_b16 v[44:45], v8 offset:96
    v_mfma_f32_16x16x32_bf16 a[60:63], v[20:23], v[104:107], a[60:63]
    v_mfma_f32_16x16x32_bf16 a[96:99], v[20:23], v[108:111], a[96:99]
    s_waitcnt lgkmcnt(9)
    ds_read_b64_tr_b16 v[46:47], v8 offset:4704
    v_mfma_f32_16x16x32_bf16 a[28:31], v[24:27], v[100:103], a[28:31]
    ds_read_b64_tr_b16 v[16:17], v8 offset:128
    v_mfma_f32_16x16x32_bf16 a[64:67], v[24:27], v[104:107], a[64:67]
    v_mfma_f32_16x16x32_bf16 a[100:103], v[24:27], v[108:111], a[100:103]
    s_waitcnt lgkmcnt(9)
    ds_read_b64_tr_b16 v[18:19], v8 offset:4736
    v_mfma_f32_16x16x32_bf16 a[32:35], v[28:31], v[100:103], a[32:35]
    ds_read_b64_tr_b16 v[20:21], v8 offset:160
    v_mfma_f32_16x16x32_bf16 a[68:71], v[28:31], v[104:107], a[68:71]
    v_mfma_f32_16x16x32_bf16 a[104:107], v[28:31], v[108:111], a[104:107]
    s_waitcnt lgkmcnt(9)
    ds_read_b64_tr_b16 v[22:23], v8 offset:4768
    v_mfma_f32_16x16x32_bf16 a[0:3], v[32:35], v[112:115], a[0:3]
    ds_read_b64_tr_b16 v[24:25], v8 offset:192
    v_mfma_f32_16x16x32_bf16 a[36:39], v[32:35], v[116:119], a[36:39]
    v_mfma_f32_16x16x32_bf16 a[72:75], v[32:35], v[120:123], a[72:75]
    s_waitcnt lgkmcnt(9)
    ds_read_b64_tr_b16 v[26:27], v8 offset:4800
    v_mfma_f32_16x16x32_bf16 a[4:7], v[36:39], v[112:115], a[4:7]
    ds_read_b64_tr_b16 v[28:29], v8 offset:224
    v_mfma_f32_16x16x32_bf16 a[40:43], v[36:39], v[116:119], a[40:43]
    v_mfma_f32_16x16x32_bf16 a[76:79], v[36:39], v[120:123], a[76:79]
    s_waitcnt lgkmcnt(9)
    ds_read_b64_tr_b16 v[30:31], v8 offset:4832
    v_mfma_f32_16x16x32_bf16 a[8:11], v[40:43], v[112:115], a[8:11]
    ds_read_b64_tr_b16 v[32:33], v8 offset:256
    v_mfma_f32_16x16x32_bf16 a[44:47], v[40:43], v[116:119], a[44:47]
    v_mfma_f32_16x16x32_bf16 a[80:83], v[40:43], v[120:123], a[80:83]
    s_waitcnt lgkmcnt(9)
    ds_read_b64_tr_b16 v[34:35], v8 offset:4864
    v_mfma_f32_16x16x32_bf16 a[12:15], v[44:47], v[112:115], a[12:15]
    ds_read_b64_tr_b16 v[36:37], v8 offset:9216
    v_mfma_f32_16x16x32_bf16 a[48:51], v[44:47], v[116:119], a[48:51]
    v_mfma_f32_16x16x32_bf16 a[84:87], v[44:47], v[120:123], a[84:87]
    s_waitcnt lgkmcnt(9)
    ds_read_b64_tr_b16 v[38:39], v8 offset:13824
    v_mfma_f32_16x16x32_bf16 a[16:19], v[16:19], v[112:115], a[16:19]
    ds_read_b64_tr_b16 v[40:41], v8 offset:9248
    v_mfma_f32_16x16x32_bf16 a[52:55], v[16:19], v[116:119], a[52:55]
    v_mfma_f32_16x16x32_bf16 a[88:91], v[16:19], v[120:123], a[88:91]
    s_waitcnt lgkmcnt(9)
    ds_read_b64_tr_b16 v[42:43], v8 offset:13856
    v_mfma_f32_16x16x32_bf16 a[20:23], v[20:23], v[112:115], a[20:23]
    ds_read_b64_tr_b16 v[44:45], v8 offset:9280
    v_mfma_f32_16x16x32_bf16 a[56:59], v[20:23], v[116:119], a[56:59]
    v_mfma_f32_16x16x32_bf16 a[92:95], v[20:23], v[120:123], a[92:95]
    s_waitcnt lgkmcnt(9)
    ds_read_b64_tr_b16 v[46:47], v8 offset:13888
    v_mfma_f32_16x16x32_bf16 a[24:27], v[24:27], v[112:115], a[24:27]
    ds_read_b64_tr_b16 v[16:17], v8 offset:9312
    v_mfma_f32_16x16x32_bf16 a[60:63], v[24:27], v[116:119], a[60:63]
    v_mfma_f32_16x16x32_bf16 a[96:99], v[24:27], v[120:123], a[96:99]
    s_waitcnt lgkmcnt(9)
    ds_read_b64_tr_b16 v[18:19], v8 offset:13920
    v_mfma_f32_16x16x32_bf16 a[28:31], v[28:31], v[112:115], a[28:31]
    ds_read_b64_tr_b16 v[20:21], v8 offset:9344
    v_mfma_f32_16x16x32_bf16 a[64:67], v[28:31], v[116:119], a[64:67]
    v_mfma_f32_16x16x32_bf16 a[100:103], v[28:31], v[120:123], a[100:103]
    s_waitcnt lgkmcnt(9)
    ds_read_b64_tr_b16 v[22:23], v8 offset:13952
    s_waitcnt vmcnt(0)
    v_cmp_gt_u32 vcc, 1, v255
    s_cbranch_vccnz L_spin1
L_spin1_back:
    v_mfma_f32_16x16x32_bf16 a[32:35], v[32:35], v[112:115], a[32:35]
    s_cmp_le_u32 s78, 0
    s_cselect_b32 s26, 1, 0
    s_mul_i32 s26, s26, 98304
    s_add_u32 s26, s26, s25
    ds_read_b64_tr_b16 v[24:25], v8 offset:9376
    v_mfma_f32_16x16x32_bf16 a[68:71], v[32:35], v[116:119], a[68:71]
    buffer_load_dwordx4 a[108:111], v10, s[48:51], s26 offen offset:0 sc1
    v_mfma_f32_16x16x32_bf16 a[104:107], v[32:35], v[120:123], a[104:107]
    s_waitcnt lgkmcnt(9)
    ds_read_b64_tr_b16 v[26:27], v8 offset:13984
    v_mfma_f32_16x16x32_bf16 a[0:3], v[36:39], v[124:127], a[0:3]
    ds_read_b64_tr_b16 v[28:29], v8 offset:9408
    v_mfma_f32_16x16x32_bf16 a[36:39], v[36:39], v[128:131], a[36:39]
    v_mfma_f32_16x16x32_bf16 a[72:75], v[36:39], v[132:135], a[72:75]
    s_waitcnt lgkmcnt(9)
    ds_read_b64_tr_b16 v[30:31], v8 offset:14016
    v_mfma_f32_16x16x32_bf16 a[4:7], v[40:43], v[124:127], a[4:7]
    ds_read_b64_tr_b16 v[32:33], v8 offset:9440
    v_mfma_f32_16x16x32_bf16 a[40:43], v[40:43], v[128:131], a[40:43]
    buffer_load_dwordx4 a[112:115], v10, s[48:51], s26 offen offset:1024 sc1
    v_mfma_f32_16x16x32_bf16 a[76:79], v[40:43], v[132:135], a[76:79]
    s_waitcnt lgkmcnt(9)
    ds_read_b64_tr_b16 v[34:35], v8 offset:14048
    v_mfma_f32_16x16x32_bf16 a[8:11], v[44:47], v[124:127], a[8:11]
    ds_read_b64_tr_b16 v[36:37], v8 offset:9472
    v_mfma_f32_16x16x32_bf16 a[44:47], v[44:47], v[128:131], a[44:47]
    buffer_load_dwordx4 a[116:119], v10, s[48:51], s26 offen offset:2048 sc1
    v_mfma_f32_16x16x32_bf16 a[80:83], v[44:47], v[132:135], a[80:83]
    s_waitcnt lgkmcnt(9)
    ds_read_b64_tr_b16 v[38:39], v8 offset:14080
    v_mfma_f32_16x16x32_bf16 a[12:15], v[16:19], v[124:127], a[12:15]
    ds_read_b64_tr_b16 v[40:41], v8 offset:18432
    v_mfma_f32_16x16x32_bf16 a[48:51], v[16:19], v[128:131], a[48:51]
    v_mfma_f32_16x16x32_bf16 a[84:87], v[16:19], v[132:135], a[84:87]
    s_waitcnt lgkmcnt(9)
    ds_read_b64_tr_b16 v[42:43], v8 offset:23040
    v_mfma_f32_16x16x32_bf16 a[16:19], v[20:23], v[124:127], a[16:19]
    s_add_u32 s26, s26, 12288
    ds_read_b64_tr_b16 v[44:45], v8 offset:18464
    v_mfma_f32_16x16x32_bf16 a[52:55], v[20:23], v[128:131], a[52:55]
    buffer_load_dwordx4 a[120:123], v10, s[48:51], s26 offen offset:0 sc1
    v_mfma_f32_16x16x32_bf16 a[88:91], v[20:23], v[132:135], a[88:91]
    s_waitcnt lgkmcnt(9)
    ds_read_b64_tr_b16 v[46:47], v8 offset:23072
    v_mfma_f32_16x16x32_bf16 a[20:23], v[24:27], v[124:127], a[20:23]
    ds_read_b64_tr_b16 v[16:17], v8 offset:18496
    v_mfma_f32_16x16x32_bf16 a[56:59], v[24:27], v[128:131], a[56:59]
    buffer_load_dwordx4 a[124:127], v10, s[48:51], s26 offen offset:1024 sc1
    v_mfma_f32_16x16x32_bf16 a[92:95], v[24:27], v[132:135], a[92:95]
    s_waitcnt lgkmcnt(9)
    ds_read_b64_tr_b16 v[18:19], v8 offset:23104
    v_mfma_f32_16x16x32_bf16 a[24:27], v[28:31], v[124:127], a[24:27]
    ds_read_b64_tr_b16 v[20:21], v8 offset:18528
    v_mfma_f32_16x16x32_bf16 a[60:63], v[28:31], v[128:131], a[60:63]
    v_mfma_f32_16x16x32_bf16 a[96:99], v[28:31], v[132:135], a[96:99]
    s_waitcnt lgkmcnt(9)
    ds_read_b64_tr_b16 v[22:23], v8 offset:23136
    v_mfma_f32_16x16x32_bf16 a[28:31], v[32:35], v[124:127], a[28:31]
    ds_read_b64_tr_b16 v[24:25], v8 offset:18560
    v_mfma_f32_16x16x32_bf16 a[64:67], v[32:35], v[128:131], a[64:67]
    buffer_load_dwordx4 a[128:131], v10, s[48:51], s26 offen offset:2048 sc1
    v_mfma_f32_16x16x32_bf16 a[100:103], v[32:35], v[132:135], a[100:103]
    s_waitcnt lgkmcnt(9)
    ds_read_b64_tr_b16 v[26:27], v8 offset:23168
    v_mfma_f32_16x16x32_bf16 a[32:35], v[36:39], v[124:127], a[32:35]
    s_add_u32 s26, s26, 36864
    ds_read_b64_tr_b16 v[28:29], v8 offset:18592
    v_mfma_f32_16x16x32_bf16 a[68:71], v[36:39], v[128:131], a[68:71]
    buffer_load_dwordx4 a[132:135], v10, s[48:51], s26 offen offset:0 sc1
    v_mfma_f32_16x16x32_bf16 a[104:107], v[36:39], v[132:135], a[104:107]
    s_waitcnt lgkmcnt(9)
    ds_read_b64_tr_b16 v[30:31], v8 offset:23200
    v_mfma_f32_16x16x32_bf16 a[0:3], v[40:43], v[136:139], a[0:3]
    ds_read_b64_tr_b16 v[32:33], v8 offset:18624
    v_mfma_f32_16x16x32_bf16 a[36:39], v[40:43], v[140:143], a[36:39]
    v_mfma_f32_16x16x32_bf16 a[72:75], v[40:43], v[144:147], a[72:75]
    s_waitcnt lgkmcnt(9)
    ds_read_b64_tr_b16 v[34:35], v8 offset:23232
    v_mfma_f32_16x16x32_bf16 a[4:7], v[44:47], v[136:139], a[4:7]
    ds_read_b64_tr_b16 v[36:37], v8 offset:18656
    v_mfma_f32_16x16x32_bf16 a[40:43], v[44:47], v[140:143], a[40:43]
    buffer_load_dwordx4 a[136:139], v10, s[48:51], s26 offen offset:1024 sc1
    v_mfma_f32_16x16x32_bf16 a[76:79], v[44:47], v[144:147], a[76:79]
    s_waitcnt lgkmcnt(9)
    ds_read_b64_tr_b16 v[38:39], v8 offset:23264
    v_mfma_f32_16x16x32_bf16 a[8:11], v[16:19], v[136:139], a[8:11]
    ds_read_b64_tr_b16 v[40:41], v8 offset:18688
    v_mfma_f32_16x16x32_bf16 a[44:47], v[16:19], v[140:143], a[44:47]
    buffer_load_dwordx4 a[140:143], v10, s[48:51], s26 offen offset:2048 sc1
    v_mfma_f32_16x16x32_bf16 a[80:83], v[16:19], v[144:147], a[80:83]
    s_waitcnt lgkmcnt(9)
    ds_read_b64_tr_b16 v[42:43], v8 offset:23296
    v_mfma_f32_16x16x32_bf16 a[12:15], v[20:23], v[136:139], a[12:15]
    ds_read_b64_tr_b16 v[44:45], v8 offset:27648
    v_mfma_f32_16x16x32_bf16 a[48:51], v[20:23], v[140:143], a[48:51]
    v_mfma_f32_16x16x32_bf16 a[84:87], v[20:23], v[144:147], a[84:87]
    s_waitcnt lgkmcnt(9)
    ds_read_b64_tr_b16 v[46:47], v8 offset:32256
    v_mfma_f32_16x16x32_bf16 a[16:19], v[24:27], v[136:139], a[16:19]
    s_add_u32 s26, s26, 12288
    ds_read_b64_tr_b16 v[16:17], v8 offset:27680
    v_mfma_f32_16x16x32_bf16 a[52:55], v[24:27], v[140:143], a[52:55]
    buffer_load_dwordx4 a[144:147], v10, s[48:51], s26 offen offset:0 sc1
    v_mfma_f32_16x16x32_bf16 a[88:91], v[24:27], v[144:147], a[88:91]
    s_waitcnt lgkmcnt(9)
    ds_read_b64_tr_b16 v[18:19], v8 offset:32288
    v_mfma_f32_16x16x32_bf16 a[20:23], v[28:31], v[136:139], a[20:23]
    ds_read_b64_tr_b16 v[20:21], v8 offset:27712
    v_mfma_f32_16x16x32_bf16 a[56:59], v[28:31], v[140:143], a[56:59]
    buffer_load_dwordx4 a[148:151], v10, s[48:51], s26 offen offset:1024 sc1
    v_mfma_f32_16x16x32_bf16 a[92:95], v[28:31], v[144:147], a[92:95]
    s_waitcnt lgkmcnt(9)
    ds_read_b64_tr_b16 v[22:23], v8 offset:32320
    s_waitcnt vmcnt(14)
    s_barrier
    s_cmp_eq_u32 s52, 0
    s_cbranch_scc1 L_flag1b
L_flag1b_back:
    v_mfma_f32_16x16x32_bf16 a[24:27], v[32:35], v[136:139], a[24:27]
    ds_read_b64_tr_b16 v[24:25], v8 offset:27744
    v_mfma_f32_16x16x32_bf16 a[60:63], v[32:35], v[140:143], a[60:63]
    v_mfma_f32_16x16x32_bf16 a[96:99], v[32:35], v[144:147], a[96:99]
    s_waitcnt lgkmcnt(9)
    ds_read_b64_tr_b16 v[26:27], v8 offset:32352
    v_mfma_f32_16x16x32_bf16 a[28:31], v[36:39], v[136:139], a[28:31]
    ds_read_b64_tr_b16 v[28:29], v8 offset:27776
    v_mfma_f32_16x16x32_bf16 a[64:67], v[36:39], v[140:143], a[64:67]
    buffer_load_dwordx4 a[152:155], v10, s[48:51], s26 offen offset:2048 sc1
    v_mfma_f32_16x16x32_bf16 a[100:103], v[36:39], v[144:147], a[100:103]
    s_waitcnt lgkmcnt(9)
    ds_read_b64_tr_b16 v[30:31], v8 offset:32384
    v_mfma_f32_16x16x32_bf16 a[32:35], v[40:43], v[136:139], a[32:35]
    s_cmp_le_u32 s78, 1
    s_cselect_b32 s26, 2, 1
    s_mul_i32 s26, s26, 98304
    s_add_u32 s26, s26, s25
    ds_read_b64_tr_b16 v[32:33], v8 offset:27808
    v_mfma_f32_16x16x32_bf16 a[68:71], v[40:43], v[140:143], a[68:71]
    buffer_load_dwordx4 a[156:159], v10, s[48:51], s26 offen offset:0 sc1
    v_mfma_f32_16x16x32_bf16 a[104:107], v[40:43], v[144:147], a[104:107]
    s_waitcnt lgkmcnt(9)
    ds_read_b64_tr_b16 v[34:35], v8 offset:32416
    v_mfma_f32_16x16x32_bf16 a[0:3], v[44:47], v[148:151], a[0:3]
    ds_read_b64_tr_b16 v[36:37], v8 offset:27840
    v_mfma_f32_16x16x32_bf16 a[36:39], v[44:47], v[152:155], a[36:39]
    v_mfma_f32_16x16x32_bf16 a[72:75], v[44:47], v[156:159], a[72:75]
    s_waitcnt lgkmcnt(9)
    ds_read_b64_tr_b16 v[38:39], v8 offset:32448
    v_mfma_f32_16x16x32_bf16 a[4:7], v[16:19], v[148:151], a[4:7]
    ds_read_b64_tr_b16 v[40:41], v8 offset:27872
    v_mfma_f32_16x16x32_bf16 a[40:43], v[16:19], v[152:155], a[40:43]
    buffer_load_dwordx4 a[160:163], v10, s[48:51], s26 offen offset:1024 sc1
    v_mfma_f32_16x16x32_bf16 a[76:79], v[16:19], v[156:159], a[76:79]
    s_waitcnt lgkmcnt(9)
    ds_read_b64_tr_b16 v[42:43], v8 offset:32480
    v_mfma_f32_16x16x32_bf16 a[8:11], v[20:23], v[148:151], a[8:11]
    ds_read_b64_tr_b16 v[44:45], v8 offset:27904
    v_mfma_f32_16x16x32_bf16 a[44:47], v[20:23], v[152:155], a[44:47]
    buffer_load_dwordx4 a[164:167], v10, s[48:51], s26 offen offset:2048 sc1
    v_mfma_f32_16x16x32_bf16 a[80:83], v[20:23], v[156:159], a[80:83]
    ds_read_b64_tr_b16 v[46:47], v8 offset:32512
    s_waitcnt  lgkmcnt(0)
    s_barrier
    v_mov_b32 v7, v246
    v_add_u32 v8, 36864, v246
    v_mfma_f32_16x16x32_bf16 a[12:15], v[24:27], v[148:151], a[12:15]
    ds_read_b64_tr_b16 v[16:17], v9 offset:0
    v_mfma_f32_16x16x32_bf16 a[48:51], v[24:27], v[152:155], a[48:51]
    v_mfma_f32_16x16x32_bf16 a[84:87], v[24:27], v[156:159], a[84:87]
    s_waitcnt lgkmcnt(9)
    ds_read_b64_tr_b16 v[18:19], v9 offset:4608
    v_mfma_f32_16x16x32_bf16 a[16:19], v[28:31], v[148:151], a[16:19]
    s_add_u32 s26, s26, 12288
    ds_read_b64_tr_b16 v[20:21], v9 offset:32
    v_mfma_f32_16x16x32_bf16 a[52:55], v[28:31], v[152:155], a[52:55]
    buffer_load_dwordx4 a[168:171], v10, s[48:51], s26 offen offset:0 sc1
    v_mfma_f32_16x16x32_bf16 a[88:91], v[28:31], v[156:159], a[88:91]
    s_waitcnt lgkmcnt(9)
    ds_read_b64_tr_b16 v[22:23], v9 offset:4640
    v_mfma_f32_16x16x32_bf16 a[20:23], v[32:35], v[148:151], a[20:23]
    ds_read_b64_tr_b16 v[24:25], v9 offset:64
    v_mfma_f32_16x16x32_bf16 a[56:59], v[32:35], v[152:155], a[56:59]
    buffer_load_dwordx4 a[172:175], v10, s[48:51], s26 offen offset:1024 sc1
    v_mfma_f32_16x16x32_bf16 a[92:95], v[32:35], v[156:159], a[92:95]
    s_waitcnt lgkmcnt(9)
    ds_read_b64_tr_b16 v[26:27], v9 offset:4672
    v_mfma_f32_16x16x32_bf16 a[24:27], v[36:39], v[148:151], a[24:27]
    ds_read_b64_tr_b16 v[28:29], v9 offset:96
    v_mfma_f32_16x16x32_bf16 a[60:63], v[36:39], v[152:155], a[60:63]
    v_mfma_f32_16x16x32_bf16 a[96:99], v[36:39], v[156:159], a[96:99]
    s_waitcnt lgkmcnt(9)
    ds_read_b64_tr_b16 v[30:31], v9 offset:4704
    v_mfma_f32_16x16x32_bf16 a[28:31], v[40:43], v[148:151], a[28:31]
    ds_read_b64_tr_b16 v[32:33], v9 offset:128
    v_mfma_f32_16x16x32_bf16 a[64:67], v[40:43], v[152:155], a[64:67]
    buffer_load_dwordx4 a[176:179], v10, s[48:51], s26 offen offset:2048 sc1
    v_mfma_f32_16x16x32_bf16 a[100:103], v[40:43], v[156:159], a[100:103]
    s_waitcnt lgkmcnt(9)
    ds_read_b64_tr_b16 v[34:35], v9 offset:4736
    v_mfma_f32_16x16x32_bf16 a[32:35], v[44:47], v[148:151], a[32:35]
    s_add_u32 s26, s26, 36864
    ds_read_b64_tr_b16 v[36:37], v9 offset:160
    v_mfma_f32_16x16x32_bf16 a[68:71], v[44:47], v[152:155], a[68:71]
    buffer_load_dwordx4 a[180:183], v10, s[48:51], s26 offen offset:0 sc1
    v_mfma_f32_16x16x32_bf16 a[104:107], v[44:47], v[156:159], a[104:107]
    ds_read_b64_tr_b16 v[38:39], v9 offset:4768
    s_waitcnt vmcnt(16) lgkmcnt(10)
    v_mfma_f32_16x16x32_bf16 a[0:3], v[16:19], a[108:111], a[0:3]
    ds_read_b64_tr_b16 v[40:41], v9 offset:192
    v_mfma_f32_16x16x32_bf16 a[36:39], v[16:19], a[112:115], a[36:39]
    v_mfma_f32_16x16x32_bf16 a[72:75], v[16:19], a[116:119], a[72:75]
    s_waitcnt lgkmcnt(9)
    ds_read_b64_tr_b16 v[42:43], v9 offset:4800
    v_mfma_f32_16x16x32_bf16 a[4:7], v[20:23], a[108:111], a[4:7]
    ds_read_b64_tr_b16 v[44:45], v9 offset:224
    v_mfma_f32_16x16x32_bf16 a[40:43], v[20:23], a[112:115], a[40:43]
    buffer_load_dwordx4 a[184:187], v10, s[48:51], s26 offen offset:1024 sc1
    v_mfma_f32_16x16x32_bf16 a[76:79], v[20:23], a[116:119], a[76:79]
    s_waitcnt lgkmcnt(9)
    ds_read_b64_tr_b16 v[46:47], v9 offset:4832
    v_mfma_f32_16x16x32_bf16 a[8:11], v[24:27], a[108:111], a[8:11]
    ds_read_b64_tr_b16 v[16:17], v9 offset:256
    v_mfma_f32_16x16x32_bf16 a[44:47], v[24:27], a[112:115], a[44:47]
    buffer_load_dwordx4 a[188:191], v10, s[48:51], s26 offen offset:2048 sc1
    v_mfma_f32_16x16x32_bf16 a[80:83], v[24:27], a[116:119], a[80:83]
    s_waitcnt lgkmcnt(9)
    ds_read_b64_tr_b16 v[18:19], v9 offset:4864
    v_mfma_f32_16x16x32_bf16 a[12:15], v[28:31], a[108:111], a[12:15]
    ds_read_b64_tr_b16 v[20:21], v9 offset:9216
    v_mfma_f32_16x16x32_bf16 a[48:51], v[28:31], a[112:115], a[48:51]
    v_mfma_f32_16x16x32_bf16 a[84:87], v[28:31], a[116:119], a[84:87]
    s_waitcnt lgkmcnt(9)
    ds_read_b64_tr_b16 v[22:23], v9 offset:13824
    v_mfma_f32_16x16x32_bf16 a[16:19], v[32:35], a[108:111], a[16:19]
    s_add_u32 s26, s26, 12288
    ds_read_b64_tr_b16 v[24:25], v9 offset:9248
    v_mfma_f32_16x16x32_bf16 a[52:55], v[32:35], a[112:115], a[52:55]
    buffer_load_dwordx4 a[192:195], v10, s[48:51], s26 offen offset:0 sc1
    v_mfma_f32_16x16x32_bf16 a[88:91], v[32:35], a[116:119], a[88:91]
    s_waitcnt lgkmcnt(9)
    ds_read_b64_tr_b16 v[26:27], v9 offset:13856
    v_mfma_f32_16x16x32_bf16 a[20:23], v[36:39], a[108:111], a[20:23]
    ds_read_b64_tr_b16 v[28:29], v9 offset:9280
    v_mfma_f32_16x16x32_bf16 a[56:59], v[36:39], a[112:115], a[56:59]
    buffer_load_dwordx4 a[196:199], v10, s[48:51], s26 offen offset:1024 sc1
    v_mfma_f32_16x16x32_bf16 a[92:95], v[36:39], a[116:119], a[92:95]
    s_waitcnt lgkmcnt(9)
    ds_read_b64_tr_b16 v[30:31], v9 offset:13888
    v_mfma_f32_16x16x32_bf16 a[24:27], v[40:43], a[108:111], a[24:27]
    ds_read_b64_tr_b16 v[32:33], v9 offset:9312
    v_mfma_f32_16x16x32_bf16 a[60:63], v[40:43], a[112:115], a[60:63]
    v_mfma_f32_16x16x32_bf16 a[96:99], v[40:43], a[116:119], a[96:99]
    s_waitcnt lgkmcnt(9)
    ds_read_b64_tr_b16 v[34:35], v9 offset:13920
    v_mfma_f32_16x16x32_bf16 a[28:31], v[44:47], a[108:111], a[28:31]
    ds_read_b64_tr_b16 v[36:37], v9 offset:9344
    v_mfma_f32_16x16x32_bf16 a[64:67], v[44:47], a[112:115], a[64:67]
    buffer_load_dwordx4 a[200:203], v10, s[48:51], s26 offen offset:2048 sc1
    v_mfma_f32_16x16x32_bf16 a[100:103], v[44:47], a[116:119], a[100:103]
    s_waitcnt lgkmcnt(9)
    ds_read_b64_tr_b16 v[38:39], v9 offset:13952
    v_mfma_f32_16x16x32_bf16 a[32:35], v[16:19], a[108:111], a[32:35]
    s_cmp_le_u32 s78, 2
    s_cselect_b32 s58, 3, 2
    s_lshl_b32 s58, s58, 3
    s_add_u32 s58, s58, s79
    s_add_u32 s58, s58, 0
    s_mul_i32 s58, s58, 36864
    s_add_u32 m0, s59, 0
    ds_read_b64_tr_b16 v[40:41], v9 offset:9376
    v_mfma_f32_16x16x32_bf16 a[68:71], v[16:19], a[112:115], a[68:71]
    buffer_load_dwordx4 v1, s[72:75], s58 offen sc1 lds
    v_mfma_f32_16x16x32_bf16 a[104:107], v[16:19], a[116:119], a[104:107]
    ds_read_b64_tr_b16 v[42:43], v9 offset:13984
    s_waitcnt vmcnt(19) lgkmcnt(10)
    v_mfma_f32_16x16x32_bf16 a[0:3], v[20:23], a[120:123], a[0:3]
    ds_read_b64_tr_b16 v[44:45], v9 offset:9408
    v_mfma_f32_16x16x32_bf16 a[36:39], v[20:23], a[124:127], a[36:39]
    v_mfma_f32_16x16x32_bf16 a[72:75], v[20:23], a[128:131], a[72:75]
    s_waitcnt lgkmcnt(9)
    ds_read_b64_tr_b16 v[46:47], v9 offset:14016
    v_mfma_f32_16x16x32_bf16 a[4:7], v[24:27], a[120:123], a[4:7]
    s_add_u32 m0, s59, 1024
    ds_read_b64_tr_b16 v[16:17], v9 offset:9440
    v_mfma_f32_16x16x32_bf16 a[40:43], v[24:27], a[124:127], a[40:43]
    buffer_load_dwordx4 v2, s[72:75], s58 offen sc1 lds
    v_mfma_f32_16x16x32_bf16 a[76:79], v[24:27], a[128:131], a[76:79]
    s_waitcnt lgkmcnt(9)
    ds_read_b64_tr_b16 v[18:19], v9 offset:14048
    v_mfma_f32_16x16x32_bf16 a[8:11], v[28:31], a[120:123], a[8:11]
    s_add_u32 m0, s59, 2048
    ds_read_b64_tr_b16 v[20:21], v9 offset:9472
    v_mfma_f32_16x16x32_bf16 a[44:47], v[28:31], a[124:127], a[44:47]
    buffer_load_dwordx4 v4, s[72:75], s58 offen sc1 lds
    v_mfma_f32_16x16x32_bf16 a[80:83], v[28:31], a[128:131], a[80:83]
    s_waitcnt lgkmcnt(9)
    ds_read_b64_tr_b16 v[22:23], v9 offset:14080
    v_mfma_f32_16x16x32_bf16 a[12:15], v[32:35], a[120:123], a[12:15]
    ds_read_b64_tr_b16 v[24:25], v9 offset:18432
    v_mfma_f32_16x16x32_bf16 a[48:51], v[32:35], a[124:127], a[48:51]
    v_mfma_f32_16x16x32_bf16 a[84:87], v[32:35], a[128:131], a[84:87]
    s_waitcnt lgkmcnt(9)
    ds_read_b64_tr_b16 v[26:27], v9 offset:23040
    v_mfma_f32_16x16x32_bf16 a[16:19], v[36:39], a[120:123], a[16:19]
    ds_read_b64_tr_b16 v[28:29], v9 offset:18464
    v_mfma_f32_16x16x32_bf16 a[52:55], v[36:39], a[124:127], a[52:55]
    global_load_dword v255, v254, s[76:77] sc1
    v_mfma_f32_16x16x32_bf16 a[88:91], v[36:39], a[128:131], a[88:91]
    s_waitcnt lgkmcnt(9)
    ds_read_b64_tr_b16 v[30:31], v9 offset:23072
    v_mfma_f32_16x16x32_bf16 a[20:23], v[40:43], a[120:123], a[20:23]
    s_add_u32 m0, s59, 3072
    ds_read_b64_tr_b16 v[32:33], v9 offset:18496
    v_mfma_f32_16x16x32_bf16 a[56:59], v[40:43], a[124:127], a[56:59]
    buffer_load_dwordx4 v5, s[72:75], s58 offen sc1 lds
    v_mfma_f32_16x16x32_bf16 a[92:95], v[40:43], a[128:131], a[92:95]
    s_waitcnt lgkmcnt(9)
    ds_read_b64_tr_b16 v[34:35], v9 offset:23104
    v_mfma_f32_16x16x32_bf16 a[24:27], v[44:47], a[120:123], a[24:27]
    ds_read_b64_tr_b16 v[36:37], v9 offset:18528
    v_mfma_f32_16x16x32_bf16 a[60:63], v[44:47], a[124:127], a[60:63]
    v_mfma_f32_16x16x32_bf16 a[96:99], v[44:47], a[128:131], a[96:99]
    s_waitcnt lgkmcnt(9)
    ds_read_b64_tr_b16 v[38:39], v9 offset:23136
    v_mfma_f32_16x16x32_bf16 a[28:31], v[16:19], a[120:123], a[28:31]
    s_add_u32 m0, s59, 4096
    ds_read_b64_tr_b16 v[40:41], v9 offset:18560
    v_mfma_f32_16x16x32_bf16 a[64:67], v[16:19], a[124:127], a[64:67]
    buffer_load_dwordx4 v6, s[72:75], s58 offen sc1 lds
    v_mfma_f32_16x16x32_bf16 a[100:103], v[16:19], a[128:131], a[100:103]
    s_waitcnt lgkmcnt(9)
    ds_read_b64_tr_b16 v[42:43], v9 offset:23168
    v_mfma_f32_16x16x32_bf16 a[32:35], v[20:23], a[120:123], a[32:35]
    s_add_u32 m0, s59, 5120
    ds_read_b64_tr_b16 v[44:45], v9 offset:18592
    v_mfma_f32_16x16x32_bf16 a[68:71], v[20:23], a[124:127], a[68:71]
    buffer_load_dwordx4 v13, s[72:75], s58 offen sc1 lds
    v_mfma_f32_16x16x32_bf16 a[104:107], v[20:23], a[128:131], a[104:107]
    ds_read_b64_tr_b16 v[46:47], v9 offset:23200
    s_waitcnt vmcnt(22) lgkmcnt(10)
    v_mfma_f32_16x16x32_bf16 a[0:3], v[24:27], a[132:135], a[0:3]
    ds_read_b64_tr_b16 v[16:17], v9 offset:18624
    v_mfma_f32_16x16x32_bf16 a[36:39], v[24:27], a[136:139], a[36:39]
    v_mfma_f32_16x16x32_bf16 a[72:75], v[24:27], a[140:143], a[72:75]
    s_waitcnt lgkmcnt(9)
    ds_read_b64_tr_b16 v[18:19], v9 offset:23232
    v_mfma_f32_16x16x32_bf16 a[4:7], v[28:31], a[132:135], a[4:7]
    s_add_u32 m0, s59, 6144
    ds_read_b64_tr_b16 v[20:21], v9 offset:18656
    v_mfma_f32_16x16x32_bf16 a[40:43], v[28:31], a[136:139], a[40:43]
    buffer_load_dwordx4 v14, s[72:75], s58 offen sc1 lds
    v_mfma_f32_16x16x32_bf16 a[76:79], v[28:31], a[140:143], a[76:79]
    s_waitcnt lgkmcnt(9)
    ds_read_b64_tr_b16 v[22:23], v9 offset:23264
    v_mfma_f32_16x16x32_bf16 a[8:11], v[32:35], a[132:135], a[8:11]
    s_add_u32 m0, s59, 7168
    ds_read_b64_tr_b16 v[24:25], v9 offset:18688
    v_mfma_f32_16x16x32_bf16 a[44:47], v[32:35], a[136:139], a[44:47]
    buffer_load_dwordx4 v15, s[72:75], s58 offen sc1 lds
    v_mfma_f32_16x16x32_bf16 a[80:83], v[32:35], a[140:143], a[80:83]
    s_waitcnt lgkmcnt(9)
    ds_read_b64_tr_b16 v[26:27], v9 offset:23296
    v_mfma_f32_16x16x32_bf16 a[12:15], v[36:39], a[132:135], a[12:15]
    ds_read_b64_tr_b16 v[28:29], v9 offset:27648
    v_mfma_f32_16x16x32_bf16 a[48:51], v[36:39], a[136:139], a[48:51]
    v_mfma_f32_16x16x32_bf16 a[84:87], v[36:39], a[140:143], a[84:87]
    s_waitcnt lgkmcnt(9)
    ds_read_b64_tr_b16 v[30:31], v9 offset:32256
    v_mfma_f32_16x16x32_bf16 a[16:19], v[40:43], a[132:135], a[16:19]
    s_add_u32 m0, s59, 8192
    ds_read_b64_tr_b16 v[32:33], v9 offset:27680
    v_mfma_f32_16x16x32_bf16 a[52:55], v[40:43], a[136:139], a[52:55]
    buffer_load_dwordx4 v251, s[72:75], s58 offen sc1 lds
    v_mfma_f32_16x16x32_bf16 a[88:91], v[40:43], a[140:143], a[88:91]
    s_waitcnt lgkmcnt(9)
    ds_read_b64_tr_b16 v[34:35], v9 offset:32288
    v_mfma_f32_16x16x32_bf16 a[20:23], v[44:47], a[132:135], a[20:23]
    s_cmp_le_u32 s78, 2
    s_cselect_b32 s26, 3, 2
    s_mul_i32 s26, s26, 98304
    s_add_u32 s26, s26, s25
    ds_read_b64_tr_b16 v[36:37], v9 offset:27712
    v_mfma_f32_16x16x32_bf16 a[56:59], v[44:47], a[136:139], a[56:59]
    buffer_load_dwordx4 a[204:207], v10, s[48:51], s26 offen offset:0 sc1
    v_mfma_f32_16x16x32_bf16 a[92:95], v[44:47], a[140:143], a[92:95]
    s_waitcnt lgkmcnt(9)
    ds_read_b64_tr_b16 v[38:39], v9 offset:32320
    v_mfma_f32_16x16x32_bf16 a[24:27], v[16:19], a[132:135], a[24:27]
    ds_read_b64_tr_b16 v[40:41], v9 offset:27744
    v_mfma_f32_16x16x32_bf16 a[60:63], v[16:19], a[136:139], a[60:63]
    v_mfma_f32_16x16x32_bf16 a[96:99], v[16:19], a[140:143], a[96:99]
    s_waitcnt lgkmcnt(9)
    ds_read_b64_tr_b16 v[42:43], v9 offset:32352
    v_mfma_f32_16x16x32_bf16 a[28:31], v[20:23], a[132:135], a[28:31]
    ds_read_b64_tr_b16 v[44:45], v9 offset:27776
    v_mfma_f32_16x16x32_bf16 a[64:67], v[20:23], a[136:139], a[64:67]
    buffer_load_dwordx4 a[208:211], v10, s[48:51], s26 offen offset:1024 sc1
    v_mfma_f32_16x16x32_bf16 a[100:103], v[20:23], a[140:143], a[100:103]
    s_waitcnt lgkmcnt(9)
    ds_read_b64_tr_b16 v[46:47], v9 offset:32384
    v_mfma_f32_16x16x32_bf16 a[32:35], v[24:27], a[132:135], a[32:35]
    ds_read_b64_tr_b16 v[16:17], v9 offset:27808
    v_mfma_f32_16x16x32_bf16 a[68:71], v[24:27], a[136:139], a[68:71]
    buffer_load_dwordx4 a[212:215], v10, s[48:51], s26 offen offset:2048 sc1
    v_mfma_f32_16x16x32_bf16 a[104:107], v[24:27], a[140:143], a[104:107]
    ds_read_b64_tr_b16 v[18:19], v9 offset:32416
    s_waitcnt vmcnt(25) lgkmcnt(10)
    v_mfma_f32_16x16x32_bf16 a[0:3], v[28:31], a[144:147], a[0:3]
    ds_read_b64_tr_b16 v[20:21], v9 offset:27840
    v_mfma_f32_16x16x32_bf16 a[36:39], v[28:31], a[148:151], a[36:39]
    v_mfma_f32_16x16x32_bf16 a[72:75], v[28:31], a[152:155], a[72:75]
    s_waitcnt lgkmcnt(9)
    ds_read_b64_tr_b16 v[22:23], v9 offset:32448
    s_waitcnt vmcnt(9)
    v_cmp_gt_u32 vcc, 2, v255
    s_cbranch_vccnz L_spin1b
L_spin1b_back:
    v_mfma_f32_16x16x32_bf16 a[4:7], v[32:35], a[144:147], a[4:7]
    s_add_u32 s26, s26, 12288
    ds_read_b64_tr_b16 v[24:25], v9 offset:27872
    v_mfma_f32_16x16x32_bf16 a[40:43], v[32:35], a[148:151], a[40:43]
    buffer_load_dwordx4 a[216:219], v10, s[48:51], s26 offen offset:0 sc1
    v_mfma_f32_16x16x32_bf16 a[76:79], v[32:35], a[152:155], a[76:79]
    s_waitcnt lgkmcnt(9)
    ds_read_b64_tr_b16 v[26:27], v9 offset:32480
    v_mfma_f32_16x16x32_bf16 a[8:11], v[36:39], a[144:147], a[8:11]
    ds_read_b64_tr_b16 v[28:29], v9 offset:27904
    v_mfma_f32_16x16x32_bf16 a[44:47], v[36:39], a[148:151], a[44:47]
    buffer_load_dwordx4 a[220:223], v10, s[48:51], s26 offen offset:1024 sc1
    v_mfma_f32_16x16x32_bf16 a[80:83], v[36:39], a[152:155], a[80:83]
    ds_read_b64_tr_b16 v[30:31], v9 offset:32512
    s_waitcnt vmcnt(40) lgkmcnt(10)
    s_barrier
    v_mfma_f32_16x16x32_bf16 a[12:15], v[40:43], a[144:147], a[12:15]
    ds_read_b64_tr_b16 v[32:33], v11 offset:0
    v_mfma_f32_16x16x32_bf16 a[48:51], v[40:43], a[148:151], a[48:51]
    v_mfma_f32_16x16x32_bf16 a[84:87], v[40:43], a[152:155], a[84:87]
    s_waitcnt lgkmcnt(9)
    ds_read_b64_tr_b16 v[34:35], v11 offset:4608
    v_mfma_f32_16x16x32_bf16 a[16:19], v[44:47], a[144:147], a[16:19]
    ds_read_b64_tr_b16 v[36:37], v11 offset:32
    v_mfma_f32_16x16x32_bf16 a[52:55], v[44:47], a[148:151], a[52:55]
    buffer_load_dwordx4 a[224:227], v10, s[48:51], s26 offen offset:2048 sc1
    v_mfma_f32_16x16x32_bf16 a[88:91], v[44:47], a[152:155], a[88:91]
    s_waitcnt lgkmcnt(9)
    ds_read_b64_tr_b16 v[38:39], v11 offset:4640
    v_mfma_f32_16x16x32_bf16 a[20:23], v[16:19], a[144:147], a[20:23]
    s_add_u32 s26, s26, 36864
    ds_read_b64_tr_b16 v[40:41], v11 offset:64
    v_mfma_f32_16x16x32_bf16 a[56:59], v[16:19], a[148:151], a[56:59]
    buffer_load_dwordx4 a[228:231], v10, s[48:51], s26 offen offset:0 sc1
    v_mfma_f32_16x16x32_bf16 a[92:95], v[16:19], a[152:155], a[92:95]
    s_waitcnt lgkmcnt(9)
    ds_read_b64_tr_b16 v[42:43], v11 offset:4672
    v_mfma_f32_16x16x32_bf16 a[24:27], v[20:23], a[144:147], a[24:27]
    ds_read_b64_tr_b16 v[44:45], v11 offset:96
    v_mfma_f32_16x16x32_bf16 a[60:63], v[20:23], a[148:151], a[60:63]
    v_mfma_f32_16x16x32_bf16 a[96:99], v[20:23], a[152:155], a[96:99]
    s_waitcnt lgkmcnt(9)
    ds_read_b64_tr_b16 v[46:47], v11 offset:4704
    v_mfma_f32_16x16x32_bf16 a[28:31], v[24:27], a[144:147], a[28:31]
    ds_read_b64_tr_b16 v[16:17], v11 offset:128
    v_mfma_f32_16x16x32_bf16 a[64:67], v[24:27], a[148:151], a[64:67]
    buffer_load_dwordx4 a[232:235], v10, s[48:51], s26 offen offset:1024 sc1
    v_mfma_f32_16x16x32_bf16 a[100:103], v[24:27], a[152:155], a[100:103]
    s_waitcnt lgkmcnt(9)
    ds_read_b64_tr_b16 v[18:19], v11 offset:4736
    v_mfma_f32_16x16x32_bf16 a[32:35], v[28:31], a[144:147], a[32:35]
    ds_read_b64_tr_b16 v[20:21], v11 offset:160
    v_mfma_f32_16x16x32_bf16 a[68:71], v[28:31], a[148:151], a[68:71]
    buffer_load_dwordx4 a[236:239], v10, s[48:51], s26 offen offset:2048 sc1
    v_mfma_f32_16x16x32_bf16 a[104:107], v[28:31], a[152:155], a[104:107]
    ds_read_b64_tr_b16 v[22:23], v11 offset:4768
    s_waitcnt vmcnt(28) lgkmcnt(10)
    v_mfma_f32_16x16x32_bf16 a[0:3], v[32:35], a[156:159], a[0:3]
    ds_read_b64_tr_b16 v[24:25], v11 offset:192
    v_mfma_f32_16x16x32_bf16 a[36:39], v[32:35], a[160:163], a[36:39]
    v_mfma_f32_16x16x32_bf16 a[72:75], v[32:35], a[164:167], a[72:75]
    s_waitcnt lgkmcnt(9)
    ds_read_b64_tr_b16 v[26:27], v11 offset:4800
    v_mfma_f32_16x16x32_bf16 a[4:7], v[36:39], a[156:159], a[4:7]
    s_add_u32 s26, s26, 12288
    ds_read_b64_tr_b16 v[28:29], v11 offset:224
    v_mfma_f32_16x16x32_bf16 a[40:43], v[36:39], a[160:163], a[40:43]
    buffer_load_dwordx4 a[240:243], v10, s[48:51], s26 offen offset:0 sc1
    v_mfma_f32_16x16x32_bf16 a[76:79], v[36:39], a[164:167], a[76:79]
    s_waitcnt lgkmcnt(9)
    ds_read_b64_tr_b16 v[30:31], v11 offset:4832
    v_mfma_f32_16x16x32_bf16 a[8:11], v[40:43], a[156:159], a[8:11]
    ds_read_b64_tr_b16 v[32:33], v11 offset:256
    v_mfma_f32_16x16x32_bf16 a[44:47], v[40:43], a[160:163], a[44:47]
    buffer_load_dwordx4 a[244:247], v10, s[48:51], s26 offen offset:1024 sc1
    v_mfma_f32_16x16x32_bf16 a[80:83], v[40:43], a[164:167], a[80:83]
    s_waitcnt lgkmcnt(9)
    ds_read_b64_tr_b16 v[34:35], v11 offset:4864
    v_mfma_f32_16x16x32_bf16 a[12:15], v[44:47], a[156:159], a[12:15]
    ds_read_b64_tr_b16 v[36:37], v11 offset:9216
    v_mfma_f32_16x16x32_bf16 a[48:51], v[44:47], a[160:163], a[48:51]
    v_mfma_f32_16x16x32_bf16 a[84:87], v[44:47], a[164:167], a[84:87]
    s_waitcnt lgkmcnt(9)
    ds_read_b64_tr_b16 v[38:39], v11 offset:13824
    v_mfma_f32_16x16x32_bf16 a[16:19], v[16:19], a[156:159], a[16:19]
    ds_read_b64_tr_b16 v[40:41], v11 offset:9248
    v_mfma_f32_16x16x32_bf16 a[52:55], v[16:19], a[160:163], a[52:55]
    buffer_load_dwordx4 a[248:251], v10, s[48:51], s26 offen offset:2048 sc1
    v_mfma_f32_16x16x32_bf16 a[88:91], v[16:19], a[164:167], a[88:91]
    s_waitcnt lgkmcnt(9)
    ds_read_b64_tr_b16 v[42:43], v11 offset:13856
    v_mfma_f32_16x16x32_bf16 a[20:23], v[20:23], a[156:159], a[20:23]
    s_cmp_le_u32 s78, 0
    s_cselect_b32 s58, 1, 0
    s_lshl_b32 s58, s58, 3
    s_add_u32 s58, s58, s79
    s_add_u32 s58, s58, 2
    s_mul_i32 s58, s58, 36864
    s_add_u32 m0, s59, 36864
    ds_read_b64_tr_b16 v[44:45], v11 offset:9280
    v_mfma_f32_16x16x32_bf16 a[56:59], v[20:23], a[160:163], a[56:59]
    buffer_load_dwordx4 v1, s[72:75], s58 offen sc1 lds
    v_mfma_f32_16x16x32_bf16 a[92:95], v[20:23], a[164:167], a[92:95]
    s_waitcnt lgkmcnt(9)
    ds_read_b64_tr_b16 v[46:47], v11 offset:13888
    v_mfma_f32_16x16x32_bf16 a[24:27], v[24:27], a[156:159], a[24:27]
    ds_read_b64_tr_b16 v[16:17], v11 offset:9312
    v_mfma_f32_16x16x32_bf16 a[60:63], v[24:27], a[160:163], a[60:63]
    v_mfma_f32_16x16x32_bf16 a[96:99], v[24:27], a[164:167], a[96:99]
    s_waitcnt lgkmcnt(9)
    ds_read_b64_tr_b16 v[18:19], v11 offset:13920
    v_mfma_f32_16x16x32_bf16 a[28:31], v[28:31], a[156:159], a[28:31]
    s_add_u32 m0, s59, 37888
    ds_read_b64_tr_b16 v[20:21], v11 offset:9344
    v_mfma_f32_16x16x32_bf16 a[64:67], v[28:31], a[160:163], a[64:67]
    buffer_load_dwordx4 v2, s[72:75], s58 offen sc1 lds
    v_mfma_f32_16x16x32_bf16 a[100:103], v[28:31], a[164:167], a[100:103]
    s_waitcnt lgkmcnt(9)
    ds_read_b64_tr_b16 v[22:23], v11 offset:13952
    v_mfma_f32_16x16x32_bf16 a[32:35], v[32:35], a[156:159], a[32:35]
    s_add_u32 m0, s59, 38912
    ds_read_b64_tr_b16 v[24:25], v11 offset:9376
    v_mfma_f32_16x16x32_bf16 a[68:71], v[32:35], a[160:163], a[68:71]
    buffer_load_dwordx4 v4, s[72:75], s58 offen sc1 lds
    v_mfma_f32_16x16x32_bf16 a[104:107], v[32:35], a[164:167], a[104:107]
    ds_read_b64_tr_b16 v[26:27], v11 offset:13984
    s_waitcnt vmcnt(31) lgkmcnt(10)
    v_mfma_f32_16x16x32_bf16 a[0:3], v[36:39], a[168:171], a[0:3]
    ds_read_b64_tr_b16 v[28:29], v11 offset:9408
    v_mfma_f32_16x16x32_bf16 a[36:39], v[36:39], a[172:175], a[36:39]
    v_mfma_f32_16x16x32_bf16 a[72:75], v[36:39], a[176:179], a[72:75]
    s_waitcnt lgkmcnt(9)
    ds_read_b64_tr_b16 v[30:31], v11 offset:14016
    v_mfma_f32_16x16x32_bf16 a[4:7], v[40:43], a[168:171], a[4:7]
    s_add_u32 m0, s59, 39936
    ds_read_b64_tr_b16 v[32:33], v11 offset:9440
    v_mfma_f32_16x16x32_bf16 a[40:43], v[40:43], a[172:175], a[40:43]
    buffer_load_dwordx4 v5, s[72:75], s58 offen sc1 lds
    v_mfma_f32_16x16x32_bf16 a[76:79], v[40:43], a[176:179], a[76:79]
    s_waitcnt lgkmcnt(9)
    ds_read_b64_tr_b16 v[34:35], v11 offset:14048
    v_mfma_f32_16x16x32_bf16 a[8:11], v[44:47], a[168:171], a[8:11]
    s_add_u32 m0, s59, 40960
    ds_read_b64_tr_b16 v[36:37], v11 offset:9472
    v_mfma_f32_16x16x32_bf16 a[44:47], v[44:47], a[172:175], a[44:47]
    buffer_load_dwordx4 v6, s[72:75], s58 offen sc1 lds
    v_mfma_f32_16x16x32_bf16 a[80:83], v[44:47], a[176:179], a[80:83]
    s_waitcnt lgkmcnt(9)
    ds_read_b64_tr_b16 v[38:39], v11 offset:14080
    v_mfma_f32_16x16x32_bf16 a[12:15], v[16:19], a[168:171], a[12:15]
    ds_read_b64_tr_b16 v[40:41], v11 offset:18432
    v_mfma_f32_16x16x32_bf16 a[48:51], v[16:19], a[172:175], a[48:51]
    v_mfma_f32_16x16x32_bf16 a[84:87], v[16:19], a[176:179], a[84:87]
    s_waitcnt lgkmcnt(9)
    ds_read_b64_tr_b16 v[42:43], v11 offset:23040
    v_mfma_f32_16x16x32_bf16 a[16:19], v[20:23], a[168:171], a[16:19]
    s_add_u32 m0, s59, 41984
    ds_read_b64_tr_b16 v[44:45], v11 offset:18464
    v_mfma_f32_16x16x32_bf16 a[52:55], v[20:23], a[172:175], a[52:55]
    buffer_load_dwordx4 v13, s[72:75], s58 offen sc1 lds
    v_mfma_f32_16x16x32_bf16 a[88:91], v[20:23], a[176:179], a[88:91]
    s_waitcnt lgkmcnt(9)
    ds_read_b64_tr_b16 v[46:47], v11 offset:23072
    v_mfma_f32_16x16x32_bf16 a[20:23], v[24:27], a[168:171], a[20:23]
    s_add_u32 m0, s59, 43008
    ds_read_b64_tr_b16 v[16:17], v11 offset:18496
    v_mfma_f32_16x16x32_bf16 a[56:59], v[24:27], a[172:175], a[56:59]
    buffer_load_dwordx4 v14, s[72:75], s58 offen sc1 lds
    v_mfma_f32_16x16x32_bf16 a[92:95], v[24:27], a[176:179], a[92:95]
    s_waitcnt lgkmcnt(9)
    ds_read_b64_tr_b16 v[18:19], v11 offset:23104
    v_mfma_f32_16x16x32_bf16 a[24:27], v[28:31], a[168:171], a[24:27]
    ds_read_b64_tr_b16 v[20:21], v11 offset:18528
    v_mfma_f32_16x16x32_bf16 a[60:63], v[28:31], a[172:175], a[60:63]
    v_mfma_f32_16x16x32_bf16 a[96:99], v[28:31], a[176:179], a[96:99]
    s_waitcnt lgkmcnt(9)
    ds_read_b64_tr_b16 v[22:23], v11 offset:23136
    v_mfma_f32_16x16x32_bf16 a[28:31], v[32:35], a[168:171], a[28:31]
    s_add_u32 m0, s59, 44032
    ds_read_b64_tr_b16 v[24:25], v11 offset:18560
    v_mfma_f32_16x16x32_bf16 a[64:67], v[32:35], a[172:175], a[64:67]
    buffer_load_dwordx4 v15, s[72:75], s58 offen sc1 lds
    v_mfma_f32_16x16x32_bf16 a[100:103], v[32:35], a[176:179], a[100:103]
    s_waitcnt lgkmcnt(9)
    ds_read_b64_tr_b16 v[26:27], v11 offset:23168
    v_mfma_f32_16x16x32_bf16 a[32:35], v[36:39], a[168:171], a[32:35]
    s_add_u32 m0, s59, 45056
    ds_read_b64_tr_b16 v[28:29], v11 offset:18592
    v_mfma_f32_16x16x32_bf16 a[68:71], v[36:39], a[172:175], a[68:71]
    buffer_load_dwordx4 v251, s[72:75], s58 offen sc1 lds
    v_mfma_f32_16x16x32_bf16 a[104:107], v[36:39], a[176:179], a[104:107]
    ds_read_b64_tr_b16 v[30:31], v11 offset:23200
    s_waitcnt vmcnt(34) lgkmcnt(10)
    v_mfma_f32_16x16x32_bf16 a[0:3], v[40:43], a[180:183], a[0:3]
    ds_read_b64_tr_b16 v[32:33], v11 offset:18624
    v_mfma_f32_16x16x32_bf16 a[36:39], v[40:43], a[184:187], a[36:39]
    v_mfma_f32_16x16x32_bf16 a[72:75], v[40:43], a[188:191], a[72:75]
    s_waitcnt lgkmcnt(9)
    ds_read_b64_tr_b16 v[34:35], v11 offset:23232
    v_mfma_f32_16x16x32_bf16 a[4:7], v[44:47], a[180:183], a[4:7]
    s_cmp_le_u32 s78, 0
    s_cselect_b32 s26, 1, 0
    s_mul_i32 s26, s26, 98304
    s_add_u32 s26, s26, s25
    s_add_u32 s26, s26, 24576
    ds_read_b64_tr_b16 v[36:37], v11 offset:18656
    v_mfma_f32_16x16x32_bf16 a[40:43], v[44:47], a[184:187], a[40:43]
    buffer_load_dwordx4 v[160:163], v10, s[48:51], s26 offen offset:0 sc1
    v_mfma_f32_16x16x32_bf16 a[76:79], v[44:47], a[188:191], a[76:79]
    s_waitcnt lgkmcnt(9)
    ds_read_b64_tr_b16 v[38:39], v11 offset:23264
    v_mfma_f32_16x16x32_bf16 a[8:11], v[16:19], a[180:183], a[8:11]
    ds_read_b64_tr_b16 v[40:41], v11 offset:18688
    v_mfma_f32_16x16x32_bf16 a[44:47], v[16:19], a[184:187], a[44:47]
    buffer_load_dwordx4 v[164:167], v10, s[48:51], s26 offen offset:1024 sc1
    v_mfma_f32_16x16x32_bf16 a[80:83], v[16:19], a[188:191], a[80:83]
    s_waitcnt lgkmcnt(9)
    ds_read_b64_tr_b16 v[42:43], v11 offset:23296
    v_mfma_f32_16x16x32_bf16 a[12:15], v[20:23], a[180:183], a[12:15]
    ds_read_b64_tr_b16 v[44:45], v11 offset:27648
    v_mfma_f32_16x16x32_bf16 a[48:51], v[20:23], a[184:187], a[48:51]
    v_mfma_f32_16x16x32_bf16 a[84:87], v[20:23], a[188:191], a[84:87]
    s_waitcnt lgkmcnt(9)
    ds_read_b64_tr_b16 v[46:47], v11 offset:32256
    v_mfma_f32_16x16x32_bf16 a[16:19], v[24:27], a[180:183], a[16:19]
    ds_read_b64_tr_b16 v[16:17], v11 offset:27680
    v_mfma_f32_16x16x32_bf16 a[52:55], v[24:27], a[184:187], a[52:55]
    buffer_load_dwordx4 v[168:171], v10, s[48:51], s26 offen offset:2048 sc1
    v_mfma_f32_16x16x32_bf16 a[88:91], v[24:27], a[188:191], a[88:91]
    s_waitcnt lgkmcnt(9)
    ds_read_b64_tr_b16 v[18:19], v11 offset:32288
    v_mfma_f32_16x16x32_bf16 a[20:23], v[28:31], a[180:183], a[20:23]
    s_add_u32 s26, s26, 12288
    ds_read_b64_tr_b16 v[20:21], v11 offset:27712
    v_mfma_f32_16x16x32_bf16 a[56:59], v[28:31], a[184:187], a[56:59]
    buffer_load_dwordx4 v[172:175], v10, s[48:51], s26 offen offset:0 sc1
    v_mfma_f32_16x16x32_bf16 a[92:95], v[28:31], a[188:191], a[92:95]
    s_waitcnt lgkmcnt(9)
    ds_read_b64_tr_b16 v[22:23], v11 offset:32320
    v_mfma_f32_16x16x32_bf16 a[24:27], v[32:35], a[180:183], a[24:27]
    ds_read_b64_tr_b16 v[24:25], v11 offset:27744
    v_mfma_f32_16x16x32_bf16 a[60:63], v[32:35], a[184:187], a[60:63]
    v_mfma_f32_16x16x32_bf16 a[96:99], v[32:35], a[188:191], a[96:99]
    s_waitcnt lgkmcnt(9)
    ds_read_b64_tr_b16 v[26:27], v11 offset:32352
    v_mfma_f32_16x16x32_bf16 a[28:31], v[36:39], a[180:183], a[28:31]
    ds_read_b64_tr_b16 v[28:29], v11 offset:27776
    v_mfma_f32_16x16x32_bf16 a[64:67], v[36:39], a[184:187], a[64:67]
    buffer_load_dwordx4 v[176:179], v10, s[48:51], s26 offen offset:1024 sc1
    v_mfma_f32_16x16x32_bf16 a[100:103], v[36:39], a[188:191], a[100:103]
    s_waitcnt lgkmcnt(9)
    ds_read_b64_tr_b16 v[30:31], v11 offset:32384
    v_mfma_f32_16x16x32_bf16 a[32:35], v[40:43], a[180:183], a[32:35]
    ds_read_b64_tr_b16 v[32:33], v11 offset:27808
    v_mfma_f32_16x16x32_bf16 a[68:71], v[40:43], a[184:187], a[68:71]
    buffer_load_dwordx4 v[180:183], v10, s[48:51], s26 offen offset:2048 sc1
    v_mfma_f32_16x16x32_bf16 a[104:107], v[40:43], a[188:191], a[104:107]
    ds_read_b64_tr_b16 v[34:35], v11 offset:32416
    s_waitcnt vmcnt(37) lgkmcnt(10)
    v_mfma_f32_16x16x32_bf16 a[0:3], v[44:47], a[192:195], a[0:3]
    ds_read_b64_tr_b16 v[36:37], v11 offset:27840
    v_mfma_f32_16x16x32_bf16 a[36:39], v[44:47], a[196:199], a[36:39]
    v_mfma_f32_16x16x32_bf16 a[72:75], v[44:47], a[200:203], a[72:75]
    s_waitcnt lgkmcnt(9)
    ds_read_b64_tr_b16 v[38:39], v11 offset:32448
    v_mfma_f32_16x16x32_bf16 a[4:7], v[16:19], a[192:195], a[4:7]
    s_add_u32 s26, s26, 36864
    ds_read_b64_tr_b16 v[40:41], v11 offset:27872
    v_mfma_f32_16x16x32_bf16 a[40:43], v[16:19], a[196:199], a[40:43]
    buffer_load_dwordx4 v[184:187], v10, s[48:51], s26 offen offset:0 sc1
    v_mfma_f32_16x16x32_bf16 a[76:79], v[16:19], a[200:203], a[76:79]
    s_waitcnt lgkmcnt(9)
    ds_read_b64_tr_b16 v[42:43], v11 offset:32480
    v_mfma_f32_16x16x32_bf16 a[8:11], v[20:23], a[192:195], a[8:11]
    ds_read_b64_tr_b16 v[44:45], v11 offset:27904
    v_mfma_f32_16x16x32_bf16 a[44:47], v[20:23], a[196:199], a[44:47]
    buffer_load_dwordx4 v[188:191], v10, s[48:51], s26 offen offset:1024 sc1
    v_mfma_f32_16x16x32_bf16 a[80:83], v[20:23], a[200:203], a[80:83]
    ds_read_b64_tr_b16 v[46:47], v11 offset:32512
    s_waitcnt vmcnt(29) lgkmcnt(0)
    s_barrier
    v_mfma_f32_16x16x32_bf16 a[12:15], v[24:27], a[192:195], a[12:15]
    ds_read_b64_tr_b16 v[16:17], v7 offset:256
    v_mfma_f32_16x16x32_bf16 a[48:51], v[24:27], a[196:199], a[48:51]
    v_mfma_f32_16x16x32_bf16 a[84:87], v[24:27], a[200:203], a[84:87]
    s_waitcnt lgkmcnt(9)
    ds_read_b64_tr_b16 v[18:19], v7 offset:4864
    v_mfma_f32_16x16x32_bf16 a[16:19], v[28:31], a[192:195], a[16:19]
    ds_read_b64_tr_b16 v[20:21], v7 offset:0
    v_mfma_f32_16x16x32_bf16 a[52:55], v[28:31], a[196:199], a[52:55]
    buffer_load_dwordx4 v[192:195], v10, s[48:51], s26 offen offset:2048 sc1
    v_mfma_f32_16x16x32_bf16 a[88:91], v[28:31], a[200:203], a[88:91]
    s_waitcnt lgkmcnt(9)
    ds_read_b64_tr_b16 v[22:23], v7 offset:4608
    v_mfma_f32_16x16x32_bf16 a[20:23], v[32:35], a[192:195], a[20:23]
    s_add_u32 s26, s26, 12288
    ds_read_b64_tr_b16 v[24:25], v7 offset:32
    v_mfma_f32_16x16x32_bf16 a[56:59], v[32:35], a[196:199], a[56:59]
    buffer_load_dwordx4 v[196:199], v10, s[48:51], s26 offen offset:0 sc1
    v_mfma_f32_16x16x32_bf16 a[92:95], v[32:35], a[200:203], a[92:95]
    s_waitcnt lgkmcnt(9)
    ds_read_b64_tr_b16 v[26:27], v7 offset:4640
    v_mfma_f32_16x16x32_bf16 a[24:27], v[36:39], a[192:195], a[24:27]
    ds_read_b64_tr_b16 v[28:29], v7 offset:64
    v_mfma_f32_16x16x32_bf16 a[60:63], v[36:39], a[196:199], a[60:63]
    v_mfma_f32_16x16x32_bf16 a[96:99], v[36:39], a[200:203], a[96:99]
    s_waitcnt lgkmcnt(9)
    ds_read_b64_tr_b16 v[30:31], v7 offset:4672
    v_mfma_f32_16x16x32_bf16 a[28:31], v[40:43], a[192:195], a[28:31]
    ds_read_b64_tr_b16 v[32:33], v7 offset:96
    v_mfma_f32_16x16x32_bf16 a[64:67], v[40:43], a[196:199], a[64:67]
    buffer_load_dwordx4 v[200:203], v10, s[48:51], s26 offen offset:1024 sc1
    v_mfma_f32_16x16x32_bf16 a[100:103], v[40:43], a[200:203], a[100:103]
    s_waitcnt lgkmcnt(9)
    ds_read_b64_tr_b16 v[34:35], v7 offset:4704
    v_mfma_f32_16x16x32_bf16 a[32:35], v[44:47], a[192:195], a[32:35]
    ds_read_b64_tr_b16 v[36:37], v7 offset:128
    v_mfma_f32_16x16x32_bf16 a[68:71], v[44:47], a[196:199], a[68:71]
    buffer_load_dwordx4 v[204:207], v10, s[48:51], s26 offen offset:2048 sc1
    v_mfma_f32_16x16x32_bf16 a[104:107], v[44:47], a[200:203], a[104:107]
    ds_read_b64_tr_b16 v[38:39], v7 offset:4736
    s_waitcnt vmcnt(30) lgkmcnt(10)
    v_mfma_f32_16x16x32_bf16 a[32:35], v[16:19], a[204:207], a[32:35]
    ds_read_b64_tr_b16 v[40:41], v7 offset:160
    v_mfma_f32_16x16x32_bf16 a[68:71], v[16:19], a[208:211], a[68:71]
    v_mfma_f32_16x16x32_bf16 a[104:107], v[16:19], a[212:215], a[104:107]
    s_waitcnt lgkmcnt(9)
    ds_read_b64_tr_b16 v[42:43], v7 offset:4768
    v_mfma_f32_16x16x32_bf16 a[0:3], v[20:23], a[204:207], a[0:3]
    s_cmp_le_u32 s78, 1
    s_cselect_b32 s58, 2, 1
    s_lshl_b32 s58, s58, 3
    s_add_u32 s58, s58, s79
    s_add_u32 s58, s58, 2
    s_mul_i32 s58, s58, 36864
    s_add_u32 m0, s59, 73728
    ds_read_b64_tr_b16 v[44:45], v7 offset:9472
    v_mfma_f32_16x16x32_bf16 a[36:39], v[20:23], a[208:211], a[36:39]
    buffer_load_dwordx4 v1, s[72:75], s58 offen sc1 lds
    v_mfma_f32_16x16x32_bf16 a[72:75], v[20:23], a[212:215], a[72:75]
    s_waitcnt lgkmcnt(9)
    ds_read_b64_tr_b16 v[46:47], v7 offset:14080
    v_mfma_f32_16x16x32_bf16 a[4:7], v[24:27], a[204:207], a[4:7]
    s_add_u32 m0, s59, 74752
    ds_read_b64_tr_b16 v[16:17], v7 offset:9216
    v_mfma_f32_16x16x32_bf16 a[40:43], v[24:27], a[208:211], a[40:43]
    buffer_load_dwordx4 v2, s[72:75], s58 offen sc1 lds
    v_mfma_f32_16x16x32_bf16 a[76:79], v[24:27], a[212:215], a[76:79]
    s_waitcnt lgkmcnt(9)
    ds_read_b64_tr_b16 v[18:19], v7 offset:13824
    v_mfma_f32_16x16x32_bf16 a[8:11], v[28:31], a[204:207], a[8:11]
    ds_read_b64_tr_b16 v[20:21], v7 offset:9248
    v_mfma_f32_16x16x32_bf16 a[44:47], v[28:31], a[208:211], a[44:47]
    v_mfma_f32_16x16x32_bf16 a[80:83], v[28:31], a[212:215], a[80:83]
    s_waitcnt lgkmcnt(9)
    ds_read_b64_tr_b16 v[22:23], v7 offset:13856
    v_mfma_f32_16x16x32_bf16 a[12:15], v[32:35], a[204:207], a[12:15]
    s_add_u32 m0, s59, 75776
    ds_read_b64_tr_b16 v[24:25], v7 offset:9280
    v_mfma_f32_16x16x32_bf16 a[48:51], v[32:35], a[208:211], a[48:51]
    buffer_load_dwordx4 v4, s[72:75], s58 offen sc1 lds
    v_mfma_f32_16x16x32_bf16 a[84:87], v[32:35], a[212:215], a[84:87]
    s_waitcnt lgkmcnt(9)
    ds_read_b64_tr_b16 v[26:27], v7 offset:13888
    v_mfma_f32_16x16x32_bf16 a[16:19], v[36:39], a[204:207], a[16:19]
    s_add_u32 m0, s59, 76800
    ds_read_b64_tr_b16 v[28:29], v7 offset:9312
    v_mfma_f32_16x16x32_bf16 a[52:55], v[36:39], a[208:211], a[52:55]
    buffer_load_dwordx4 v5, s[72:75], s58 offen sc1 lds
    v_mfma_f32_16x16x32_bf16 a[88:91], v[36:39], a[212:215], a[88:91]
    s_waitcnt lgkmcnt(9)
    ds_read_b64_tr_b16 v[30:31], v7 offset:13920
    v_mfma_f32_16x16x32_bf16 a[20:23], v[40:43], a[204:207], a[20:23]
    ds_read_b64_tr_b16 v[32:33], v7 offset:9344
    v_mfma_f32_16x16x32_bf16 a[56:59], v[40:43], a[208:211], a[56:59]
    v_mfma_f32_16x16x32_bf16 a[92:95], v[40:43], a[212:215], a[92:95]
    ds_read_b64_tr_b16 v[34:35], v7 offset:13952
    s_waitcnt vmcnt(31) lgkmcnt(10)
    v_mfma_f32_16x16x32_bf16 a[32:35], v[44:47], a[216:219], a[32:35]
    s_add_u32 m0, s59, 77824
    ds_read_b64_tr_b16 v[36:37], v7 offset:9376
    v_mfma_f32_16x16x32_bf16 a[68:71], v[44:47], a[220:223], a[68:71]
    buffer_load_dwordx4 v6, s[72:75], s58 offen sc1 lds
    v_mfma_f32_16x16x32_bf16 a[104:107], v[44:47], a[224:227], a[104:107]
    s_waitcnt lgkmcnt(9)
    ds_read_b64_tr_b16 v[38:39], v7 offset:13984
    v_mfma_f32_16x16x32_bf16 a[0:3], v[16:19], a[216:219], a[0:3]
    s_add_u32 m0, s59, 78848
    ds_read_b64_tr_b16 v[40:41], v7 offset:18688
    v_mfma_f32_16x16x32_bf16 a[36:39], v[16:19], a[220:223], a[36:39]
    buffer_load_dwordx4 v13, s[72:75], s58 offen sc1 lds
    v_mfma_f32_16x16x32_bf16 a[72:75], v[16:19], a[224:227], a[72:75]
    s_waitcnt lgkmcnt(9)
    ds_read_b64_tr_b16 v[42:43], v7 offset:23296
    v_mfma_f32_16x16x32_bf16 a[4:7], v[20:23], a[216:219], a[4:7]
    ds_read_b64_tr_b16 v[44:45], v7 offset:18432
    v_mfma_f32_16x16x32_bf16 a[40:43], v[20:23], a[220:223], a[40:43]
    v_mfma_f32_16x16x32_bf16 a[76:79], v[20:23], a[224:227], a[76:79]
    s_waitcnt lgkmcnt(9)
    ds_read_b64_tr_b16 v[46:47], v7 offset:23040
    v_mfma_f32_16x16x32_bf16 a[8:11], v[24:27], a[216:219], a[8:11]
    s_add_u32 m0, s59, 79872
    ds_read_b64_tr_b16 v[16:17], v7 offset:18464
    v_mfma_f32_16x16x32_bf16 a[44:47], v[24:27], a[220:223], a[44:47]
    buffer_load_dwordx4 v14, s[72:75], s58 offen sc1 lds
    v_mfma_f32_16x16x32_bf16 a[80:83], v[24:27], a[224:227], a[80:83]
    s_waitcnt lgkmcnt(9)
    ds_read_b64_tr_b16 v[18:19], v7 offset:23072
    v_mfma_f32_16x16x32_bf16 a[12:15], v[28:31], a[216:219], a[12:15]
    s_add_u32 m0, s59, 80896
    ds_read_b64_tr_b16 v[20:21], v7 offset:18496
    v_mfma_f32_16x16x32_bf16 a[48:51], v[28:31], a[220:223], a[48:51]
    buffer_load_dwordx4 v15, s[72:75], s58 offen sc1 lds
    v_mfma_f32_16x16x32_bf16 a[84:87], v[28:31], a[224:227], a[84:87]
    s_waitcnt lgkmcnt(9)
    ds_read_b64_tr_b16 v[22:23], v7 offset:23104
    v_mfma_f32_16x16x32_bf16 a[16:19], v[32:35], a[216:219], a[16:19]
    ds_read_b64_tr_b16 v[24:25], v7 offset:18528
    v_mfma_f32_16x16x32_bf16 a[52:55], v[32:35], a[220:223], a[52:55]
    v_mfma_f32_16x16x32_bf16 a[88:91], v[32:35], a[224:227], a[88:91]
    s_waitcnt lgkmcnt(9)
    ds_read_b64_tr_b16 v[26:27], v7 offset:23136
    v_mfma_f32_16x16x32_bf16 a[20:23], v[36:39], a[216:219], a[20:23]
    s_add_u32 m0, s59, 81920
    ds_read_b64_tr_b16 v[28:29], v7 offset:18560
    v_mfma_f32_16x16x32_bf16 a[56:59], v[36:39], a[220:223], a[56:59]
    buffer_load_dwordx4 v251, s[72:75], s58 offen sc1 lds
    v_mfma_f32_16x16x32_bf16 a[92:95], v[36:39], a[224:227], a[92:95]
    ds_read_b64_tr_b16 v[30:31], v7 offset:23168
    s_waitcnt vmcnt(33) lgkmcnt(10)
    v_mfma_f32_16x16x32_bf16 a[32:35], v[40:43], a[228:231], a[32:35]
    s_cmp_le_u32 s78, 1
    s_cselect_b32 s26, 2, 1
    s_mul_i32 s26, s26, 98304
    s_add_u32 s26, s26, s25
    s_add_u32 s26, s26, 24576
    ds_read_b64_tr_b16 v[32:33], v7 offset:18592
    v_mfma_f32_16x16x32_bf16 a[68:71], v[40:43], a[232:235], a[68:71]
    buffer_load_dwordx4 v[208:211], v10, s[48:51], s26 offen offset:0 sc1
    v_mfma_f32_16x16x32_bf16 a[104:107], v[40:43], a[236:239], a[104:107]
    s_waitcnt lgkmcnt(9)
    ds_read_b64_tr_b16 v[34:35], v7 offset:23200
    v_mfma_f32_16x16x32_bf16 a[0:3], v[44:47], a[228:231], a[0:3]
    ds_read_b64_tr_b16 v[36:37], v7 offset:27904
    v_mfma_f32_16x16x32_bf16 a[36:39], v[44:47], a[232:235], a[36:39]
    v_mfma_f32_16x16x32_bf16 a[72:75], v[44:47], a[236:239], a[72:75]
    s_waitcnt lgkmcnt(9)
    ds_read_b64_tr_b16 v[38:39], v7 offset:32512
    v_mfma_f32_16x16x32_bf16 a[4:7], v[16:19], a[228:231], a[4:7]
    ds_read_b64_tr_b16 v[40:41], v7 offset:27648
    v_mfma_f32_16x16x32_bf16 a[40:43], v[16:19], a[232:235], a[40:43]
    buffer_load_dwordx4 v[212:215], v10, s[48:51], s26 offen offset:1024 sc1
    v_mfma_f32_16x16x32_bf16 a[76:79], v[16:19], a[236:239], a[76:79]
    s_waitcnt lgkmcnt(9)
    ds_read_b64_tr_b16 v[42:43], v7 offset:32256
    v_mfma_f32_16x16x32_bf16 a[8:11], v[20:23], a[228:231], a[8:11]
    ds_read_b64_tr_b16 v[44:45], v7 offset:27680
    v_mfma_f32_16x16x32_bf16 a[44:47], v[20:23], a[232:235], a[44:47]
    buffer_load_dwordx4 v[216:219], v10, s[48:51], s26 offen offset:2048 sc1
    v_mfma_f32_16x16x32_bf16 a[80:83], v[20:23], a[236:239], a[80:83]
    s_waitcnt lgkmcnt(9)
    ds_read_b64_tr_b16 v[46:47], v7 offset:32288
    v_mfma_f32_16x16x32_bf16 a[12:15], v[24:27], a[228:231], a[12:15]
    ds_read_b64_tr_b16 v[16:17], v7 offset:27712
    v_mfma_f32_16x16x32_bf16 a[48:51], v[24:27], a[232:235], a[48:51]
    v_mfma_f32_16x16x32_bf16 a[84:87], v[24:27], a[236:239], a[84:87]
    s_waitcnt lgkmcnt(9)
    ds_read_b64_tr_b16 v[18:19], v7 offset:32320
    v_mfma_f32_16x16x32_bf16 a[16:19], v[28:31], a[228:231], a[16:19]
    s_add_u32 s26, s26, 12288
    ds_read_b64_tr_b16 v[20:21], v7 offset:27744
    v_mfma_f32_16x16x32_bf16 a[52:55], v[28:31], a[232:235], a[52:55]
    buffer_load_dwordx4 v[220:223], v10, s[48:51], s26 offen offset:0 sc1
    v_mfma_f32_16x16x32_bf16 a[88:91], v[28:31], a[236:239], a[88:91]
    s_waitcnt lgkmcnt(9)
    ds_read_b64_tr_b16 v[22:23], v7 offset:32352
    v_mfma_f32_16x16x32_bf16 a[20:23], v[32:35], a[228:231], a[20:23]
    ds_read_b64_tr_b16 v[24:25], v7 offset:27776
    v_mfma_f32_16x16x32_bf16 a[56:59], v[32:35], a[232:235], a[56:59]
    buffer_load_dwordx4 v[224:227], v10, s[48:51], s26 offen offset:1024 sc1
    v_mfma_f32_16x16x32_bf16 a[92:95], v[32:35], a[236:239], a[92:95]
    ds_read_b64_tr_b16 v[26:27], v7 offset:32384
    s_waitcnt vmcnt(35) lgkmcnt(10)
    v_mfma_f32_16x16x32_bf16 a[32:35], v[36:39], a[240:243], a[32:35]
    ds_read_b64_tr_b16 v[28:29], v7 offset:27808
    v_mfma_f32_16x16x32_bf16 a[68:71], v[36:39], a[244:247], a[68:71]
    v_mfma_f32_16x16x32_bf16 a[104:107], v[36:39], a[248:251], a[104:107]
    ds_read_b64_tr_b16 v[30:31], v7 offset:32416
    s_waitcnt vmcnt(26) lgkmcnt(10)
    s_barrier
    v_mfma_f32_16x16x32_bf16 a[0:3], v[40:43], a[240:243], a[0:3]
    ds_read_b64_tr_b16 v[32:33], v8 offset:256
    v_mfma_f32_16x16x32_bf16 a[36:39], v[40:43], a[244:247], a[36:39]
    buffer_load_dwordx4 v[228:231], v10, s[48:51], s26 offen offset:2048 sc1
    v_mfma_f32_16x16x32_bf16 a[72:75], v[40:43], a[248:251], a[72:75]
    s_waitcnt lgkmcnt(9)
    ds_read_b64_tr_b16 v[34:35], v8 offset:4864
    v_mfma_f32_16x16x32_bf16 a[4:7], v[44:47], a[240:243], a[4:7]
    s_add_u32 s26, s26, 36864
    ds_read_b64_tr_b16 v[36:37], v8 offset:0
    v_mfma_f32_16x16x32_bf16 a[40:43], v[44:47], a[244:247], a[40:43]
    buffer_load_dwordx4 v[64:67], v10, s[48:51], s26 offen offset:0 sc1
    v_mfma_f32_16x16x32_bf16 a[76:79], v[44:47], a[248:251], a[76:79]
    s_waitcnt lgkmcnt(9)
    ds_read_b64_tr_b16 v[38:39], v8 offset:4608
    v_mfma_f32_16x16x32_bf16 a[8:11], v[16:19], a[240:243], a[8:11]
    ds_read_b64_tr_b16 v[40:41], v8 offset:32
    v_mfma_f32_16x16x32_bf16 a[44:47], v[16:19], a[244:247], a[44:47]
    v_mfma_f32_16x16x32_bf16 a[80:83], v[16:19], a[248:251], a[80:83]
    s_waitcnt lgkmcnt(9)
    ds_read_b64_tr_b16 v[42:43], v8 offset:4640
    v_mfma_f32_16x16x32_bf16 a[12:15], v[20:23], a[240:243], a[12:15]
    ds_read_b64_tr_b16 v[44:45], v8 offset:64
    v_mfma_f32_16x16x32_bf16 a[48:51], v[20:23], a[244:247], a[48:51]
    buffer_load_dwordx4 v[68:71], v10, s[48:51], s26 offen offset:1024 sc1
    v_mfma_f32_16x16x32_bf16 a[84:87], v[20:23], a[248:251], a[84:87]
    s_waitcnt lgkmcnt(9)
    ds_read_b64_tr_b16 v[46:47], v8 offset:4672
    v_mfma_f32_16x16x32_bf16 a[16:19], v[24:27], a[240:243], a[16:19]
    ds_read_b64_tr_b16 v[16:17], v8 offset:96
    v_mfma_f32_16x16x32_bf16 a[52:55], v[24:27], a[244:247], a[52:55]
    buffer_load_dwordx4 v[72:75], v10, s[48:51], s26 offen offset:2048 sc1
    v_mfma_f32_16x16x32_bf16 a[88:91], v[24:27], a[248:251], a[88:91]
    s_waitcnt lgkmcnt(9)
    ds_read_b64_tr_b16 v[18:19], v8 offset:4704
    v_mfma_f32_16x16x32_bf16 a[20:23], v[28:31], a[240:243], a[20:23]
    ds_read_b64_tr_b16 v[20:21], v8 offset:128
    v_mfma_f32_16x16x32_bf16 a[56:59], v[28:31], a[244:247], a[56:59]
    v_mfma_f32_16x16x32_bf16 a[92:95], v[28:31], a[248:251], a[92:95]
    ds_read_b64_tr_b16 v[22:23], v8 offset:4736
    s_waitcnt vmcnt(27) lgkmcnt(10)
    v_mfma_f32_16x16x32_bf16 a[32:35], v[32:35], v[160:163], a[32:35]
    s_add_u32 s26, s26, 12288
    ds_read_b64_tr_b16 v[24:25], v8 offset:160
    v_mfma_f32_16x16x32_bf16 a[68:71], v[32:35], v[164:167], a[68:71]
    buffer_load_dwordx4 v[76:79], v10, s[48:51], s26 offen offset:0 sc1
    v_mfma_f32_16x16x32_bf16 a[104:107], v[32:35], v[168:171], a[104:107]
    s_waitcnt lgkmcnt(9)
    ds_read_b64_tr_b16 v[26:27], v8 offset:4768
    v_mfma_f32_16x16x32_bf16 a[0:3], v[36:39], v[160:163], a[0:3]
    ds_read_b64_tr_b16 v[28:29], v8 offset:9472
    v_mfma_f32_16x16x32_bf16 a[36:39], v[36:39], v[164:167], a[36:39]
    buffer_load_dwordx4 v[80:83], v10, s[48:51], s26 offen offset:1024 sc1
    v_mfma_f32_16x16x32_bf16 a[72:75], v[36:39], v[168:171], a[72:75]
    s_waitcnt lgkmcnt(9)
    ds_read_b64_tr_b16 v[30:31], v8 offset:14080
    v_mfma_f32_16x16x32_bf16 a[4:7], v[40:43], v[160:163], a[4:7]
    ds_read_b64_tr_b16 v[32:33], v8 offset:9216
    v_mfma_f32_16x16x32_bf16 a[40:43], v[40:43], v[164:167], a[40:43]
    v_mfma_f32_16x16x32_bf16 a[76:79], v[40:43], v[168:171], a[76:79]
    s_waitcnt lgkmcnt(9)
    ds_read_b64_tr_b16 v[34:35], v8 offset:13824
    v_mfma_f32_16x16x32_bf16 a[8:11], v[44:47], v[160:163], a[8:11]
    ds_read_b64_tr_b16 v[36:37], v8 offset:9248
    v_mfma_f32_16x16x32_bf16 a[44:47], v[44:47], v[164:167], a[44:47]
    buffer_load_dwordx4 v[84:87], v10, s[48:51], s26 offen offset:2048 sc1
    v_mfma_f32_16x16x32_bf16 a[80:83], v[44:47], v[168:171], a[80:83]
    s_waitcnt lgkmcnt(9)
    ds_read_b64_tr_b16 v[38:39], v8 offset:13856
    v_mfma_f32_16x16x32_bf16 a[12:15], v[16:19], v[160:163], a[12:15]
    s_cmp_le_u32 s78, 2
    s_cselect_b32 s58, 3, 2
    s_lshl_b32 s58, s58, 3
    s_add_u32 s58, s58, s79
    s_add_u32 s58, s58, 2
    s_mul_i32 s58, s58, 36864
    s_add_u32 m0, s59, 110592
    ds_read_b64_tr_b16 v[40:41], v8 offset:9280
    v_mfma_f32_16x16x32_bf16 a[48:51], v[16:19], v[164:167], a[48:51]
    buffer_load_dwordx4 v1, s[72:75], s58 offen sc1 lds
    v_mfma_f32_16x16x32_bf16 a[84:87], v[16:19], v[168:171], a[84:87]
    s_waitcnt lgkmcnt(9)
    ds_read_b64_tr_b16 v[42:43], v8 offset:13888
    v_mfma_f32_16x16x32_bf16 a[16:19], v[20:23], v[160:163], a[16:19]
    ds_read_b64_tr_b16 v[44:45], v8 offset:9312
    v_mfma_f32_16x16x32_bf16 a[52:55], v[20:23], v[164:167], a[52:55]
    v_mfma_f32_16x16x32_bf16 a[88:91], v[20:23], v[168:171], a[88:91]
    s_waitcnt lgkmcnt(9)
    ds_read_b64_tr_b16 v[46:47], v8 offset:13920
    v_mfma_f32_16x16x32_bf16 a[20:23], v[24:27], v[160:163], a[20:23]
    s_add_u32 m0, s59, 111616
    ds_read_b64_tr_b16 v[16:17], v8 offset:9344
    v_mfma_f32_16x16x32_bf16 a[56:59], v[24:27], v[164:167], a[56:59]
    buffer_load_dwordx4 v2, s[72:75], s58 offen sc1 lds
    v_mfma_f32_16x16x32_bf16 a[92:95], v[24:27], v[168:171], a[92:95]
    ds_read_b64_tr_b16 v[18:19], v8 offset:13952
    s_waitcnt vmcnt(29) lgkmcnt(10)
    v_mfma_f32_16x16x32_bf16 a[32:35], v[28:31], v[172:175], a[32:35]
    s_add_u32 m0, s59, 112640
    ds_read_b64_tr_b16 v[20:21], v8 offset:9376
    v_mfma_f32_16x16x32_bf16 a[68:71], v[28:31], v[176:179], a[68:71]
    buffer_load_dwordx4 v4, s[72:75], s58 offen sc1 lds
    v_mfma_f32_16x16x32_bf16 a[104:107], v[28:31], v[180:183], a[104:107]
    s_waitcnt lgkmcnt(9)
    ds_read_b64_tr_b16 v[22:23], v8 offset:13984
    v_mfma_f32_16x16x32_bf16 a[0:3], v[32:35], v[172:175], a[0:3]
    ds_read_b64_tr_b16 v[24:25], v8 offset:18688
    v_mfma_f32_16x16x32_bf16 a[36:39], v[32:35], v[176:179], a[36:39]
    v_mfma_f32_16x16x32_bf16 a[72:75], v[32:35], v[180:183], a[72:75]
    s_waitcnt lgkmcnt(9)
    ds_read_b64_tr_b16 v[26:27], v8 offset:23296
    v_mfma_f32_16x16x32_bf16 a[4:7], v[36:39], v[172:175], a[4:7]
    s_add_u32 m0, s59, 113664
    ds_read_b64_tr_b16 v[28:29], v8 offset:18432
    v_mfma_f32_16x16x32_bf16 a[40:43], v[36:39], v[176:179], a[40:43]
    buffer_load_dwordx4 v5, s[72:75], s58 offen sc1 lds
    v_mfma_f32_16x16x32_bf16 a[76:79], v[36:39], v[180:183], a[76:79]
    s_waitcnt lgkmcnt(9)
    ds_read_b64_tr_b16 v[30:31], v8 offset:23040
    v_mfma_f32_16x16x32_bf16 a[8:11], v[40:43], v[172:175], a[8:11]
    s_add_u32 m0, s59, 114688
    ds_read_b64_tr_b16 v[32:33], v8 offset:18464
    v_mfma_f32_16x16x32_bf16 a[44:47], v[40:43], v[176:179], a[44:47]
    buffer_load_dwordx4 v6, s[72:75], s58 offen sc1 lds
    v_mfma_f32_16x16x32_bf16 a[80:83], v[40:43], v[180:183], a[80:83]
    s_waitcnt lgkmcnt(9)
    ds_read_b64_tr_b16 v[34:35], v8 offset:23072
    v_mfma_f32_16x16x32_bf16 a[12:15], v[44:47], v[172:175], a[12:15]
    ds_read_b64_tr_b16 v[36:37], v8 offset:18496
    v_mfma_f32_16x16x32_bf16 a[48:51], v[44:47], v[176:179], a[48:51]
    v_mfma_f32_16x16x32_bf16 a[84:87], v[44:47], v[180:183], a[84:87]
    s_waitcnt lgkmcnt(9)
    ds_read_b64_tr_b16 v[38:39], v8 offset:23104
    v_mfma_f32_16x16x32_bf16 a[16:19], v[16:19], v[172:175], a[16:19]
    s_add_u32 m0, s59, 115712
    ds_read_b64_tr_b16 v[40:41], v8 offset:18528
    v_mfma_f32_16x16x32_bf16 a[52:55], v[16:19], v[176:179], a[52:55]
    buffer_load_dwordx4 v13, s[72:75], s58 offen sc1 lds
    v_mfma_f32_16x16x32_bf16 a[88:91], v[16:19], v[180:183], a[88:91]
    s_waitcnt lgkmcnt(9)
    ds_read_b64_tr_b16 v[42:43], v8 offset:23136
    v_mfma_f32_16x16x32_bf16 a[20:23], v[20:23], v[172:175], a[20:23]
    s_add_u32 m0, s59, 116736
    ds_read_b64_tr_b16 v[44:45], v8 offset:18560
    v_mfma_f32_16x16x32_bf16 a[56:59], v[20:23], v[176:179], a[56:59]
    buffer_load_dwordx4 v14, s[72:75], s58 offen sc1 lds
    v_mfma_f32_16x16x32_bf16 a[92:95], v[20:23], v[180:183], a[92:95]
    ds_read_b64_tr_b16 v[46:47], v8 offset:23168
    s_waitcnt vmcnt(31) lgkmcnt(10)
    v_mfma_f32_16x16x32_bf16 a[32:35], v[24:27], v[184:187], a[32:35]
    ds_read_b64_tr_b16 v[16:17], v8 offset:18592
    v_mfma_f32_16x16x32_bf16 a[68:71], v[24:27], v[188:191], a[68:71]
    v_mfma_f32_16x16x32_bf16 a[104:107], v[24:27], v[192:195], a[104:107]
    s_waitcnt lgkmcnt(9)
    ds_read_b64_tr_b16 v[18:19], v8 offset:23200
    v_mfma_f32_16x16x32_bf16 a[0:3], v[28:31], v[184:187], a[0:3]
    s_add_u32 m0, s59, 117760
    ds_read_b64_tr_b16 v[20:21], v8 offset:27904
    v_mfma_f32_16x16x32_bf16 a[36:39], v[28:31], v[188:191], a[36:39]
    buffer_load_dwordx4 v15, s[72:75], s58 offen sc1 lds
    v_mfma_f32_16x16x32_bf16 a[72:75], v[28:31], v[192:195], a[72:75]
    s_waitcnt lgkmcnt(9)
    ds_read_b64_tr_b16 v[22:23], v8 offset:32512
    v_mfma_f32_16x16x32_bf16 a[4:7], v[32:35], v[184:187], a[4:7]
    s_add_u32 m0, s59, 118784
    ds_read_b64_tr_b16 v[24:25], v8 offset:27648
    v_mfma_f32_16x16x32_bf16 a[40:43], v[32:35], v[188:191], a[40:43]
    buffer_load_dwordx4 v251, s[72:75], s58 offen sc1 lds
    v_mfma_f32_16x16x32_bf16 a[76:79], v[32:35], v[192:195], a[76:79]
    s_waitcnt lgkmcnt(9)
    ds_read_b64_tr_b16 v[26:27], v8 offset:32256
    v_mfma_f32_16x16x32_bf16 a[8:11], v[36:39], v[184:187], a[8:11]
    ds_read_b64_tr_b16 v[28:29], v8 offset:27680
    v_mfma_f32_16x16x32_bf16 a[44:47], v[36:39], v[188:191], a[44:47]
    v_mfma_f32_16x16x32_bf16 a[80:83], v[36:39], v[192:195], a[80:83]
    s_waitcnt lgkmcnt(9)
    ds_read_b64_tr_b16 v[30:31], v8 offset:32288
    v_mfma_f32_16x16x32_bf16 a[12:15], v[40:43], v[184:187], a[12:15]
    s_cmp_le_u32 s78, 2
    s_cselect_b32 s26, 3, 2
    s_mul_i32 s26, s26, 98304
    s_add_u32 s26, s26, s25
    s_add_u32 s26, s26, 24576
    ds_read_b64_tr_b16 v[32:33], v8 offset:27712
    v_mfma_f32_16x16x32_bf16 a[48:51], v[40:43], v[188:191], a[48:51]
    buffer_load_dwordx4 v[88:91], v10, s[48:51], s26 offen offset:0 sc1
    v_mfma_f32_16x16x32_bf16 a[84:87], v[40:43], v[192:195], a[84:87]
    s_waitcnt lgkmcnt(9)
    ds_read_b64_tr_b16 v[34:35], v8 offset:32320
    v_mfma_f32_16x16x32_bf16 a[16:19], v[44:47], v[184:187], a[16:19]
    ds_read_b64_tr_b16 v[36:37], v8 offset:27744
    v_mfma_f32_16x16x32_bf16 a[52:55], v[44:47], v[188:191], a[52:55]
    buffer_load_dwordx4 v[92:95], v10, s[48:51], s26 offen offset:1024 sc1
    v_mfma_f32_16x16x32_bf16 a[88:91], v[44:47], v[192:195], a[88:91]
    s_waitcnt lgkmcnt(9)
    ds_read_b64_tr_b16 v[38:39], v8 offset:32352
    v_mfma_f32_16x16x32_bf16 a[20:23], v[16:19], v[184:187], a[20:23]
    ds_read_b64_tr_b16 v[40:41], v8 offset:27776
    v_mfma_f32_16x16x32_bf16 a[56:59], v[16:19], v[188:191], a[56:59]
    v_mfma_f32_16x16x32_bf16 a[92:95], v[16:19], v[192:195], a[92:95]
    ds_read_b64_tr_b16 v[42:43], v8 offset:32384
    s_waitcnt vmcnt(32) lgkmcnt(10)
    v_mfma_f32_16x16x32_bf16 a[32:35], v[20:23], v[196:199], a[32:35]
    ds_read_b64_tr_b16 v[44:45], v8 offset:27808
    v_mfma_f32_16x16x32_bf16 a[68:71], v[20:23], v[200:203], a[68:71]
    buffer_load_dwordx4 v[96:99], v10, s[48:51], s26 offen offset:2048 sc1
    v_mfma_f32_16x16x32_bf16 a[104:107], v[20:23], v[204:207], a[104:107]
    ds_read_b64_tr_b16 v[46:47], v8 offset:32416
    s_waitcnt vmcnt(24) lgkmcnt(10)
    s_barrier
    v_mfma_f32_16x16x32_bf16 a[0:3], v[24:27], v[196:199], a[0:3]
    s_add_u32 s26, s26, 12288
    ds_read_b64_tr_b16 v[16:17], v9 offset:256
    v_mfma_f32_16x16x32_bf16 a[36:39], v[24:27], v[200:203], a[36:39]
    buffer_load_dwordx4 v[100:103], v10, s[48:51], s26 offen offset:0 sc1
    v_mfma_f32_16x16x32_bf16 a[72:75], v[24:27], v[204:207], a[72:75]
    s_waitcnt lgkmcnt(9)
    ds_read_b64_tr_b16 v[18:19], v9 offset:4864
    v_mfma_f32_16x16x32_bf16 a[4:7], v[28:31], v[196:199], a[4:7]
    ds_read_b64_tr_b16 v[20:21], v9 offset:0
    v_mfma_f32_16x16x32_bf16 a[40:43], v[28:31], v[200:203], a[40:43]
    v_mfma_f32_16x16x32_bf16 a[76:79], v[28:31], v[204:207], a[76:79]
    s_waitcnt lgkmcnt(9)
    ds_read_b64_tr_b16 v[22:23], v9 offset:4608
    v_mfma_f32_16x16x32_bf16 a[8:11], v[32:35], v[196:199], a[8:11]
    ds_read_b64_tr_b16 v[24:25], v9 offset:32
    v_mfma_f32_16x16x32_bf16 a[44:47], v[32:35], v[200:203], a[44:47]
    buffer_load_dwordx4 v[104:107], v10, s[48:51], s26 offen offset:1024 sc1
    v_mfma_f32_16x16x32_bf16 a[80:83], v[32:35], v[204:207], a[80:83]
    s_waitcnt lgkmcnt(9)
    ds_read_b64_tr_b16 v[26:27], v9 offset:4640
    v_mfma_f32_16x16x32_bf16 a[12:15], v[36:39], v[196:199], a[12:15]
    ds_read_b64_tr_b16 v[28:29], v9 offset:64
    v_mfma_f32_16x16x32_bf16 a[48:51], v[36:39], v[200:203], a[48:51]
    buffer_load_dwordx4 v[108:111], v10, s[48:51], s26 offen offset:2048 sc1
    v_mfma_f32_16x16x32_bf16 a[84:87], v[36:39], v[204:207], a[84:87]
    s_waitcnt lgkmcnt(9)
    ds_read_b64_tr_b16 v[30:31], v9 offset:4672
    v_mfma_f32_16x16x32_bf16 a[16:19], v[40:43], v[196:199], a[16:19]
    ds_read_b64_tr_b16 v[32:33], v9 offset:96
    v_mfma_f32_16x16x32_bf16 a[52:55], v[40:43], v[200:203], a[52:55]
    v_mfma_f32_16x16x32_bf16 a[88:91], v[40:43], v[204:207], a[88:91]
    s_waitcnt lgkmcnt(9)
    ds_read_b64_tr_b16 v[34:35], v9 offset:4704
    v_mfma_f32_16x16x32_bf16 a[20:23], v[44:47], v[196:199], a[20:23]
    s_add_u32 s26, s26, 36864
    ds_read_b64_tr_b16 v[36:37], v9 offset:128
    v_mfma_f32_16x16x32_bf16 a[56:59], v[44:47], v[200:203], a[56:59]
    buffer_load_dwordx4 v[112:115], v10, s[48:51], s26 offen offset:0 sc1
    v_mfma_f32_16x16x32_bf16 a[92:95], v[44:47], v[204:207], a[92:95]
    ds_read_b64_tr_b16 v[38:39], v9 offset:4736
    s_waitcnt vmcnt(25) lgkmcnt(10)
    v_mfma_f32_16x16x32_bf16 a[32:35], v[16:19], v[208:211], a[32:35]
    ds_read_b64_tr_b16 v[40:41], v9 offset:160
    v_mfma_f32_16x16x32_bf16 a[68:71], v[16:19], v[212:215], a[68:71]
    buffer_load_dwordx4 v[116:119], v10, s[48:51], s26 offen offset:1024 sc1
    v_mfma_f32_16x16x32_bf16 a[104:107], v[16:19], v[216:219], a[104:107]
    s_waitcnt lgkmcnt(9)
    ds_read_b64_tr_b16 v[42:43], v9 offset:4768
    v_mfma_f32_16x16x32_bf16 a[0:3], v[20:23], v[208:211], a[0:3]
    ds_read_b64_tr_b16 v[44:45], v9 offset:9472
    v_mfma_f32_16x16x32_bf16 a[36:39], v[20:23], v[212:215], a[36:39]
    v_mfma_f32_16x16x32_bf16 a[72:75], v[20:23], v[216:219], a[72:75]
    s_waitcnt lgkmcnt(9)
    ds_read_b64_tr_b16 v[46:47], v9 offset:14080
    v_mfma_f32_16x16x32_bf16 a[4:7], v[24:27], v[208:211], a[4:7]
    ds_read_b64_tr_b16 v[16:17], v9 offset:9216
    v_mfma_f32_16x16x32_bf16 a[40:43], v[24:27], v[212:215], a[40:43]
    buffer_load_dwordx4 v[120:123], v10, s[48:51], s26 offen offset:2048 sc1
    v_mfma_f32_16x16x32_bf16 a[76:79], v[24:27], v[216:219], a[76:79]
    s_waitcnt lgkmcnt(9)
    ds_read_b64_tr_b16 v[18:19], v9 offset:13824
    v_mfma_f32_16x16x32_bf16 a[8:11], v[28:31], v[208:211], a[8:11]
    s_add_u32 s26, s26, 12288
    ds_read_b64_tr_b16 v[20:21], v9 offset:9248
    v_mfma_f32_16x16x32_bf16 a[44:47], v[28:31], v[212:215], a[44:47]
    buffer_load_dwordx4 v[124:127], v10, s[48:51], s26 offen offset:0 sc1
    v_mfma_f32_16x16x32_bf16 a[80:83], v[28:31], v[216:219], a[80:83]
    s_waitcnt lgkmcnt(9)
    ds_read_b64_tr_b16 v[22:23], v9 offset:13856
    v_mfma_f32_16x16x32_bf16 a[12:15], v[32:35], v[208:211], a[12:15]
    ds_read_b64_tr_b16 v[24:25], v9 offset:9280
    v_mfma_f32_16x16x32_bf16 a[48:51], v[32:35], v[212:215], a[48:51]
    v_mfma_f32_16x16x32_bf16 a[84:87], v[32:35], v[216:219], a[84:87]
    s_waitcnt lgkmcnt(9)
    ds_read_b64_tr_b16 v[26:27], v9 offset:13888
    v_mfma_f32_16x16x32_bf16 a[16:19], v[36:39], v[208:211], a[16:19]
    ds_read_b64_tr_b16 v[28:29], v9 offset:9312
    v_mfma_f32_16x16x32_bf16 a[52:55], v[36:39], v[212:215], a[52:55]
    buffer_load_dwordx4 v[128:131], v10, s[48:51], s26 offen offset:1024 sc1
    v_mfma_f32_16x16x32_bf16 a[88:91], v[36:39], v[216:219], a[88:91]
    s_waitcnt lgkmcnt(9)
    ds_read_b64_tr_b16 v[30:31], v9 offset:13920
    v_mfma_f32_16x16x32_bf16 a[20:23], v[40:43], v[208:211], a[20:23]
    ds_read_b64_tr_b16 v[32:33], v9 offset:9344
    v_mfma_f32_16x16x32_bf16 a[56:59], v[40:43], v[212:215], a[56:59]
    buffer_load_dwordx4 v[132:135], v10, s[48:51], s26 offen offset:2048 sc1
    v_mfma_f32_16x16x32_bf16 a[92:95], v[40:43], v[216:219], a[92:95]
    ds_read_b64_tr_b16 v[34:35], v9 offset:13952
    s_waitcnt vmcnt(27) lgkmcnt(10)
    v_mfma_f32_16x16x32_bf16 a[32:35], v[44:47], v[220:223], a[32:35]
    ds_read_b64_tr_b16 v[36:37], v9 offset:9376
    v_mfma_f32_16x16x32_bf16 a[68:71], v[44:47], v[224:227], a[68:71]
    v_mfma_f32_16x16x32_bf16 a[104:107], v[44:47], v[228:231], a[104:107]
    s_waitcnt lgkmcnt(9)
    ds_read_b64_tr_b16 v[38:39], v9 offset:13984
    v_mfma_f32_16x16x32_bf16 a[0:3], v[16:19], v[220:223], a[0:3]
    ds_read_b64_tr_b16 v[40:41], v9 offset:18688
    v_mfma_f32_16x16x32_bf16 a[36:39], v[16:19], v[224:227], a[36:39]
    v_mfma_f32_16x16x32_bf16 a[72:75], v[16:19], v[228:231], a[72:75]
    s_waitcnt lgkmcnt(9)
    ds_read_b64_tr_b16 v[42:43], v9 offset:23296
    v_mfma_f32_16x16x32_bf16 a[4:7], v[20:23], v[220:223], a[4:7]
    ds_read_b64_tr_b16 v[44:45], v9 offset:18432
    v_mfma_f32_16x16x32_bf16 a[40:43], v[20:23], v[224:227], a[40:43]
    v_mfma_f32_16x16x32_bf16 a[76:79], v[20:23], v[228:231], a[76:79]
    s_waitcnt lgkmcnt(9)
    ds_read_b64_tr_b16 v[46:47], v9 offset:23040
    v_mfma_f32_16x16x32_bf16 a[8:11], v[24:27], v[220:223], a[8:11]
    ds_read_b64_tr_b16 v[16:17], v9 offset:18464
    v_mfma_f32_16x16x32_bf16 a[44:47], v[24:27], v[224:227], a[44:47]
    v_mfma_f32_16x16x32_bf16 a[80:83], v[24:27], v[228:231], a[80:83]
    s_waitcnt lgkmcnt(9)
    ds_read_b64_tr_b16 v[18:19], v9 offset:23072
    v_mfma_f32_16x16x32_bf16 a[12:15], v[28:31], v[220:223], a[12:15]
    ds_read_b64_tr_b16 v[20:21], v9 offset:18496
    v_mfma_f32_16x16x32_bf16 a[48:51], v[28:31], v[224:227], a[48:51]
    v_mfma_f32_16x16x32_bf16 a[84:87], v[28:31], v[228:231], a[84:87]
    s_waitcnt lgkmcnt(9)
    ds_read_b64_tr_b16 v[22:23], v9 offset:23104
    v_mfma_f32_16x16x32_bf16 a[16:19], v[32:35], v[220:223], a[16:19]
    ds_read_b64_tr_b16 v[24:25], v9 offset:18528
    v_mfma_f32_16x16x32_bf16 a[52:55], v[32:35], v[224:227], a[52:55]
    v_mfma_f32_16x16x32_bf16 a[88:91], v[32:35], v[228:231], a[88:91]
    s_waitcnt lgkmcnt(9)
    ds_read_b64_tr_b16 v[26:27], v9 offset:23136
    v_mfma_f32_16x16x32_bf16 a[20:23], v[36:39], v[220:223], a[20:23]
    ds_read_b64_tr_b16 v[28:29], v9 offset:18560
    v_mfma_f32_16x16x32_bf16 a[56:59], v[36:39], v[224:227], a[56:59]
    v_mfma_f32_16x16x32_bf16 a[92:95], v[36:39], v[228:231], a[92:95]
    ds_read_b64_tr_b16 v[30:31], v9 offset:23168
    s_waitcnt vmcnt(24) lgkmcnt(10)
    v_mfma_f32_16x16x32_bf16 a[32:35], v[40:43], v[64:67], a[32:35]
    ds_read_b64_tr_b16 v[32:33], v9 offset:18592
    v_mfma_f32_16x16x32_bf16 a[68:71], v[40:43], v[68:71], a[68:71]
    v_mfma_f32_16x16x32_bf16 a[104:107], v[40:43], v[72:75], a[104:107]
    s_waitcnt lgkmcnt(9)
    ds_read_b64_tr_b16 v[34:35], v9 offset:23200
    v_mfma_f32_16x16x32_bf16 a[0:3], v[44:47], v[64:67], a[0:3]
    ds_read_b64_tr_b16 v[36:37], v9 offset:27904
    v_mfma_f32_16x16x32_bf16 a[36:39], v[44:47], v[68:71], a[36:39]
    v_mfma_f32_16x16x32_bf16 a[72:75], v[44:47], v[72:75], a[72:75]
    s_waitcnt lgkmcnt(9)
    ds_read_b64_tr_b16 v[38:39], v9 offset:32512
    v_mfma_f32_16x16x32_bf16 a[4:7], v[16:19], v[64:67], a[4:7]
    ds_read_b64_tr_b16 v[40:41], v9 offset:27648
    v_mfma_f32_16x16x32_bf16 a[40:43], v[16:19], v[68:71], a[40:43]
    v_mfma_f32_16x16x32_bf16 a[76:79], v[16:19], v[72:75], a[76:79]
    s_waitcnt lgkmcnt(9)
    ds_read_b64_tr_b16 v[42:43], v9 offset:32256
    v_mfma_f32_16x16x32_bf16 a[8:11], v[20:23], v[64:67], a[8:11]
    ds_read_b64_tr_b16 v[44:45], v9 offset:27680
    v_mfma_f32_16x16x32_bf16 a[44:47], v[20:23], v[68:71], a[44:47]
    v_mfma_f32_16x16x32_bf16 a[80:83], v[20:23], v[72:75], a[80:83]
    s_waitcnt lgkmcnt(9)
    ds_read_b64_tr_b16 v[46:47], v9 offset:32288
    v_mfma_f32_16x16x32_bf16 a[12:15], v[24:27], v[64:67], a[12:15]
    ds_read_b64_tr_b16 v[16:17], v9 offset:27712
    v_mfma_f32_16x16x32_bf16 a[48:51], v[24:27], v[68:71], a[48:51]
    v_mfma_f32_16x16x32_bf16 a[84:87], v[24:27], v[72:75], a[84:87]
    s_waitcnt lgkmcnt(9)
    ds_read_b64_tr_b16 v[18:19], v9 offset:32320
    v_mfma_f32_16x16x32_bf16 a[16:19], v[28:31], v[64:67], a[16:19]
    ds_read_b64_tr_b16 v[20:21], v9 offset:27744
    v_mfma_f32_16x16x32_bf16 a[52:55], v[28:31], v[68:71], a[52:55]
    v_mfma_f32_16x16x32_bf16 a[88:91], v[28:31], v[72:75], a[88:91]
    s_waitcnt lgkmcnt(9)
    ds_read_b64_tr_b16 v[22:23], v9 offset:32352
    v_mfma_f32_16x16x32_bf16 a[20:23], v[32:35], v[64:67], a[20:23]
    ds_read_b64_tr_b16 v[24:25], v9 offset:27776
    v_mfma_f32_16x16x32_bf16 a[56:59], v[32:35], v[68:71], a[56:59]
    v_mfma_f32_16x16x32_bf16 a[92:95], v[32:35], v[72:75], a[92:95]
    ds_read_b64_tr_b16 v[26:27], v9 offset:32384
    s_waitcnt vmcnt(21) lgkmcnt(10)
    v_mfma_f32_16x16x32_bf16 a[32:35], v[36:39], v[76:79], a[32:35]
    ds_read_b64_tr_b16 v[28:29], v9 offset:27808
    v_mfma_f32_16x16x32_bf16 a[68:71], v[36:39], v[80:83], a[68:71]
    v_mfma_f32_16x16x32_bf16 a[104:107], v[36:39], v[84:87], a[104:107]
    ds_read_b64_tr_b16 v[30:31], v9 offset:32416
    s_waitcnt vmcnt(12) lgkmcnt(10)
    s_barrier
    v_mfma_f32_16x16x32_bf16 a[0:3], v[40:43], v[76:79], a[0:3]
    ds_read_b64_tr_b16 v[32:33], v11 offset:256
    v_mfma_f32_16x16x32_bf16 a[36:39], v[40:43], v[80:83], a[36:39]
    v_mfma_f32_16x16x32_bf16 a[72:75], v[40:43], v[84:87], a[72:75]
    s_waitcnt lgkmcnt(9)
    ds_read_b64_tr_b16 v[34:35], v11 offset:4864
    v_mfma_f32_16x16x32_bf16 a[4:7], v[44:47], v[76:79], a[4:7]
    ds_read_b64_tr_b16 v[36:37], v11 offset:9472
    v_mfma_f32_16x16x32_bf16 a[40:43], v[44:47], v[80:83], a[40:43]
    v_mfma_f32_16x16x32_bf16 a[76:79], v[44:47], v[84:87], a[76:79]
    s_waitcnt lgkmcnt(9)
    ds_read_b64_tr_b16 v[38:39], v11 offset:14080
    v_mfma_f32_16x16x32_bf16 a[8:11], v[16:19], v[76:79], a[8:11]
    ds_read_b64_tr_b16 v[40:41], v11 offset:18688
    v_mfma_f32_16x16x32_bf16 a[44:47], v[16:19], v[80:83], a[44:47]
    v_mfma_f32_16x16x32_bf16 a[80:83], v[16:19], v[84:87], a[80:83]
    s_waitcnt lgkmcnt(9)
    ds_read_b64_tr_b16 v[42:43], v11 offset:23296
    v_mfma_f32_16x16x32_bf16 a[12:15], v[20:23], v[76:79], a[12:15]
    ds_read_b64_tr_b16 v[44:45], v11 offset:27904
    v_mfma_f32_16x16x32_bf16 a[48:51], v[20:23], v[80:83], a[48:51]
    v_mfma_f32_16x16x32_bf16 a[84:87], v[20:23], v[84:87], a[84:87]
    s_waitcnt lgkmcnt(9)
    ds_read_b64_tr_b16 v[46:47], v11 offset:32512
    v_mfma_f32_16x16x32_bf16 a[16:19], v[24:27], v[76:79], a[16:19]
    ds_read_b64_tr_b16 v[16:17], v11 offset:0
    v_mfma_f32_16x16x32_bf16 a[52:55], v[24:27], v[80:83], a[52:55]
    v_mfma_f32_16x16x32_bf16 a[88:91], v[24:27], v[84:87], a[88:91]
    s_waitcnt lgkmcnt(9)
    ds_read_b64_tr_b16 v[18:19], v11 offset:4608
    v_mfma_f32_16x16x32_bf16 a[20:23], v[28:31], v[76:79], a[20:23]
    ds_read_b64_tr_b16 v[20:21], v11 offset:9216
    v_mfma_f32_16x16x32_bf16 a[56:59], v[28:31], v[80:83], a[56:59]
    v_mfma_f32_16x16x32_bf16 a[92:95], v[28:31], v[84:87], a[92:95]
    ds_read_b64_tr_b16 v[22:23], v11 offset:13824
    s_waitcnt vmcnt(9) lgkmcnt(10)
    v_mfma_f32_16x16x32_bf16 a[32:35], v[32:35], v[88:91], a[32:35]
    ds_read_b64_tr_b16 v[24:25], v11 offset:18432
    v_mfma_f32_16x16x32_bf16 a[68:71], v[32:35], v[92:95], a[68:71]
    v_mfma_f32_16x16x32_bf16 a[104:107], v[32:35], v[96:99], a[104:107]
    ds_read_b64_tr_b16 v[26:27], v11 offset:23040
    s_waitcnt vmcnt(6) lgkmcnt(10)
    v_mfma_f32_16x16x32_bf16 a[32:35], v[36:39], v[100:103], a[32:35]
    ds_read_b64_tr_b16 v[28:29], v11 offset:27648
    v_mfma_f32_16x16x32_bf16 a[68:71], v[36:39], v[104:107], a[68:71]
    v_mfma_f32_16x16x32_bf16 a[104:107], v[36:39], v[108:111], a[104:107]
    ds_read_b64_tr_b16 v[30:31], v11 offset:32256
    s_waitcnt vmcnt(3) lgkmcnt(10)
    v_mfma_f32_16x16x32_bf16 a[32:35], v[40:43], v[112:115], a[32:35]
    ds_read_b64_tr_b16 v[32:33], v11 offset:32
    v_mfma_f32_16x16x32_bf16 a[68:71], v[40:43], v[116:119], a[68:71]
    v_mfma_f32_16x16x32_bf16 a[104:107], v[40:43], v[120:123], a[104:107]
    ds_read_b64_tr_b16 v[34:35], v11 offset:4640
    s_waitcnt vmcnt(0) lgkmcnt(10)
    v_mfma_f32_16x16x32_bf16 a[32:35], v[44:47], v[124:127], a[32:35]
    ds_read_b64_tr_b16 v[36:37], v11 offset:9248
    v_mfma_f32_16x16x32_bf16 a[68:71], v[44:47], v[128:131], a[68:71]
    v_mfma_f32_16x16x32_bf16 a[104:107], v[44:47], v[132:135], a[104:107]
    s_waitcnt lgkmcnt(9)
    ds_read_b64_tr_b16 v[38:39], v11 offset:13856
    v_mfma_f32_16x16x32_bf16 a[0:3], v[16:19], v[88:91], a[0:3]
    ds_read_b64_tr_b16 v[40:41], v11 offset:18464
    v_mfma_f32_16x16x32_bf16 a[36:39], v[16:19], v[92:95], a[36:39]
    v_mfma_f32_16x16x32_bf16 a[72:75], v[16:19], v[96:99], a[72:75]
    s_waitcnt lgkmcnt(9)
    ds_read_b64_tr_b16 v[42:43], v11 offset:23072
    v_mfma_f32_16x16x32_bf16 a[0:3], v[20:23], v[100:103], a[0:3]
    ds_read_b64_tr_b16 v[44:45], v11 offset:27680
    v_accvgpr_read_b32 v48, a32
    v_mfma_f32_16x16x32_bf16 a[36:39], v[20:23], v[104:107], a[36:39]
    v_accvgpr_read_b32 v49, a33
    v_accvgpr_read_b32 v50, a34
    v_mfma_f32_16x16x32_bf16 a[72:75], v[20:23], v[108:111], a[72:75]
    s_waitcnt lgkmcnt(9)
    ds_read_b64_tr_b16 v[46:47], v11 offset:32288
    v_accvgpr_read_b32 v51, a35
    v_mfma_f32_16x16x32_bf16 a[0:3], v[24:27], v[112:115], a[0:3]
    ds_read_b64_tr_b16 v[16:17], v11 offset:64
    v_cvt_pk_bf16_f32 v56, v48, v49
    v_mfma_f32_16x16x32_bf16 a[36:39], v[24:27], v[116:119], a[36:39]
    v_cvt_pk_bf16_f32 v57, v50, v51
    v_accvgpr_read_b32 v52, a68
    v_mfma_f32_16x16x32_bf16 a[72:75], v[24:27], v[120:123], a[72:75]
    s_waitcnt lgkmcnt(9)
    ds_read_b64_tr_b16 v[18:19], v11 offset:4672
    v_accvgpr_read_b32 v53, a69
    v_mfma_f32_16x16x32_bf16 a[0:3], v[28:31], v[124:127], a[0:3]
    ds_read_b64_tr_b16 v[20:21], v11 offset:9280
    v_accvgpr_read_b32 v54, a70
    v_mfma_f32_16x16x32_bf16 a[36:39], v[28:31], v[128:131], a[36:39]
    v_accvgpr_read_b32 v55, a71
    v_cvt_pk_bf16_f32 v58, v52, v53
    v_mfma_f32_16x16x32_bf16 a[72:75], v[28:31], v[132:135], a[72:75]
    s_waitcnt lgkmcnt(9)
    ds_read_b64_tr_b16 v[22:23], v11 offset:13888
    v_cvt_pk_bf16_f32 v59, v54, v55
    v_mfma_f32_16x16x32_bf16 a[4:7], v[32:35], v[88:91], a[4:7]
    ds_read_b64_tr_b16 v[24:25], v11 offset:18496
    v_mfma_f32_16x16x32_bf16 a[40:43], v[32:35], v[92:95], a[40:43]
    buffer_store_dwordx4 v[56:59], v10, s[28:31], s39 offen offset:0 sc1
    v_accvgpr_read_b32 v48, a104
    v_mfma_f32_16x16x32_bf16 a[76:79], v[32:35], v[96:99], a[76:79]
    s_waitcnt lgkmcnt(9)
    ds_read_b64_tr_b16 v[26:27], v11 offset:23104
    v_accvgpr_read_b32 v49, a105
    v_mfma_f32_16x16x32_bf16 a[4:7], v[36:39], v[100:103], a[4:7]
    ds_read_b64_tr_b16 v[28:29], v11 offset:27712
    v_accvgpr_read_b32 v50, a106
    v_mfma_f32_16x16x32_bf16 a[40:43], v[36:39], v[104:107], a[40:43]
    v_accvgpr_read_b32 v51, a107
    v_cvt_pk_bf16_f32 v60, v48, v49
    v_mfma_f32_16x16x32_bf16 a[76:79], v[36:39], v[108:111], a[76:79]
    s_waitcnt lgkmcnt(9)
    ds_read_b64_tr_b16 v[30:31], v11 offset:32320
    v_cvt_pk_bf16_f32 v61, v50, v51
    v_mfma_f32_16x16x32_bf16 a[4:7], v[40:43], v[112:115], a[4:7]
    ds_read_b64_tr_b16 v[32:33], v11 offset:96
    v_mfma_f32_16x16x32_bf16 a[40:43], v[40:43], v[116:119], a[40:43]
    buffer_store_dwordx4 v[60:63], v10, s[28:31], s39 offen offset:1024 sc1
    v_accvgpr_read_b32 v48, a0
    v_mfma_f32_16x16x32_bf16 a[76:79], v[40:43], v[120:123], a[76:79]
    s_waitcnt lgkmcnt(9)
    ds_read_b64_tr_b16 v[34:35], v11 offset:4704
    v_accvgpr_read_b32 v49, a1
    v_mfma_f32_16x16x32_bf16 a[4:7], v[44:47], v[124:127], a[4:7]
    ds_read_b64_tr_b16 v[36:37], v11 offset:9312
    v_accvgpr_read_b32 v50, a2
    v_mfma_f32_16x16x32_bf16 a[40:43], v[44:47], v[128:131], a[40:43]
    v_accvgpr_read_b32 v51, a3
    v_cvt_pk_bf16_f32 v136, v48, v49
    v_mfma_f32_16x16x32_bf16 a[76:79], v[44:47], v[132:135], a[76:79]
    s_waitcnt lgkmcnt(9)
    ds_read_b64_tr_b16 v[38:39], v11 offset:13920
    v_cvt_pk_bf16_f32 v137, v50, v51
    v_mfma_f32_16x16x32_bf16 a[8:11], v[16:19], v[88:91], a[8:11]
    ds_read_b64_tr_b16 v[40:41], v11 offset:18528
    v_accvgpr_read_b32 v52, a36
    v_mfma_f32_16x16x32_bf16 a[44:47], v[16:19], v[92:95], a[44:47]
    v_accvgpr_read_b32 v53, a37
    v_accvgpr_read_b32 v54, a38
    v_mfma_f32_16x16x32_bf16 a[80:83], v[16:19], v[96:99], a[80:83]
    s_waitcnt lgkmcnt(9)
    ds_read_b64_tr_b16 v[42:43], v11 offset:23136
    v_accvgpr_read_b32 v55, a39
    v_mfma_f32_16x16x32_bf16 a[8:11], v[20:23], v[100:103], a[8:11]
    ds_read_b64_tr_b16 v[44:45], v11 offset:27744
    v_cvt_pk_bf16_f32 v140, v52, v53
    v_mfma_f32_16x16x32_bf16 a[44:47], v[20:23], v[104:107], a[44:47]
    v_cvt_pk_bf16_f32 v141, v54, v55
    v_accvgpr_read_b32 v48, a72
    v_mfma_f32_16x16x32_bf16 a[80:83], v[20:23], v[108:111], a[80:83]
    s_waitcnt lgkmcnt(9)
    ds_read_b64_tr_b16 v[46:47], v11 offset:32352
    v_accvgpr_read_b32 v49, a73
    v_mfma_f32_16x16x32_bf16 a[8:11], v[24:27], v[112:115], a[8:11]
    ds_read_b64_tr_b16 v[16:17], v11 offset:128
    v_accvgpr_read_b32 v50, a74
    v_mfma_f32_16x16x32_bf16 a[44:47], v[24:27], v[116:119], a[44:47]
    v_accvgpr_read_b32 v51, a75
    v_cvt_pk_bf16_f32 v144, v48, v49
    v_mfma_f32_16x16x32_bf16 a[80:83], v[24:27], v[120:123], a[80:83]
    s_waitcnt lgkmcnt(9)
    ds_read_b64_tr_b16 v[18:19], v11 offset:4736
    v_cvt_pk_bf16_f32 v145, v50, v51
    v_mfma_f32_16x16x32_bf16 a[8:11], v[28:31], v[124:127], a[8:11]
    ds_read_b64_tr_b16 v[20:21], v11 offset:9344
    v_accvgpr_read_b32 v48, a4
    v_mfma_f32_16x16x32_bf16 a[44:47], v[28:31], v[128:131], a[44:47]
    v_accvgpr_read_b32 v49, a5
    v_accvgpr_read_b32 v50, a6
    v_mfma_f32_16x16x32_bf16 a[80:83], v[28:31], v[132:135], a[80:83]
    s_waitcnt lgkmcnt(9)
    ds_read_b64_tr_b16 v[22:23], v11 offset:13952
    v_accvgpr_read_b32 v51, a7
    v_mfma_f32_16x16x32_bf16 a[12:15], v[32:35], v[88:91], a[12:15]
    ds_read_b64_tr_b16 v[24:25], v11 offset:18560
    v_cvt_pk_bf16_f32 v138, v48, v49
    v_mfma_f32_16x16x32_bf16 a[48:51], v[32:35], v[92:95], a[48:51]
    v_cvt_pk_bf16_f32 v139, v50, v51
    v_mfma_f32_16x16x32_bf16 a[84:87], v[32:35], v[96:99], a[84:87]
    s_waitcnt lgkmcnt(9)
    ds_read_b64_tr_b16 v[26:27], v11 offset:23168
    v_mfma_f32_16x16x32_bf16 a[12:15], v[36:39], v[100:103], a[12:15]
    ds_read_b64_tr_b16 v[28:29], v11 offset:27776
    v_mfma_f32_16x16x32_bf16 a[48:51], v[36:39], v[104:107], a[48:51]
    buffer_store_dwordx4 v[136:139], v10, s[28:31], s36 offen offset:0 sc1
    v_accvgpr_read_b32 v52, a40
    v_mfma_f32_16x16x32_bf16 a[84:87], v[36:39], v[108:111], a[84:87]
    s_waitcnt lgkmcnt(9)
    ds_read_b64_tr_b16 v[30:31], v11 offset:32384
    v_accvgpr_read_b32 v53, a41
    v_mfma_f32_16x16x32_bf16 a[12:15], v[40:43], v[112:115], a[12:15]
    ds_read_b64_tr_b16 v[32:33], v11 offset:160
    v_accvgpr_read_b32 v54, a42
    v_mfma_f32_16x16x32_bf16 a[48:51], v[40:43], v[116:119], a[48:51]
    v_accvgpr_read_b32 v55, a43
    v_cvt_pk_bf16_f32 v142, v52, v53
    v_mfma_f32_16x16x32_bf16 a[84:87], v[40:43], v[120:123], a[84:87]
    s_waitcnt lgkmcnt(9)
    ds_read_b64_tr_b16 v[34:35], v11 offset:4768
    v_cvt_pk_bf16_f32 v143, v54, v55
    v_mfma_f32_16x16x32_bf16 a[12:15], v[44:47], v[124:127], a[12:15]
    ds_read_b64_tr_b16 v[36:37], v11 offset:9376
    v_mfma_f32_16x16x32_bf16 a[48:51], v[44:47], v[128:131], a[48:51]
    buffer_store_dwordx4 v[140:143], v10, s[28:31], s36 offen offset:1024 sc1
    v_accvgpr_read_b32 v48, a76
    v_mfma_f32_16x16x32_bf16 a[84:87], v[44:47], v[132:135], a[84:87]
    s_waitcnt lgkmcnt(9)
    ds_read_b64_tr_b16 v[38:39], v11 offset:13984
    v_accvgpr_read_b32 v49, a77
    v_mfma_f32_16x16x32_bf16 a[16:19], v[16:19], v[88:91], a[16:19]
    ds_read_b64_tr_b16 v[40:41], v11 offset:18592
    v_accvgpr_read_b32 v50, a78
    v_mfma_f32_16x16x32_bf16 a[52:55], v[16:19], v[92:95], a[52:55]
    v_accvgpr_read_b32 v51, a79
    v_cvt_pk_bf16_f32 v146, v48, v49
    v_mfma_f32_16x16x32_bf16 a[88:91], v[16:19], v[96:99], a[88:91]
    s_waitcnt lgkmcnt(9)
    ds_read_b64_tr_b16 v[42:43], v11 offset:23200
    v_cvt_pk_bf16_f32 v147, v50, v51
    v_mfma_f32_16x16x32_bf16 a[16:19], v[20:23], v[100:103], a[16:19]
    ds_read_b64_tr_b16 v[44:45], v11 offset:27808
    v_mfma_f32_16x16x32_bf16 a[52:55], v[20:23], v[104:107], a[52:55]
    buffer_store_dwordx4 v[144:147], v10, s[28:31], s36 offen offset:2048 sc1
    v_accvgpr_read_b32 v48, a8
    v_mfma_f32_16x16x32_bf16 a[88:91], v[20:23], v[108:111], a[88:91]
    s_waitcnt lgkmcnt(9)
    ds_read_b64_tr_b16 v[46:47], v11 offset:32416
    v_accvgpr_read_b32 v49, a9
    v_mfma_f32_16x16x32_bf16 a[16:19], v[24:27], v[112:115], a[16:19]
    ds_read_b64_tr_b16 v[16:17], v7 offset:192
    v_accvgpr_read_b32 v50, a10
    v_mfma_f32_16x16x32_bf16 a[52:55], v[24:27], v[116:119], a[52:55]
    v_accvgpr_read_b32 v51, a11
    v_cvt_pk_bf16_f32 v148, v48, v49
    v_mfma_f32_16x16x32_bf16 a[88:91], v[24:27], v[120:123], a[88:91]
    s_waitcnt lgkmcnt(9)
    ds_read_b64_tr_b16 v[18:19], v7 offset:4800
    v_cvt_pk_bf16_f32 v149, v50, v51
    v_mfma_f32_16x16x32_bf16 a[16:19], v[28:31], v[124:127], a[16:19]
    ds_read_b64_tr_b16 v[20:21], v7 offset:224
    v_accvgpr_read_b32 v52, a44
    v_mfma_f32_16x16x32_bf16 a[52:55], v[28:31], v[128:131], a[52:55]
    v_accvgpr_read_b32 v53, a45
    v_accvgpr_read_b32 v54, a46
    v_mfma_f32_16x16x32_bf16 a[88:91], v[28:31], v[132:135], a[88:91]
    s_waitcnt lgkmcnt(9)
    ds_read_b64_tr_b16 v[22:23], v7 offset:4832
    v_accvgpr_read_b32 v55, a47
    v_mfma_f32_16x16x32_bf16 a[20:23], v[32:35], v[88:91], a[20:23]
    ds_read_b64_tr_b16 v[24:25], v7 offset:9408
    v_cvt_pk_bf16_f32 v152, v52, v53
    v_mfma_f32_16x16x32_bf16 a[56:59], v[32:35], v[92:95], a[56:59]
    v_cvt_pk_bf16_f32 v153, v54, v55
    v_accvgpr_read_b32 v48, a80
    v_mfma_f32_16x16x32_bf16 a[92:95], v[32:35], v[96:99], a[92:95]
    s_waitcnt lgkmcnt(9)
    ds_read_b64_tr_b16 v[26:27], v7 offset:14016
    v_accvgpr_read_b32 v49, a81
    v_mfma_f32_16x16x32_bf16 a[20:23], v[36:39], v[100:103], a[20:23]
    ds_read_b64_tr_b16 v[28:29], v7 offset:9440
    v_accvgpr_read_b32 v50, a82
    v_mfma_f32_16x16x32_bf16 a[56:59], v[36:39], v[104:107], a[56:59]
    v_accvgpr_read_b32 v51, a83
    v_cvt_pk_bf16_f32 v156, v48, v49
    v_mfma_f32_16x16x32_bf16 a[92:95], v[36:39], v[108:111], a[92:95]
    s_waitcnt lgkmcnt(9)
    ds_read_b64_tr_b16 v[30:31], v7 offset:14048
    v_cvt_pk_bf16_f32 v157, v50, v51
    v_mfma_f32_16x16x32_bf16 a[20:23], v[40:43], v[112:115], a[20:23]
    ds_read_b64_tr_b16 v[32:33], v7 offset:18624
    v_accvgpr_read_b32 v48, a12
    v_mfma_f32_16x16x32_bf16 a[56:59], v[40:43], v[116:119], a[56:59]
    v_accvgpr_read_b32 v49, a13
    v_accvgpr_read_b32 v50, a14
    v_mfma_f32_16x16x32_bf16 a[92:95], v[40:43], v[120:123], a[92:95]
    s_waitcnt lgkmcnt(9)
    ds_read_b64_tr_b16 v[34:35], v7 offset:23232
    v_accvgpr_read_b32 v51, a15
    v_mfma_f32_16x16x32_bf16 a[20:23], v[44:47], v[124:127], a[20:23]
    ds_read_b64_tr_b16 v[36:37], v7 offset:18656
    v_cvt_pk_bf16_f32 v150, v48, v49
    v_mfma_f32_16x16x32_bf16 a[56:59], v[44:47], v[128:131], a[56:59]
    v_cvt_pk_bf16_f32 v151, v50, v51
    v_mfma_f32_16x16x32_bf16 a[92:95], v[44:47], v[132:135], a[92:95]
    s_waitcnt lgkmcnt(9)
    ds_read_b64_tr_b16 v[38:39], v7 offset:23264
    v_mfma_f32_16x16x32_bf16 a[24:27], v[16:19], a[204:207], a[24:27]
    ds_read_b64_tr_b16 v[40:41], v7 offset:27840
    v_mfma_f32_16x16x32_bf16 a[60:63], v[16:19], a[208:211], a[60:63]
    buffer_store_dwordx4 v[148:151], v10, s[28:31], s37 offen offset:0 sc1
    v_accvgpr_read_b32 v52, a48
    v_mfma_f32_16x16x32_bf16 a[96:99], v[16:19], a[212:215], a[96:99]
    s_waitcnt lgkmcnt(9)
    ds_read_b64_tr_b16 v[42:43], v7 offset:32448
    v_accvgpr_read_b32 v53, a49
    v_mfma_f32_16x16x32_bf16 a[28:31], v[20:23], a[204:207], a[28:31]
    ds_read_b64_tr_b16 v[44:45], v7 offset:27872
    v_accvgpr_read_b32 v54, a50
    v_mfma_f32_16x16x32_bf16 a[64:67], v[20:23], a[208:211], a[64:67]
    v_accvgpr_read_b32 v55, a51
    v_cvt_pk_bf16_f32 v154, v52, v53
    v_mfma_f32_16x16x32_bf16 a[100:103], v[20:23], a[212:215], a[100:103]
    s_waitcnt lgkmcnt(9)
    ds_read_b64_tr_b16 v[46:47], v7 offset:32480
    v_cvt_pk_bf16_f32 v155, v54, v55
    v_mfma_f32_16x16x32_bf16 a[24:27], v[24:27], a[216:219], a[24:27]
    ds_read_b64_tr_b16 v[16:17], v8 offset:192
    v_mfma_f32_16x16x32_bf16 a[60:63], v[24:27], a[220:223], a[60:63]
    buffer_store_dwordx4 v[152:155], v10, s[28:31], s37 offen offset:1024 sc1
    v_accvgpr_read_b32 v48, a84
    v_mfma_f32_16x16x32_bf16 a[96:99], v[24:27], a[224:227], a[96:99]
    s_waitcnt lgkmcnt(9)
    ds_read_b64_tr_b16 v[18:19], v8 offset:4800
    v_accvgpr_read_b32 v49, a85
    v_mfma_f32_16x16x32_bf16 a[28:31], v[28:31], a[216:219], a[28:31]
    ds_read_b64_tr_b16 v[20:21], v8 offset:224
    v_accvgpr_read_b32 v50, a86
    v_mfma_f32_16x16x32_bf16 a[64:67], v[28:31], a[220:223], a[64:67]
    v_accvgpr_read_b32 v51, a87
    v_cvt_pk_bf16_f32 v158, v48, v49
    v_mfma_f32_16x16x32_bf16 a[100:103], v[28:31], a[224:227], a[100:103]
    s_waitcnt lgkmcnt(9)
    ds_read_b64_tr_b16 v[22:23], v8 offset:4832
    v_cvt_pk_bf16_f32 v159, v50, v51
    v_mfma_f32_16x16x32_bf16 a[24:27], v[32:35], a[228:231], a[24:27]
    ds_read_b64_tr_b16 v[24:25], v8 offset:9408
    v_mfma_f32_16x16x32_bf16 a[60:63], v[32:35], a[232:235], a[60:63]
    buffer_store_dwordx4 v[156:159], v10, s[28:31], s37 offen offset:2048 sc1
    v_accvgpr_read_b32 v48, a16
    v_mfma_f32_16x16x32_bf16 a[96:99], v[32:35], a[236:239], a[96:99]
    s_waitcnt lgkmcnt(9)
    ds_read_b64_tr_b16 v[26:27], v8 offset:14016
    v_accvgpr_read_b32 v49, a17
    v_mfma_f32_16x16x32_bf16 a[28:31], v[36:39], a[228:231], a[28:31]
    ds_read_b64_tr_b16 v[28:29], v8 offset:9440
    v_accvgpr_read_b32 v50, a18
    v_mfma_f32_16x16x32_bf16 a[64:67], v[36:39], a[232:235], a[64:67]
    v_accvgpr_read_b32 v51, a19
    v_cvt_pk_bf16_f32 v136, v48, v49
    v_mfma_f32_16x16x32_bf16 a[100:103], v[36:39], a[236:239], a[100:103]
    s_waitcnt lgkmcnt(9)
    ds_read_b64_tr_b16 v[30:31], v8 offset:14048
    v_cvt_pk_bf16_f32 v137, v50, v51
    v_mfma_f32_16x16x32_bf16 a[24:27], v[40:43], a[240:243], a[24:27]
    ds_read_b64_tr_b16 v[32:33], v8 offset:18624
    v_accvgpr_read_b32 v52, a52
    v_mfma_f32_16x16x32_bf16 a[60:63], v[40:43], a[244:247], a[60:63]
    v_accvgpr_read_b32 v53, a53
    v_accvgpr_read_b32 v54, a54
    v_mfma_f32_16x16x32_bf16 a[96:99], v[40:43], a[248:251], a[96:99]
    s_waitcnt lgkmcnt(9)
    ds_read_b64_tr_b16 v[34:35], v8 offset:23232
    v_accvgpr_read_b32 v55, a55
    v_mfma_f32_16x16x32_bf16 a[28:31], v[44:47], a[240:243], a[28:31]
    ds_read_b64_tr_b16 v[36:37], v8 offset:18656
    v_cvt_pk_bf16_f32 v140, v52, v53
    v_mfma_f32_16x16x32_bf16 a[64:67], v[44:47], a[244:247], a[64:67]
    v_cvt_pk_bf16_f32 v141, v54, v55
    v_accvgpr_read_b32 v48, a88
    v_mfma_f32_16x16x32_bf16 a[100:103], v[44:47], a[248:251], a[100:103]
    s_waitcnt lgkmcnt(9)
    ds_read_b64_tr_b16 v[38:39], v8 offset:23264
    v_accvgpr_read_b32 v49, a89
    v_mfma_f32_16x16x32_bf16 a[24:27], v[16:19], v[160:163], a[24:27]
    ds_read_b64_tr_b16 v[40:41], v8 offset:27840
    v_accvgpr_read_b32 v50, a90
    v_mfma_f32_16x16x32_bf16 a[60:63], v[16:19], v[164:167], a[60:63]
    v_accvgpr_read_b32 v51, a91
    v_cvt_pk_bf16_f32 v144, v48, v49
    v_mfma_f32_16x16x32_bf16 a[96:99], v[16:19], v[168:171], a[96:99]
    s_waitcnt lgkmcnt(9)
    ds_read_b64_tr_b16 v[42:43], v8 offset:32448
    v_cvt_pk_bf16_f32 v145, v50, v51
    v_mfma_f32_16x16x32_bf16 a[28:31], v[20:23], v[160:163], a[28:31]
    ds_read_b64_tr_b16 v[44:45], v8 offset:27872
    v_accvgpr_read_b32 v48, a20
    v_mfma_f32_16x16x32_bf16 a[64:67], v[20:23], v[164:167], a[64:67]
    v_accvgpr_read_b32 v49, a21
    v_accvgpr_read_b32 v50, a22
    v_mfma_f32_16x16x32_bf16 a[100:103], v[20:23], v[168:171], a[100:103]
    s_waitcnt lgkmcnt(9)
    ds_read_b64_tr_b16 v[46:47], v8 offset:32480
    v_accvgpr_read_b32 v51, a23
    v_mfma_f32_16x16x32_bf16 a[24:27], v[24:27], v[172:175], a[24:27]
    ds_read_b64_tr_b16 v[16:17], v9 offset:192
    v_cvt_pk_bf16_f32 v138, v48, v49
    v_mfma_f32_16x16x32_bf16 a[60:63], v[24:27], v[176:179], a[60:63]
    v_cvt_pk_bf16_f32 v139, v50, v51
    v_mfma_f32_16x16x32_bf16 a[96:99], v[24:27], v[180:183], a[96:99]
    s_waitcnt lgkmcnt(9)
    ds_read_b64_tr_b16 v[18:19], v9 offset:4800
    v_mfma_f32_16x16x32_bf16 a[28:31], v[28:31], v[172:175], a[28:31]
    ds_read_b64_tr_b16 v[20:21], v9 offset:224
    v_mfma_f32_16x16x32_bf16 a[64:67], v[28:31], v[176:179], a[64:67]
    buffer_store_dwordx4 v[136:139], v10, s[28:31], s38 offen offset:0 sc1
    v_accvgpr_read_b32 v52, a56
    v_mfma_f32_16x16x32_bf16 a[100:103], v[28:31], v[180:183], a[100:103]
    s_waitcnt lgkmcnt(9)
    ds_read_b64_tr_b16 v[22:23], v9 offset:4832
    v_accvgpr_read_b32 v53, a57
    v_mfma_f32_16x16x32_bf16 a[24:27], v[32:35], v[184:187], a[24:27]
    ds_read_b64_tr_b16 v[24:25], v9 offset:9408
    v_accvgpr_read_b32 v54, a58
    v_mfma_f32_16x16x32_bf16 a[60:63], v[32:35], v[188:191], a[60:63]
    v_accvgpr_read_b32 v55, a59
    v_cvt_pk_bf16_f32 v142, v52, v53
    v_mfma_f32_16x16x32_bf16 a[96:99], v[32:35], v[192:195], a[96:99]
    s_waitcnt lgkmcnt(9)
    ds_read_b64_tr_b16 v[26:27], v9 offset:14016
    v_cvt_pk_bf16_f32 v143, v54, v55
    v_mfma_f32_16x16x32_bf16 a[28:31], v[36:39], v[184:187], a[28:31]
    ds_read_b64_tr_b16 v[28:29], v9 offset:9440
    v_mfma_f32_16x16x32_bf16 a[64:67], v[36:39], v[188:191], a[64:67]
    buffer_store_dwordx4 v[140:143], v10, s[28:31], s38 offen offset:1024 sc1
    v_accvgpr_read_b32 v48, a92
    v_mfma_f32_16x16x32_bf16 a[100:103], v[36:39], v[192:195], a[100:103]
    s_waitcnt lgkmcnt(9)
    ds_read_b64_tr_b16 v[30:31], v9 offset:14048
    v_accvgpr_read_b32 v49, a93
    v_mfma_f32_16x16x32_bf16 a[24:27], v[40:43], v[196:199], a[24:27]
    ds_read_b64_tr_b16 v[32:33], v9 offset:18624
    v_accvgpr_read_b32 v50, a94
    v_mfma_f32_16x16x32_bf16 a[60:63], v[40:43], v[200:203], a[60:63]
    v_accvgpr_read_b32 v51, a95
    v_cvt_pk_bf16_f32 v146, v48, v49
    v_mfma_f32_16x16x32_bf16 a[96:99], v[40:43], v[204:207], a[96:99]
    s_waitcnt lgkmcnt(9)
    ds_read_b64_tr_b16 v[34:35], v9 offset:23232
    v_cvt_pk_bf16_f32 v147, v50, v51
    v_mfma_f32_16x16x32_bf16 a[28:31], v[44:47], v[196:199], a[28:31]
    ds_read_b64_tr_b16 v[36:37], v9 offset:18656
    v_mfma_f32_16x16x32_bf16 a[64:67], v[44:47], v[200:203], a[64:67]
    buffer_store_dwordx4 v[144:147], v10, s[28:31], s38 offen offset:2048 sc1
    v_mfma_f32_16x16x32_bf16 a[100:103], v[44:47], v[204:207], a[100:103]
    s_waitcnt lgkmcnt(9)
    ds_read_b64_tr_b16 v[38:39], v9 offset:23264
    v_mfma_f32_16x16x32_bf16 a[24:27], v[16:19], v[208:211], a[24:27]
    ds_read_b64_tr_b16 v[40:41], v9 offset:27840
    v_mfma_f32_16x16x32_bf16 a[60:63], v[16:19], v[212:215], a[60:63]
    v_mfma_f32_16x16x32_bf16 a[96:99], v[16:19], v[216:219], a[96:99]
    s_waitcnt lgkmcnt(9)
    ds_read_b64_tr_b16 v[42:43], v9 offset:32448
    v_mfma_f32_16x16x32_bf16 a[28:31], v[20:23], v[208:211], a[28:31]
    ds_read_b64_tr_b16 v[44:45], v9 offset:27872
    v_mfma_f32_16x16x32_bf16 a[64:67], v[20:23], v[212:215], a[64:67]
    v_mfma_f32_16x16x32_bf16 a[100:103], v[20:23], v[216:219], a[100:103]
    s_waitcnt lgkmcnt(9)
    ds_read_b64_tr_b16 v[46:47], v9 offset:32480
    v_mfma_f32_16x16x32_bf16 a[24:27], v[24:27], v[220:223], a[24:27]
    ds_read_b64_tr_b16 v[16:17], v11 offset:192
    v_mfma_f32_16x16x32_bf16 a[60:63], v[24:27], v[224:227], a[60:63]
    v_mfma_f32_16x16x32_bf16 a[96:99], v[24:27], v[228:231], a[96:99]
    s_waitcnt lgkmcnt(9)
    ds_read_b64_tr_b16 v[18:19], v11 offset:4800
    v_mfma_f32_16x16x32_bf16 a[28:31], v[28:31], v[220:223], a[28:31]
    ds_read_b64_tr_b16 v[20:21], v11 offset:224
    v_mfma_f32_16x16x32_bf16 a[64:67], v[28:31], v[224:227], a[64:67]
    v_mfma_f32_16x16x32_bf16 a[100:103], v[28:31], v[228:231], a[100:103]
    s_waitcnt lgkmcnt(9)
    ds_read_b64_tr_b16 v[22:23], v11 offset:4832
    v_mfma_f32_16x16x32_bf16 a[24:27], v[32:35], v[64:67], a[24:27]
    ds_read_b64_tr_b16 v[24:25], v11 offset:9408
    v_mfma_f32_16x16x32_bf16 a[60:63], v[32:35], v[68:71], a[60:63]
    v_mfma_f32_16x16x32_bf16 a[96:99], v[32:35], v[72:75], a[96:99]
    s_waitcnt lgkmcnt(9)
    ds_read_b64_tr_b16 v[26:27], v11 offset:14016
    v_mfma_f32_16x16x32_bf16 a[28:31], v[36:39], v[64:67], a[28:31]
    ds_read_b64_tr_b16 v[28:29], v11 offset:9440
    v_mfma_f32_16x16x32_bf16 a[64:67], v[36:39], v[68:71], a[64:67]
    v_mfma_f32_16x16x32_bf16 a[100:103], v[36:39], v[72:75], a[100:103]
    s_waitcnt lgkmcnt(9)
    ds_read_b64_tr_b16 v[30:31], v11 offset:14048
    v_mfma_f32_16x16x32_bf16 a[24:27], v[40:43], v[76:79], a[24:27]
    ds_read_b64_tr_b16 v[32:33], v11 offset:18624
    v_mfma_f32_16x16x32_bf16 a[60:63], v[40:43], v[80:83], a[60:63]
    v_mfma_f32_16x16x32_bf16 a[96:99], v[40:43], v[84:87], a[96:99]
    s_waitcnt lgkmcnt(9)
    ds_read_b64_tr_b16 v[34:35], v11 offset:23232
    v_mfma_f32_16x16x32_bf16 a[28:31], v[44:47], v[76:79], a[28:31]
    ds_read_b64_tr_b16 v[36:37], v11 offset:18656
    v_mfma_f32_16x16x32_bf16 a[64:67], v[44:47], v[80:83], a[64:67]
    v_mfma_f32_16x16x32_bf16 a[100:103], v[44:47], v[84:87], a[100:103]
    s_waitcnt lgkmcnt(9)
    ds_read_b64_tr_b16 v[38:39], v11 offset:23264
    s_waitcnt vmcnt(0)
    s_barrier
    s_cmp_eq_u32 s52, 0
    s_cbranch_scc1 L_flag2
L_flag2_back:
    v_mfma_f32_16x16x32_bf16 a[24:27], v[16:19], v[88:91], a[24:27]
    ds_read_b64_tr_b16 v[40:41], v11 offset:27840
    v_mfma_f32_16x16x32_bf16 a[60:63], v[16:19], v[92:95], a[60:63]
    v_mfma_f32_16x16x32_bf16 a[96:99], v[16:19], v[96:99], a[96:99]
    s_waitcnt lgkmcnt(9)
    ds_read_b64_tr_b16 v[42:43], v11 offset:32448
    v_mfma_f32_16x16x32_bf16 a[28:31], v[20:23], v[88:91], a[28:31]
    ds_read_b64_tr_b16 v[44:45], v11 offset:27872
    v_mfma_f32_16x16x32_bf16 a[64:67], v[20:23], v[92:95], a[64:67]
    v_mfma_f32_16x16x32_bf16 a[100:103], v[20:23], v[96:99], a[100:103]
    s_waitcnt lgkmcnt(9)
    ds_read_b64_tr_b16 v[46:47], v11 offset:32480
    s_branch L_spin2
L_spin2_back:
    v_mfma_f32_16x16x32_bf16 a[24:27], v[24:27], v[100:103], a[24:27]
    s_add_u32 s36, s40, 0
    v_mfma_f32_16x16x32_bf16 a[60:63], v[24:27], v[104:107], a[60:63]
    buffer_load_dwordx4 v[136:139], v10, s[28:31], s36 offen offset:0 sc1
    v_mfma_f32_16x16x32_bf16 a[96:99], v[24:27], v[108:111], a[96:99]
    s_waitcnt  lgkmcnt(8)
    v_mfma_f32_16x16x32_bf16 a[28:31], v[28:31], v[100:103], a[28:31]
    s_add_u32 s37, s40, 12288
    v_mfma_f32_16x16x32_bf16 a[64:67], v[28:31], v[104:107], a[64:67]
    buffer_load_dwordx4 v[140:143], v10, s[28:31], s37 offen offset:0 sc1
    v_mfma_f32_16x16x32_bf16 a[100:103], v[28:31], v[108:111], a[100:103]
    s_waitcnt  lgkmcnt(6)
    v_mfma_f32_16x16x32_bf16 a[24:27], v[32:35], v[112:115], a[24:27]
    s_add_u32 s38, s40, 24576
    v_mfma_f32_16x16x32_bf16 a[60:63], v[32:35], v[116:119], a[60:63]
    buffer_load_dwordx4 v[144:147], v10, s[28:31], s38 offen offset:0 sc1
    v_mfma_f32_16x16x32_bf16 a[96:99], v[32:35], v[120:123], a[96:99]
    s_waitcnt  lgkmcnt(4)
    v_mfma_f32_16x16x32_bf16 a[28:31], v[36:39], v[112:115], a[28:31]
    v_mfma_f32_16x16x32_bf16 a[64:67], v[36:39], v[116:119], a[64:67]
    buffer_load_dwordx4 v[148:151], v10, s[28:31], s36 offen offset:1024 sc1
    v_mfma_f32_16x16x32_bf16 a[100:103], v[36:39], v[120:123], a[100:103]
    s_waitcnt  lgkmcnt(2)
    v_mfma_f32_16x16x32_bf16 a[24:27], v[40:43], v[124:127], a[24:27]
    v_mfma_f32_16x16x32_bf16 a[60:63], v[40:43], v[128:131], a[60:63]
    buffer_load_dwordx4 v[152:155], v10, s[28:31], s37 offen offset:1024 sc1
    v_mfma_f32_16x16x32_bf16 a[96:99], v[40:43], v[132:135], a[96:99]
    s_waitcnt  lgkmcnt(0)
    v_mfma_f32_16x16x32_bf16 a[28:31], v[44:47], v[124:127], a[28:31]
    v_mfma_f32_16x16x32_bf16 a[64:67], v[44:47], v[128:131], a[64:67]
    buffer_load_dwordx4 v[156:159], v10, s[28:31], s38 offen offset:1024 sc1
    v_mfma_f32_16x16x32_bf16 a[100:103], v[44:47], v[132:135], a[100:103]
    buffer_load_dwordx4 v[160:163], v10, s[28:31], s36 offen offset:2048 sc1
    buffer_load_dwordx4 v[164:167], v10, s[28:31], s37 offen offset:2048 sc1
    buffer_load_dwordx4 v[168:171], v10, s[28:31], s38 offen offset:2048 sc1
    s_cmp_lg_u32 s52, s20
    s_cbranch_scc1 L_no8
    s_add_u32 s55, s41, 0
    buffer_load_dwordx4 v[172:175], v10, s[28:31], s55 offen offset:0 sc1
    s_add_u32 s55, s41, 2048
    buffer_load_dwordx4 v[176:179], v10, s[28:31], s55 offen offset:0 sc1
    s_add_u32 s55, s41, 4096
    buffer_load_dwordx4 v[180:183], v10, s[28:31], s55 offen offset:0 sc1
    s_add_u32 s55, s41, 0
    buffer_load_dwordx4 v[184:187], v10, s[28:31], s55 offen offset:1024 sc1
    s_add_u32 s55, s41, 2048
    buffer_load_dwordx4 v[188:191], v10, s[28:31], s55 offen offset:1024 sc1
    s_add_u32 s55, s41, 4096
    buffer_load_dwordx4 v[192:195], v10, s[28:31], s55 offen offset:1024 sc1
L_no8:
    s_nop 3
    s_mov_b32 s82, 0xffff0000
    v_accvgpr_read_b32 v16, a24
    v_accvgpr_read_b32 v17, a25
    v_accvgpr_read_b32 v18, a26
    v_accvgpr_read_b32 v19, a27
    v_accvgpr_read_b32 v20, a28
    v_accvgpr_read_b32 v21, a29
    v_accvgpr_read_b32 v22, a30
    v_accvgpr_read_b32 v23, a31
    v_accvgpr_read_b32 v24, a60
    v_accvgpr_read_b32 v25, a61
    v_accvgpr_read_b32 v26, a62
    v_accvgpr_read_b32 v27, a63
    v_accvgpr_read_b32 v28, a64
    v_accvgpr_read_b32 v29, a65
    v_accvgpr_read_b32 v30, a66
    v_accvgpr_read_b32 v31, a67
    v_accvgpr_read_b32 v32, a96
    v_accvgpr_read_b32 v33, a97
    v_accvgpr_read_b32 v34, a98
    v_accvgpr_read_b32 v35, a99
    v_accvgpr_read_b32 v36, a100
    v_accvgpr_read_b32 v37, a101
    v_accvgpr_read_b32 v38, a102
    v_accvgpr_read_b32 v39, a103
    v_accvgpr_read_b32 v40, a32
    v_accvgpr_read_b32 v41, a33
    v_accvgpr_read_b32 v42, a34
    v_accvgpr_read_b32 v43, a35
    v_accvgpr_read_b32 v44, a68
    v_accvgpr_read_b32 v45, a69
    v_accvgpr_read_b32 v46, a70
    v_accvgpr_read_b32 v47, a71
    v_accvgpr_read_b32 v48, a104
    v_accvgpr_read_b32 v49, a105
    v_accvgpr_read_b32 v50, a106
    v_accvgpr_read_b32 v51, a107
    s_waitcnt vmcnt(6)
    v_lshlrev_b32 v56, 16, v136
    v_and_b32 v57, s82, v136
    v_lshlrev_b32 v58, 16, v137
    v_and_b32 v59, s82, v137
    v_lshlrev_b32 v60, 16, v138
    v_and_b32 v61, s82, v138
    v_lshlrev_b32 v62, 16, v139
    v_and_b32 v63, s82, v139
    v_pk_add_f32 v[16:17], v[16:17], v[56:57]
    v_pk_add_f32 v[18:19], v[18:19], v[58:59]
    v_pk_add_f32 v[20:21], v[20:21], v[60:61]
    v_pk_add_f32 v[22:23], v[22:23], v[62:63]
    v_lshlrev_b32 v56, 16, v140
    v_and_b32 v57, s82, v140
    v_lshlrev_b32 v58, 16, v141
    v_and_b32 v59, s82, v141
    v_lshlrev_b32 v60, 16, v142
    v_and_b32 v61, s82, v142
    v_lshlrev_b32 v62, 16, v143
    v_and_b32 v63, s82, v143
    v_pk_add_f32 v[16:17], v[16:17], v[56:57]
    v_pk_add_f32 v[18:19], v[18:19], v[58:59]
    v_pk_add_f32 v[20:21], v[20:21], v[60:61]
    v_pk_add_f32 v[22:23], v[22:23], v[62:63]
    v_lshlrev_b32 v56, 16, v144
    v_and_b32 v57, s82, v144
    v_lshlrev_b32 v58, 16, v145
    v_and_b32 v59, s82, v145
    v_lshlrev_b32 v60, 16, v146
    v_and_b32 v61, s82, v146
    v_lshlrev_b32 v62, 16, v147
    v_and_b32 v63, s82, v147
    v_pk_add_f32 v[16:17], v[16:17], v[56:57]
    v_pk_add_f32 v[18:19], v[18:19], v[58:59]
    v_pk_add_f32 v[20:21], v[20:21], v[60:61]
    v_pk_add_f32 v[22:23], v[22:23], v[62:63]
    v_cvt_pk_bf16_f32 v16, v16, v17
    v_cvt_pk_bf16_f32 v17, v18, v19
    v_cvt_pk_bf16_f32 v18, v20, v21
    v_cvt_pk_bf16_f32 v19, v22, v23
    s_add_u32 s55, s42, 0
    buffer_store_dwordx2 v[16:17], v3, s[32:35], s55 offen
    buffer_store_dwordx2 v[18:19], v3, s[32:35], s55 offen offset:32
    s_waitcnt vmcnt(5)
    v_lshlrev_b32 v56, 16, v148
    v_and_b32 v57, s82, v148
    v_lshlrev_b32 v58, 16, v149
    v_and_b32 v59, s82, v149
    v_lshlrev_b32 v60, 16, v150
    v_and_b32 v61, s82, v150
    v_lshlrev_b32 v62, 16, v151
    v_and_b32 v63, s82, v151
    v_pk_add_f32 v[24:25], v[24:25], v[56:57]
    v_pk_add_f32 v[26:27], v[26:27], v[58:59]
    v_pk_add_f32 v[28:29], v[28:29], v[60:61]
    v_pk_add_f32 v[30:31], v[30:31], v[62:63]
    v_lshlrev_b32 v56, 16, v152
    v_and_b32 v57, s82, v152
    v_lshlrev_b32 v58, 16, v153
    v_and_b32 v59, s82, v153
    v_lshlrev_b32 v60, 16, v154
    v_and_b32 v61, s82, v154
    v_lshlrev_b32 v62, 16, v155
    v_and_b32 v63, s82, v155
    v_pk_add_f32 v[24:25], v[24:25], v[56:57]
    v_pk_add_f32 v[26:27], v[26:27], v[58:59]
    v_pk_add_f32 v[28:29], v[28:29], v[60:61]
    v_pk_add_f32 v[30:31], v[30:31], v[62:63]
    v_lshlrev_b32 v56, 16, v156
    v_and_b32 v57, s82, v156
    v_lshlrev_b32 v58, 16, v157
    v_and_b32 v59, s82, v157
    v_lshlrev_b32 v60, 16, v158
    v_and_b32 v61, s82, v158
    v_lshlrev_b32 v62, 16, v159
    v_and_b32 v63, s82, v159
    v_pk_add_f32 v[24:25], v[24:25], v[56:57]
    v_pk_add_f32 v[26:27], v[26:27], v[58:59]
    v_pk_add_f32 v[28:29], v[28:29], v[60:61]
    v_pk_add_f32 v[30:31], v[30:31], v[62:63]
    v_cvt_pk_bf16_f32 v24, v24, v25
    v_cvt_pk_bf16_f32 v25, v26, v27
    v_cvt_pk_bf16_f32 v26, v28, v29
    v_cvt_pk_bf16_f32 v27, v30, v31
    s_add_u32 s55, s42, 18432
    buffer_store_dwordx2 v[24:25], v3, s[32:35], s55 offen
    buffer_store_dwordx2 v[26:27], v3, s[32:35], s55 offen offset:32
    s_waitcnt vmcnt(4)
    v_lshlrev_b32 v56, 16, v160
    v_and_b32 v57, s82, v160
    v_lshlrev_b32 v58, 16, v161
    v_and_b32 v59, s82, v161
    v_lshlrev_b32 v60, 16, v162
    v_and_b32 v61, s82, v162
    v_lshlrev_b32 v62, 16, v163
    v_and_b32 v63, s82, v163
    v_pk_add_f32 v[32:33], v[32:33], v[56:57]
    v_pk_add_f32 v[34:35], v[34:35], v[58:59]
    v_pk_add_f32 v[36:37], v[36:37], v[60:61]
    v_pk_add_f32 v[38:39], v[38:39], v[62:63]
    v_lshlrev_b32 v56, 16, v164
    v_and_b32 v57, s82, v164
    v_lshlrev_b32 v58, 16, v165
    v_and_b32 v59, s82, v165
    v_lshlrev_b32 v60, 16, v166
    v_and_b32 v61, s82, v166
    v_lshlrev_b32 v62, 16, v167
    v_and_b32 v63, s82, v167
    v_pk_add_f32 v[32:33], v[32:33], v[56:57]
    v_pk_add_f32 v[34:35], v[34:35], v[58:59]
    v_pk_add_f32 v[36:37], v[36:37], v[60:61]
    v_pk_add_f32 v[38:39], v[38:39], v[62:63]
    v_lshlrev_b32 v56, 16, v168
    v_and_b32 v57, s82, v168
    v_lshlrev_b32 v58, 16, v169
    v_and_b32 v59, s82, v169
    v_lshlrev_b32 v60, 16, v170
    v_and_b32 v61, s82, v170
    v_lshlrev_b32 v62, 16, v171
    v_and_b32 v63, s82, v171
    v_pk_add_f32 v[32:33], v[32:33], v[56:57]
    v_pk_add_f32 v[34:35], v[34:35], v[58:59]
    v_pk_add_f32 v[36:37], v[36:37], v[60:61]
    v_pk_add_f32 v[38:39], v[38:39], v[62:63]
    v_cvt_pk_bf16_f32 v32, v32, v33
    v_cvt_pk_bf16_f32 v33, v34, v35
    v_cvt_pk_bf16_f32 v34, v36, v37
    v_cvt_pk_bf16_f32 v35, v38, v39
    s_add_u32 s55, s42, 36864
    buffer_store_dwordx2 v[32:33], v3, s[32:35], s55 offen
    buffer_store_dwordx2 v[34:35], v3, s[32:35], s55 offen offset:32
    s_cmp_lg_u32 s52, s20
    s_cbranch_scc1 L_fin
    s_waitcnt vmcnt(9)
    v_lshlrev_b32 v56, 16, v172
    v_and_b32 v57, s82, v172
    v_lshlrev_b32 v58, 16, v173
    v_and_b32 v59, s82, v173
    v_lshlrev_b32 v60, 16, v174
    v_and_b32 v61, s82, v174
    v_lshlrev_b32 v62, 16, v175
    v_and_b32 v63, s82, v175
    v_pk_add_f32 v[40:41], v[40:41], v[56:57]
    v_pk_add_f32 v[42:43], v[42:43], v[58:59]
    v_pk_add_f32 v[44:45], v[44:45], v[60:61]
    v_pk_add_f32 v[46:47], v[46:47], v[62:63]
    v_lshlrev_b32 v56, 16, v176
    v_and_b32 v57, s82, v176
    v_lshlrev_b32 v58, 16, v177
    v_and_b32 v59, s82, v177
    v_lshlrev_b32 v60, 16, v178
    v_and_b32 v61, s82, v178
    v_lshlrev_b32 v62, 16, v179
    v_and_b32 v63, s82, v179
    v_pk_add_f32 v[40:41], v[40:41], v[56:57]
    v_pk_add_f32 v[42:43], v[42:43], v[58:59]
    v_pk_add_f32 v[44:45], v[44:45], v[60:61]
    v_pk_add_f32 v[46:47], v[46:47], v[62:63]
    v_lshlrev_b32 v56, 16, v180
    v_and_b32 v57, s82, v180
    v_lshlrev_b32 v58, 16, v181
    v_and_b32 v59, s82, v181
    v_lshlrev_b32 v60, 16, v182
    v_and_b32 v61, s82, v182
    v_lshlrev_b32 v62, 16, v183
    v_and_b32 v63, s82, v183
    v_pk_add_f32 v[40:41], v[40:41], v[56:57]
    v_pk_add_f32 v[42:43], v[42:43], v[58:59]
    v_pk_add_f32 v[44:45], v[44:45], v[60:61]
    v_pk_add_f32 v[46:47], v[46:47], v[62:63]
    v_cvt_pk_bf16_f32 v40, v40, v41
    v_cvt_pk_bf16_f32 v41, v42, v43
    v_cvt_pk_bf16_f32 v42, v44, v45
    v_cvt_pk_bf16_f32 v43, v46, v47
    s_add_u32 s55, s43, 0
    buffer_store_dwordx2 v[40:41], v3, s[32:35], s55 offen
    s_add_u32 s55, s43, 18432
    buffer_store_dwordx2 v[42:43], v3, s[32:35], s55 offen
    s_waitcnt vmcnt(8)
    v_lshlrev_b32 v56, 16, v184
    v_and_b32 v57, s82, v184
    v_lshlrev_b32 v58, 16, v185
    v_and_b32 v59, s82, v185
    v_pk_add_f32 v[48:49], v[48:49], v[56:57]
    v_pk_add_f32 v[50:51], v[50:51], v[58:59]
    v_lshlrev_b32 v56, 16, v188
    v_and_b32 v57, s82, v188
    v_lshlrev_b32 v58, 16, v189
    v_and_b32 v59, s82, v189
    v_pk_add_f32 v[48:49], v[48:49], v[56:57]
    v_pk_add_f32 v[50:51], v[50:51], v[58:59]
    v_lshlrev_b32 v56, 16, v192
    v_and_b32 v57, s82, v192
    v_lshlrev_b32 v58, 16, v193
    v_and_b32 v59, s82, v193
    v_pk_add_f32 v[48:49], v[48:49], v[56:57]
    v_pk_add_f32 v[50:51], v[50:51], v[58:59]
    v_cvt_pk_bf16_f32 v48, v48, v49
    v_cvt_pk_bf16_f32 v49, v50, v51
    s_add_u32 s55, s43, 36864
    buffer_store_dwordx2 v[48:49], v3, s[32:35], s55 offen
L_fin:
L_end:
    s_endpgm
L_sigw:
    s_lshl_b32 s55, s53, 4
    v_mov_b32 v254, s55
    v_mov_b32 v255, 1
    s_mov_b64 exec, 1
    global_atomic_add v254, v255, s[16:17] sc1
    s_mov_b64 exec, -1
    s_branch L_sigw_back
L_flag1:
    s_lshl_b32 s55, s78, 2
    s_add_u32 s55, s55, s22
    v_mov_b32 v252, s55
    v_mov_b32 v253, 1
    s_mov_b64 exec, 1
    global_atomic_add v252, v253, s[76:77] sc1
    s_mov_b64 exec, -1
    s_branch L_flag1_back
L_ctt:
    s_getpc_b64 s[82:83]
L_pct:
    s_sub_u32 s82, s82, L_pct-L_tail0
    s_subb_u32 s83, s83, 0
    s_lshr_b32 s55, s2, 3
    s_lshl_b32 s55, s55, 2
    s_add_u32 s55, s55, s52
    s_lshl_b32 s55, s55, 8
    v_lshrrev_b32 v254, 5, v0
    v_lshl_add_u32 v254, v254, 7, s55
    v_min_u32 v254, L_codeend-L_tail0, v254
    global_load_dword v10, v254, s[82:83]
    s_branch L_ctt_back
L_flag2:
    s_lshl_b32 s55, s20, 2
    s_add_u32 s55, s55, s23
    v_mov_b32 v252, s55
    v_mov_b32 v253, 1
    s_mov_b64 exec, 1
    global_atomic_add v252, v253, s[76:77] sc1
    s_mov_b64 exec, -1
    s_branch L_flag2_back
L_spin1:
    s_mov_b32 s81, 1048576
    v_mov_b32 v252, 0
    s_mov_b64 exec, 7
L_poll_o:
    global_atomic_add v255, v254, v252, s[76:77] sc0 sc1
    s_waitcnt vmcnt(0)
    v_cmp_gt_u32 vcc, 1, v255
    s_cbranch_vccz L_pdone_o
    s_sleep 1
    s_sub_u32 s81, s81, 1
    s_cmp_lg_u32 s81, 0
    s_cbranch_scc1 L_poll_o
L_pdone_o:
    s_mov_b64 exec, -1
    s_branch L_spin1_back
L_flag1b:
    s_lshl_b32 s55, s78, 2
    s_add_u32 s55, s55, s22
    v_mov_b32 v252, s55
    v_mov_b32 v253, 1
    s_mov_b64 exec, 1
    global_atomic_add v252, v253, s[76:77] sc1
    s_mov_b64 exec, -1
    s_branch L_flag1b_back
L_spin1b:
    s_mov_b32 s81, 1048576
    v_mov_b32 v252, 0
    s_mov_b64 exec, 7
L_poll_ob:
    global_atomic_add v255, v254, v252, s[76:77] sc0 sc1
    s_waitcnt vmcnt(0)
    v_cmp_gt_u32 vcc, 2, v255
    s_cbranch_vccz L_pdone_ob
    s_sleep 1
    s_sub_u32 s81, s81, 1
    s_cmp_lg_u32 s81, 0
    s_cbranch_scc1 L_poll_ob
L_pdone_ob:
    s_mov_b64 exec, -1
    s_branch L_spin1b_back
L_spin2:
    v_mov_b32 v254, v12
    s_mov_b32 s81, 1048576
    v_mov_b32 v252, 0
    s_mov_b64 exec, 7
L_poll_x:
    global_atomic_add v255, v254, v252, s[76:77] sc0 sc1
    s_waitcnt vmcnt(0)
    v_cmp_gt_u32 vcc, 1, v255
    s_cbranch_vccz L_pdone_x
    s_sleep 1
    s_sub_u32 s81, s81, 1
    s_cmp_lg_u32 s81, 0
    s_cbranch_scc1 L_poll_x
L_pdone_x:
    s_mov_b64 exec, -1
    s_branch L_spin2_back
L_chkw:
    s_mov_b32 s81, 1048576
    s_waitcnt vmcnt(7)
L_chkw_loop:
    v_readfirstlane_b32 s55, v255
    s_nop 0
    s_cmp_ge_u32 s55, 16
    s_cbranch_scc1 L_chkw_back
    s_sleep 2
    v_mov_b32 v255, 0
    s_mov_b64 exec, 1
    global_atomic_add v255, v254, v255, s[16:17] sc0 sc1
    s_mov_b64 exec, -1
    s_waitcnt vmcnt(0)
    s_sub_u32 s81, s81, 1
    s_cmp_lg_u32 s81, 0
    s_cbranch_scc1 L_chkw_loop
    s_branch L_chkw_back
L_ldw:
    s_lshl_b32 s55, s53, 4
    v_mov_b32 v254, s55
    global_load_dword v255, v254, s[16:17] sc1
    s_branch L_ldw_back
L_codeend:
L_stub0:
    s_call_b64 s[70:71], L_rare00
    s_branch L_back0
L_stub1:
    s_call_b64 s[70:71], L_rare01
    s_branch L_back1
L_stub2:
    s_call_b64 s[70:71], L_rare10
    s_branch L_back2
L_stub3:
    s_call_b64 s[70:71], L_rare11
    s_branch L_back3
L_stub4:
    s_call_b64 s[70:71], L_rare00
    s_branch L_back4
L_stub5:
    s_call_b64 s[70:71], L_rare01
    s_branch L_back5
L_stub6:
    s_call_b64 s[70:71], L_rare10
    s_branch L_back6
L_stub7:
    s_call_b64 s[70:71], L_rare11
    s_branch L_back7
L_rare00:
    s_nop 15
    v_max3_f32 v248, v184, v185, v186
    v_max3_f32 v248, v248, v187, v208
    v_max3_f32 v248, v248, v209, v210
    v_max3_f32 v248, v248, v211, 0
    v_mov_b32 v249, v248
    s_nop 1
    v_permlane16_swap_b32 v248, v249
    v_max_f32 v248, v248, v249
    v_mov_b32 v249, v248
    s_nop 1
    v_permlane32_swap_b32 v248, v249
    v_max_f32 v248, v248, v249
    v_exp_f32 v250, -v248
    v_sub_f32 v160, v160, v248
    v_sub_f32 v161, v161, v248
    v_sub_f32 v162, v162, v248
    v_sub_f32 v163, v163, v248
    v_mul_f32 v232, v238, v250
    v_sub_f32 v184, v184, v248
    v_sub_f32 v185, v185, v248
    v_sub_f32 v186, v186, v248
    v_sub_f32 v187, v187, v248
    v_sub_f32 v208, v208, v248
    v_sub_f32 v209, v209, v248
    v_sub_f32 v210, v210, v248
    v_sub_f32 v211, v211, v248
    v_exp_f32 v184, v184
    v_exp_f32 v185, v185
    v_exp_f32 v186, v186
    v_exp_f32 v187, v187
    v_exp_f32 v208, v208
    v_exp_f32 v209, v209
    v_exp_f32 v210, v210
    v_exp_f32 v211, v211
    v_add_f32 v232, v232, v184
    v_add_f32 v232, v232, v185
    v_add_f32 v232, v232, v186
    v_add_f32 v232, v232, v187
    v_add_f32 v232, v232, v208
    v_add_f32 v232, v232, v209
    v_add_f32 v232, v232, v210
    v_add_f32 v232, v232, v211
    v_cvt_pk_bf16_f32 v16, v184, v185
    v_cvt_pk_bf16_f32 v17, v186, v187
    v_cvt_pk_bf16_f32 v18, v208, v209
    v_cvt_pk_bf16_f32 v19, v210, v211
    v_accvgpr_read_b32 v249, a0
    v_mul_f32 v249, v249, v250
    v_accvgpr_write_b32 a0, v249
    v_accvgpr_read_b32 v249, a1
    v_mul_f32 v249, v249, v250
    v_accvgpr_write_b32 a1, v249
    v_accvgpr_read_b32 v249, a2
    v_mul_f32 v249, v249, v250
    v_accvgpr_write_b32 a2, v249
    v_accvgpr_read_b32 v249, a3
    v_mul_f32 v249, v249, v250
    v_accvgpr_write_b32 a3, v249
    v_accvgpr_read_b32 v249, a4
    v_mul_f32 v249, v249, v250
    v_accvgpr_write_b32 a4, v249
    v_accvgpr_read_b32 v249, a5
    v_mul_f32 v249, v249, v250
    v_accvgpr_write_b32 a5, v249
    v_accvgpr_read_b32 v249, a6
    v_mul_f32 v249, v249, v250
    v_accvgpr_write_b32 a6, v249
    v_accvgpr_read_b32 v249, a7
    v_mul_f32 v249, v249, v250
    v_accvgpr_write_b32 a7, v249
    v_accvgpr_read_b32 v249, a8
    v_mul_f32 v249, v249, v250
    v_accvgpr_write_b32 a8, v249
    v_accvgpr_read_b32 v249, a9
    v_mul_f32 v249, v249, v250
    v_accvgpr_write_b32 a9, v249
    v_accvgpr_read_b32 v249, a10
    v_mul_f32 v249, v249, v250
    v_accvgpr_write_b32 a10, v249
    v_accvgpr_read_b32 v249, a11
    v_mul_f32 v249, v249, v250
    v_accvgpr_write_b32 a11, v249
    v_accvgpr_read_b32 v249, a12
    v_mul_f32 v249, v249, v250
    v_accvgpr_write_b32 a12, v249
    v_accvgpr_read_b32 v249, a13
    v_mul_f32 v249, v249, v250
    v_accvgpr_write_b32 a13, v249
    v_accvgpr_read_b32 v249, a14
    v_mul_f32 v249, v249, v250
    v_accvgpr_write_b32 a14, v249
    v_accvgpr_read_b32 v249, a15
    v_mul_f32 v249, v249, v250
    v_accvgpr_write_b32 a15, v249
    v_accvgpr_read_b32 v249, a16
    v_mul_f32 v249, v249, v250
    v_accvgpr_write_b32 a16, v249
    v_accvgpr_read_b32 v249, a17
    v_mul_f32 v249, v249, v250
    v_accvgpr_write_b32 a17, v249
    v_accvgpr_read_b32 v249, a18
    v_mul_f32 v249, v249, v250
    v_accvgpr_write_b32 a18, v249
    v_accvgpr_read_b32 v249, a19
    v_mul_f32 v249, v249, v250
    v_accvgpr_write_b32 a19, v249
    v_accvgpr_read_b32 v249, a20
    v_mul_f32 v249, v249, v250
    v_accvgpr_write_b32 a20, v249
    v_accvgpr_read_b32 v249, a21
    v_mul_f32 v249, v249, v250
    v_accvgpr_write_b32 a21, v249
    v_accvgpr_read_b32 v249, a22
    v_mul_f32 v249, v249, v250
    v_accvgpr_write_b32 a22, v249
    v_accvgpr_read_b32 v249, a23
    v_mul_f32 v249, v249, v250
    v_accvgpr_write_b32 a23, v249
    v_accvgpr_read_b32 v249, a24
    v_mul_f32 v249, v249, v250
    v_accvgpr_write_b32 a24, v249
    v_accvgpr_read_b32 v249, a25
    v_mul_f32 v249, v249, v250
    v_accvgpr_write_b32 a25, v249
    v_accvgpr_read_b32 v249, a26
    v_mul_f32 v249, v249, v250
    v_accvgpr_write_b32 a26, v249
    v_accvgpr_read_b32 v249, a27
    v_mul_f32 v249, v249, v250
    v_accvgpr_write_b32 a27, v249
    v_accvgpr_read_b32 v249, a28
    v_mul_f32 v249, v249, v250
    v_accvgpr_write_b32 a28, v249
    v_accvgpr_read_b32 v249, a29
    v_mul_f32 v249, v249, v250
    v_accvgpr_write_b32 a29, v249
    v_accvgpr_read_b32 v249, a30
    v_mul_f32 v249, v249, v250
    v_accvgpr_write_b32 a30, v249
    v_accvgpr_read_b32 v249, a31
    v_mul_f32 v249, v249, v250
    v_accvgpr_write_b32 a31, v249
    v_max3_f32 v248, v188, v189, v190
    v_max3_f32 v248, v248, v191, v212
    v_max3_f32 v248, v248, v213, v214
    v_max3_f32 v248, v248, v215, 0
    v_mov_b32 v249, v248
    s_nop 1
    v_permlane16_swap_b32 v248, v249
    v_max_f32 v248, v248, v249
    v_mov_b32 v249, v248
    s_nop 1
    v_permlane32_swap_b32 v248, v249
    v_max_f32 v248, v248, v249
    v_exp_f32 v250, -v248
    v_sub_f32 v164, v164, v248
    v_sub_f32 v165, v165, v248
    v_sub_f32 v166, v166, v248
    v_sub_f32 v167, v167, v248
    v_mul_f32 v233, v239, v250
    v_sub_f32 v188, v188, v248
    v_sub_f32 v189, v189, v248
    v_sub_f32 v190, v190, v248
    v_sub_f32 v191, v191, v248
    v_sub_f32 v212, v212, v248
    v_sub_f32 v213, v213, v248
    v_sub_f32 v214, v214, v248
    v_sub_f32 v215, v215, v248
    v_exp_f32 v188, v188
    v_exp_f32 v189, v189
    v_exp_f32 v190, v190
    v_exp_f32 v191, v191
    v_exp_f32 v212, v212
    v_exp_f32 v213, v213
    v_exp_f32 v214, v214
    v_exp_f32 v215, v215
    v_add_f32 v233, v233, v188
    v_add_f32 v233, v233, v189
    v_add_f32 v233, v233, v190
    v_add_f32 v233, v233, v191
    v_add_f32 v233, v233, v212
    v_add_f32 v233, v233, v213
    v_add_f32 v233, v233, v214
    v_add_f32 v233, v233, v215
    v_cvt_pk_bf16_f32 v20, v188, v189
    v_cvt_pk_bf16_f32 v21, v190, v191
    v_cvt_pk_bf16_f32 v22, v212, v213
    v_cvt_pk_bf16_f32 v23, v214, v215
    v_accvgpr_read_b32 v249, a32
    v_mul_f32 v249, v249, v250
    v_accvgpr_write_b32 a32, v249
    v_accvgpr_read_b32 v249, a33
    v_mul_f32 v249, v249, v250
    v_accvgpr_write_b32 a33, v249
    v_accvgpr_read_b32 v249, a34
    v_mul_f32 v249, v249, v250
    v_accvgpr_write_b32 a34, v249
    v_accvgpr_read_b32 v249, a35
    v_mul_f32 v249, v249, v250
    v_accvgpr_write_b32 a35, v249
    v_accvgpr_read_b32 v249, a36
    v_mul_f32 v249, v249, v250
    v_accvgpr_write_b32 a36, v249
    v_accvgpr_read_b32 v249, a37
    v_mul_f32 v249, v249, v250
    v_accvgpr_write_b32 a37, v249
    v_accvgpr_read_b32 v249, a38
    v_mul_f32 v249, v249, v250
    v_accvgpr_write_b32 a38, v249
    v_accvgpr_read_b32 v249, a39
    v_mul_f32 v249, v249, v250
    v_accvgpr_write_b32 a39, v249
    v_accvgpr_read_b32 v249, a40
    v_mul_f32 v249, v249, v250
    v_accvgpr_write_b32 a40, v249
    v_accvgpr_read_b32 v249, a41
    v_mul_f32 v249, v249, v250
    v_accvgpr_write_b32 a41, v249
    v_accvgpr_read_b32 v249, a42
    v_mul_f32 v249, v249, v250
    v_accvgpr_write_b32 a42, v249
    v_accvgpr_read_b32 v249, a43
    v_mul_f32 v249, v249, v250
    v_accvgpr_write_b32 a43, v249
    v_accvgpr_read_b32 v249, a44
    v_mul_f32 v249, v249, v250
    v_accvgpr_write_b32 a44, v249
    v_accvgpr_read_b32 v249, a45
    v_mul_f32 v249, v249, v250
    v_accvgpr_write_b32 a45, v249
    v_accvgpr_read_b32 v249, a46
    v_mul_f32 v249, v249, v250
    v_accvgpr_write_b32 a46, v249
    v_accvgpr_read_b32 v249, a47
    v_mul_f32 v249, v249, v250
    v_accvgpr_write_b32 a47, v249
    v_accvgpr_read_b32 v249, a48
    v_mul_f32 v249, v249, v250
    v_accvgpr_write_b32 a48, v249
    v_accvgpr_read_b32 v249, a49
    v_mul_f32 v249, v249, v250
    v_accvgpr_write_b32 a49, v249
    v_accvgpr_read_b32 v249, a50
    v_mul_f32 v249, v249, v250
    v_accvgpr_write_b32 a50, v249
    v_accvgpr_read_b32 v249, a51
    v_mul_f32 v249, v249, v250
    v_accvgpr_write_b32 a51, v249
    v_accvgpr_read_b32 v249, a52
    v_mul_f32 v249, v249, v250
    v_accvgpr_write_b32 a52, v249
    v_accvgpr_read_b32 v249, a53
    v_mul_f32 v249, v249, v250
    v_accvgpr_write_b32 a53, v249
    v_accvgpr_read_b32 v249, a54
    v_mul_f32 v249, v249, v250
    v_accvgpr_write_b32 a54, v249
    v_accvgpr_read_b32 v249, a55
    v_mul_f32 v249, v249, v250
    v_accvgpr_write_b32 a55, v249
    v_accvgpr_read_b32 v249, a56
    v_mul_f32 v249, v249, v250
    v_accvgpr_write_b32 a56, v249
    v_accvgpr_read_b32 v249, a57
    v_mul_f32 v249, v249, v250
    v_accvgpr_write_b32 a57, v249
    v_accvgpr_read_b32 v249, a58
    v_mul_f32 v249, v249, v250
    v_accvgpr_write_b32 a58, v249
    v_accvgpr_read_b32 v249, a59
    v_mul_f32 v249, v249, v250
    v_accvgpr_write_b32 a59, v249
    v_accvgpr_read_b32 v249, a60
    v_mul_f32 v249, v249, v250
    v_accvgpr_write_b32 a60, v249
    v_accvgpr_read_b32 v249, a61
    v_mul_f32 v249, v249, v250
    v_accvgpr_write_b32 a61, v249
    v_accvgpr_read_b32 v249, a62
    v_mul_f32 v249, v249, v250
    v_accvgpr_write_b32 a62, v249
    v_accvgpr_read_b32 v249, a63
    v_mul_f32 v249, v249, v250
    v_accvgpr_write_b32 a63, v249
    v_max3_f32 v248, v192, v193, v194
    v_max3_f32 v248, v248, v195, v216
    v_max3_f32 v248, v248, v217, v218
    v_max3_f32 v248, v248, v219, 0
    v_mov_b32 v249, v248
    s_nop 1
    v_permlane16_swap_b32 v248, v249
    v_max_f32 v248, v248, v249
    v_mov_b32 v249, v248
    s_nop 1
    v_permlane32_swap_b32 v248, v249
    v_max_f32 v248, v248, v249
    v_exp_f32 v250, -v248
    v_sub_f32 v168, v168, v248
    v_sub_f32 v169, v169, v248
    v_sub_f32 v170, v170, v248
    v_sub_f32 v171, v171, v248
    v_mul_f32 v234, v240, v250
    v_sub_f32 v192, v192, v248
    v_sub_f32 v193, v193, v248
    v_sub_f32 v194, v194, v248
    v_sub_f32 v195, v195, v248
    v_sub_f32 v216, v216, v248
    v_sub_f32 v217, v217, v248
    v_sub_f32 v218, v218, v248
    v_sub_f32 v219, v219, v248
    v_exp_f32 v192, v192
    v_exp_f32 v193, v193
    v_exp_f32 v194, v194
    v_exp_f32 v195, v195
    v_exp_f32 v216, v216
    v_exp_f32 v217, v217
    v_exp_f32 v218, v218
    v_exp_f32 v219, v219
    v_add_f32 v234, v234, v192
    v_add_f32 v234, v234, v193
    v_add_f32 v234, v234, v194
    v_add_f32 v234, v234, v195
    v_add_f32 v234, v234, v216
    v_add_f32 v234, v234, v217
    v_add_f32 v234, v234, v218
    v_add_f32 v234, v234, v219
    v_cvt_pk_bf16_f32 v24, v192, v193
    v_cvt_pk_bf16_f32 v25, v194, v195
    v_cvt_pk_bf16_f32 v26, v216, v217
    v_cvt_pk_bf16_f32 v27, v218, v219
    v_accvgpr_read_b32 v249, a64
    v_mul_f32 v249, v249, v250
    v_accvgpr_write_b32 a64, v249
    v_accvgpr_read_b32 v249, a65
    v_mul_f32 v249, v249, v250
    v_accvgpr_write_b32 a65, v249
    v_accvgpr_read_b32 v249, a66
    v_mul_f32 v249, v249, v250
    v_accvgpr_write_b32 a66, v249
    v_accvgpr_read_b32 v249, a67
    v_mul_f32 v249, v249, v250
    v_accvgpr_write_b32 a67, v249
    v_accvgpr_read_b32 v249, a68
    v_mul_f32 v249, v249, v250
    v_accvgpr_write_b32 a68, v249
    v_accvgpr_read_b32 v249, a69
    v_mul_f32 v249, v249, v250
    v_accvgpr_write_b32 a69, v249
    v_accvgpr_read_b32 v249, a70
    v_mul_f32 v249, v249, v250
    v_accvgpr_write_b32 a70, v249
    v_accvgpr_read_b32 v249, a71
    v_mul_f32 v249, v249, v250
    v_accvgpr_write_b32 a71, v249
    v_accvgpr_read_b32 v249, a72
    v_mul_f32 v249, v249, v250
    v_accvgpr_write_b32 a72, v249
    v_accvgpr_read_b32 v249, a73
    v_mul_f32 v249, v249, v250
    v_accvgpr_write_b32 a73, v249
    v_accvgpr_read_b32 v249, a74
    v_mul_f32 v249, v249, v250
    v_accvgpr_write_b32 a74, v249
    v_accvgpr_read_b32 v249, a75
    v_mul_f32 v249, v249, v250
    v_accvgpr_write_b32 a75, v249
    v_accvgpr_read_b32 v249, a76
    v_mul_f32 v249, v249, v250
    v_accvgpr_write_b32 a76, v249
    v_accvgpr_read_b32 v249, a77
    v_mul_f32 v249, v249, v250
    v_accvgpr_write_b32 a77, v249
    v_accvgpr_read_b32 v249, a78
    v_mul_f32 v249, v249, v250
    v_accvgpr_write_b32 a78, v249
    v_accvgpr_read_b32 v249, a79
    v_mul_f32 v249, v249, v250
    v_accvgpr_write_b32 a79, v249
    v_accvgpr_read_b32 v249, a80
    v_mul_f32 v249, v249, v250
    v_accvgpr_write_b32 a80, v249
    v_accvgpr_read_b32 v249, a81
    v_mul_f32 v249, v249, v250
    v_accvgpr_write_b32 a81, v249
    v_accvgpr_read_b32 v249, a82
    v_mul_f32 v249, v249, v250
    v_accvgpr_write_b32 a82, v249
    v_accvgpr_read_b32 v249, a83
    v_mul_f32 v249, v249, v250
    v_accvgpr_write_b32 a83, v249
    v_accvgpr_read_b32 v249, a84
    v_mul_f32 v249, v249, v250
    v_accvgpr_write_b32 a84, v249
    v_accvgpr_read_b32 v249, a85
    v_mul_f32 v249, v249, v250
    v_accvgpr_write_b32 a85, v249
    v_accvgpr_read_b32 v249, a86
    v_mul_f32 v249, v249, v250
    v_accvgpr_write_b32 a86, v249
    v_accvgpr_read_b32 v249, a87
    v_mul_f32 v249, v249, v250
    v_accvgpr_write_b32 a87, v249
    v_accvgpr_read_b32 v249, a88
    v_mul_f32 v249, v249, v250
    v_accvgpr_write_b32 a88, v249
    v_accvgpr_read_b32 v249, a89
    v_mul_f32 v249, v249, v250
    v_accvgpr_write_b32 a89, v249
    v_accvgpr_read_b32 v249, a90
    v_mul_f32 v249, v249, v250
    v_accvgpr_write_b32 a90, v249
    v_accvgpr_read_b32 v249, a91
    v_mul_f32 v249, v249, v250
    v_accvgpr_write_b32 a91, v249
    v_accvgpr_read_b32 v249, a92
    v_mul_f32 v249, v249, v250
    v_accvgpr_write_b32 a92, v249
    v_accvgpr_read_b32 v249, a93
    v_mul_f32 v249, v249, v250
    v_accvgpr_write_b32 a93, v249
    v_accvgpr_read_b32 v249, a94
    v_mul_f32 v249, v249, v250
    v_accvgpr_write_b32 a94, v249
    v_accvgpr_read_b32 v249, a95
    v_mul_f32 v249, v249, v250
    v_accvgpr_write_b32 a95, v249
    s_nop 3
    s_setpc_b64 s[70:71]
L_rare01:
    s_nop 15
    v_max3_f32 v248, v196, v197, v198
    v_max3_f32 v248, v248, v199, v220
    v_max3_f32 v248, v248, v221, v222
    v_max3_f32 v248, v248, v223, 0
    v_mov_b32 v249, v248
    s_nop 1
    v_permlane16_swap_b32 v248, v249
    v_max_f32 v248, v248, v249
    v_mov_b32 v249, v248
    s_nop 1
    v_permlane32_swap_b32 v248, v249
    v_max_f32 v248, v248, v249
    v_exp_f32 v250, -v248
    v_sub_f32 v172, v172, v248
    v_sub_f32 v173, v173, v248
    v_sub_f32 v174, v174, v248
    v_sub_f32 v175, v175, v248
    v_mul_f32 v235, v241, v250
    v_sub_f32 v196, v196, v248
    v_sub_f32 v197, v197, v248
    v_sub_f32 v198, v198, v248
    v_sub_f32 v199, v199, v248
    v_sub_f32 v220, v220, v248
    v_sub_f32 v221, v221, v248
    v_sub_f32 v222, v222, v248
    v_sub_f32 v223, v223, v248
    v_exp_f32 v196, v196
    v_exp_f32 v197, v197
    v_exp_f32 v198, v198
    v_exp_f32 v199, v199
    v_exp_f32 v220, v220
    v_exp_f32 v221, v221
    v_exp_f32 v222, v222
    v_exp_f32 v223, v223
    v_add_f32 v235, v235, v196
    v_add_f32 v235, v235, v197
    v_add_f32 v235, v235, v198
    v_add_f32 v235, v235, v199
    v_add_f32 v235, v235, v220
    v_add_f32 v235, v235, v221
    v_add_f32 v235, v235, v222
    v_add_f32 v235, v235, v223
    v_cvt_pk_bf16_f32 v28, v196, v197
    v_cvt_pk_bf16_f32 v29, v198, v199
    v_cvt_pk_bf16_f32 v30, v220, v221
    v_cvt_pk_bf16_f32 v31, v222, v223
    v_accvgpr_read_b32 v249, a96
    v_mul_f32 v249, v249, v250
    v_accvgpr_write_b32 a96, v249
    v_accvgpr_read_b32 v249, a97
    v_mul_f32 v249, v249, v250
    v_accvgpr_write_b32 a97, v249
    v_accvgpr_read_b32 v249, a98
    v_mul_f32 v249, v249, v250
    v_accvgpr_write_b32 a98, v249
    v_accvgpr_read_b32 v249, a99
    v_mul_f32 v249, v249, v250
    v_accvgpr_write_b32 a99, v249
    v_accvgpr_read_b32 v249, a100
    v_mul_f32 v249, v249, v250
    v_accvgpr_write_b32 a100, v249
    v_accvgpr_read_b32 v249, a101
    v_mul_f32 v249, v249, v250
    v_accvgpr_write_b32 a101, v249
    v_accvgpr_read_b32 v249, a102
    v_mul_f32 v249, v249, v250
    v_accvgpr_write_b32 a102, v249
    v_accvgpr_read_b32 v249, a103
    v_mul_f32 v249, v249, v250
    v_accvgpr_write_b32 a103, v249
    v_accvgpr_read_b32 v249, a104
    v_mul_f32 v249, v249, v250
    v_accvgpr_write_b32 a104, v249
    v_accvgpr_read_b32 v249, a105
    v_mul_f32 v249, v249, v250
    v_accvgpr_write_b32 a105, v249
    v_accvgpr_read_b32 v249, a106
    v_mul_f32 v249, v249, v250
    v_accvgpr_write_b32 a106, v249
    v_accvgpr_read_b32 v249, a107
    v_mul_f32 v249, v249, v250
    v_accvgpr_write_b32 a107, v249
    v_accvgpr_read_b32 v249, a108
    v_mul_f32 v249, v249, v250
    v_accvgpr_write_b32 a108, v249
    v_accvgpr_read_b32 v249, a109
    v_mul_f32 v249, v249, v250
    v_accvgpr_write_b32 a109, v249
    v_accvgpr_read_b32 v249, a110
    v_mul_f32 v249, v249, v250
    v_accvgpr_write_b32 a110, v249
    v_accvgpr_read_b32 v249, a111
    v_mul_f32 v249, v249, v250
    v_accvgpr_write_b32 a111, v249
    v_accvgpr_read_b32 v249, a112
    v_mul_f32 v249, v249, v250
    v_accvgpr_write_b32 a112, v249
    v_accvgpr_read_b32 v249, a113
    v_mul_f32 v249, v249, v250
    v_accvgpr_write_b32 a113, v249
    v_accvgpr_read_b32 v249, a114
    v_mul_f32 v249, v249, v250
    v_accvgpr_write_b32 a114, v249
    v_accvgpr_read_b32 v249, a115
    v_mul_f32 v249, v249, v250
    v_accvgpr_write_b32 a115, v249
    v_accvgpr_read_b32 v249, a116
    v_mul_f32 v249, v249, v250
    v_accvgpr_write_b32 a116, v249
    v_accvgpr_read_b32 v249, a117
    v_mul_f32 v249, v249, v250
    v_accvgpr_write_b32 a117, v249
    v_accvgpr_read_b32 v249, a118
    v_mul_f32 v249, v249, v250
    v_accvgpr_write_b32 a118, v249
    v_accvgpr_read_b32 v249, a119
    v_mul_f32 v249, v249, v250
    v_accvgpr_write_b32 a119, v249
    v_accvgpr_read_b32 v249, a120
    v_mul_f32 v249, v249, v250
    v_accvgpr_write_b32 a120, v249
    v_accvgpr_read_b32 v249, a121
    v_mul_f32 v249, v249, v250
    v_accvgpr_write_b32 a121, v249
    v_accvgpr_read_b32 v249, a122
    v_mul_f32 v249, v249, v250
    v_accvgpr_write_b32 a122, v249
    v_accvgpr_read_b32 v249, a123
    v_mul_f32 v249, v249, v250
    v_accvgpr_write_b32 a123, v249
    v_accvgpr_read_b32 v249, a124
    v_mul_f32 v249, v249, v250
    v_accvgpr_write_b32 a124, v249
    v_accvgpr_read_b32 v249, a125
    v_mul_f32 v249, v249, v250
    v_accvgpr_write_b32 a125, v249
    v_accvgpr_read_b32 v249, a126
    v_mul_f32 v249, v249, v250
    v_accvgpr_write_b32 a126, v249
    v_accvgpr_read_b32 v249, a127
    v_mul_f32 v249, v249, v250
    v_accvgpr_write_b32 a127, v249
    v_max3_f32 v248, v200, v201, v202
    v_max3_f32 v248, v248, v203, v224
    v_max3_f32 v248, v248, v225, v226
    v_max3_f32 v248, v248, v227, 0
    v_mov_b32 v249, v248
    s_nop 1
    v_permlane16_swap_b32 v248, v249
    v_max_f32 v248, v248, v249
    v_mov_b32 v249, v248
    s_nop 1
    v_permlane32_swap_b32 v248, v249
    v_max_f32 v248, v248, v249
    v_exp_f32 v250, -v248
    v_sub_f32 v176, v176, v248
    v_sub_f32 v177, v177, v248
    v_sub_f32 v178, v178, v248
    v_sub_f32 v179, v179, v248
    v_mul_f32 v236, v242, v250
    v_sub_f32 v200, v200, v248
    v_sub_f32 v201, v201, v248
    v_sub_f32 v202, v202, v248
    v_sub_f32 v203, v203, v248
    v_sub_f32 v224, v224, v248
    v_sub_f32 v225, v225, v248
    v_sub_f32 v226, v226, v248
    v_sub_f32 v227, v227, v248
    v_exp_f32 v200, v200
    v_exp_f32 v201, v201
    v_exp_f32 v202, v202
    v_exp_f32 v203, v203
    v_exp_f32 v224, v224
    v_exp_f32 v225, v225
    v_exp_f32 v226, v226
    v_exp_f32 v227, v227
    v_add_f32 v236, v236, v200
    v_add_f32 v236, v236, v201
    v_add_f32 v236, v236, v202
    v_add_f32 v236, v236, v203
    v_add_f32 v236, v236, v224
    v_add_f32 v236, v236, v225
    v_add_f32 v236, v236, v226
    v_add_f32 v236, v236, v227
    v_cvt_pk_bf16_f32 v32, v200, v201
    v_cvt_pk_bf16_f32 v33, v202, v203
    v_cvt_pk_bf16_f32 v34, v224, v225
    v_cvt_pk_bf16_f32 v35, v226, v227
    v_accvgpr_read_b32 v249, a128
    v_mul_f32 v249, v249, v250
    v_accvgpr_write_b32 a128, v249
    v_accvgpr_read_b32 v249, a129
    v_mul_f32 v249, v249, v250
    v_accvgpr_write_b32 a129, v249
    v_accvgpr_read_b32 v249, a130
    v_mul_f32 v249, v249, v250
    v_accvgpr_write_b32 a130, v249
    v_accvgpr_read_b32 v249, a131
    v_mul_f32 v249, v249, v250
    v_accvgpr_write_b32 a131, v249
    v_accvgpr_read_b32 v249, a132
    v_mul_f32 v249, v249, v250
    v_accvgpr_write_b32 a132, v249
    v_accvgpr_read_b32 v249, a133
    v_mul_f32 v249, v249, v250
    v_accvgpr_write_b32 a133, v249
    v_accvgpr_read_b32 v249, a134
    v_mul_f32 v249, v249, v250
    v_accvgpr_write_b32 a134, v249
    v_accvgpr_read_b32 v249, a135
    v_mul_f32 v249, v249, v250
    v_accvgpr_write_b32 a135, v249
    v_accvgpr_read_b32 v249, a136
    v_mul_f32 v249, v249, v250
    v_accvgpr_write_b32 a136, v249
    v_accvgpr_read_b32 v249, a137
    v_mul_f32 v249, v249, v250
    v_accvgpr_write_b32 a137, v249
    v_accvgpr_read_b32 v249, a138
    v_mul_f32 v249, v249, v250
    v_accvgpr_write_b32 a138, v249
    v_accvgpr_read_b32 v249, a139
    v_mul_f32 v249, v249, v250
    v_accvgpr_write_b32 a139, v249
    v_accvgpr_read_b32 v249, a140
    v_mul_f32 v249, v249, v250
    v_accvgpr_write_b32 a140, v249
    v_accvgpr_read_b32 v249, a141
    v_mul_f32 v249, v249, v250
    v_accvgpr_write_b32 a141, v249
    v_accvgpr_read_b32 v249, a142
    v_mul_f32 v249, v249, v250
    v_accvgpr_write_b32 a142, v249
    v_accvgpr_read_b32 v249, a143
    v_mul_f32 v249, v249, v250
    v_accvgpr_write_b32 a143, v249
    v_accvgpr_read_b32 v249, a144
    v_mul_f32 v249, v249, v250
    v_accvgpr_write_b32 a144, v249
    v_accvgpr_read_b32 v249, a145
    v_mul_f32 v249, v249, v250
    v_accvgpr_write_b32 a145, v249
    v_accvgpr_read_b32 v249, a146
    v_mul_f32 v249, v249, v250
    v_accvgpr_write_b32 a146, v249
    v_accvgpr_read_b32 v249, a147
    v_mul_f32 v249, v249, v250
    v_accvgpr_write_b32 a147, v249
    v_accvgpr_read_b32 v249, a148
    v_mul_f32 v249, v249, v250
    v_accvgpr_write_b32 a148, v249
    v_accvgpr_read_b32 v249, a149
    v_mul_f32 v249, v249, v250
    v_accvgpr_write_b32 a149, v249
    v_accvgpr_read_b32 v249, a150
    v_mul_f32 v249, v249, v250
    v_accvgpr_write_b32 a150, v249
    v_accvgpr_read_b32 v249, a151
    v_mul_f32 v249, v249, v250
    v_accvgpr_write_b32 a151, v249
    v_accvgpr_read_b32 v249, a152
    v_mul_f32 v249, v249, v250
    v_accvgpr_write_b32 a152, v249
    v_accvgpr_read_b32 v249, a153
    v_mul_f32 v249, v249, v250
    v_accvgpr_write_b32 a153, v249
    v_accvgpr_read_b32 v249, a154
    v_mul_f32 v249, v249, v250
    v_accvgpr_write_b32 a154, v249
    v_accvgpr_read_b32 v249, a155
    v_mul_f32 v249, v249, v250
    v_accvgpr_write_b32 a155, v249
    v_accvgpr_read_b32 v249, a156
    v_mul_f32 v249, v249, v250
    v_accvgpr_write_b32 a156, v249
    v_accvgpr_read_b32 v249, a157
    v_mul_f32 v249, v249, v250
    v_accvgpr_write_b32 a157, v249
    v_accvgpr_read_b32 v249, a158
    v_mul_f32 v249, v249, v250
    v_accvgpr_write_b32 a158, v249
    v_accvgpr_read_b32 v249, a159
    v_mul_f32 v249, v249, v250
    v_accvgpr_write_b32 a159, v249
    v_max3_f32 v248, v204, v205, v206
    v_max3_f32 v248, v248, v207, v228
    v_max3_f32 v248, v248, v229, v230
    v_max3_f32 v248, v248, v231, 0
    v_mov_b32 v249, v248
    s_nop 1
    v_permlane16_swap_b32 v248, v249
    v_max_f32 v248, v248, v249
    v_mov_b32 v249, v248
    s_nop 1
    v_permlane32_swap_b32 v248, v249
    v_max_f32 v248, v248, v249
    v_exp_f32 v250, -v248
    v_sub_f32 v180, v180, v248
    v_sub_f32 v181, v181, v248
    v_sub_f32 v182, v182, v248
    v_sub_f32 v183, v183, v248
    v_mul_f32 v237, v243, v250
    v_sub_f32 v204, v204, v248
    v_sub_f32 v205, v205, v248
    v_sub_f32 v206, v206, v248
    v_sub_f32 v207, v207, v248
    v_sub_f32 v228, v228, v248
    v_sub_f32 v229, v229, v248
    v_sub_f32 v230, v230, v248
    v_sub_f32 v231, v231, v248
    v_exp_f32 v204, v204
    v_exp_f32 v205, v205
    v_exp_f32 v206, v206
    v_exp_f32 v207, v207
    v_exp_f32 v228, v228
    v_exp_f32 v229, v229
    v_exp_f32 v230, v230
    v_exp_f32 v231, v231
    v_add_f32 v237, v237, v204
    v_add_f32 v237, v237, v205
    v_add_f32 v237, v237, v206
    v_add_f32 v237, v237, v207
    v_add_f32 v237, v237, v228
    v_add_f32 v237, v237, v229
    v_add_f32 v237, v237, v230
    v_add_f32 v237, v237, v231
    v_cvt_pk_bf16_f32 v36, v204, v205
    v_cvt_pk_bf16_f32 v37, v206, v207
    v_cvt_pk_bf16_f32 v38, v228, v229
    v_cvt_pk_bf16_f32 v39, v230, v231
    v_accvgpr_read_b32 v249, a160
    v_mul_f32 v249, v249, v250
    v_accvgpr_write_b32 a160, v249
    v_accvgpr_read_b32 v249, a161
    v_mul_f32 v249, v249, v250
    v_accvgpr_write_b32 a161, v249
    v_accvgpr_read_b32 v249, a162
    v_mul_f32 v249, v249, v250
    v_accvgpr_write_b32 a162, v249
    v_accvgpr_read_b32 v249, a163
    v_mul_f32 v249, v249, v250
    v_accvgpr_write_b32 a163, v249
    v_accvgpr_read_b32 v249, a164
    v_mul_f32 v249, v249, v250
    v_accvgpr_write_b32 a164, v249
    v_accvgpr_read_b32 v249, a165
    v_mul_f32 v249, v249, v250
    v_accvgpr_write_b32 a165, v249
    v_accvgpr_read_b32 v249, a166
    v_mul_f32 v249, v249, v250
    v_accvgpr_write_b32 a166, v249
    v_accvgpr_read_b32 v249, a167
    v_mul_f32 v249, v249, v250
    v_accvgpr_write_b32 a167, v249
    v_accvgpr_read_b32 v249, a168
    v_mul_f32 v249, v249, v250
    v_accvgpr_write_b32 a168, v249
    v_accvgpr_read_b32 v249, a169
    v_mul_f32 v249, v249, v250
    v_accvgpr_write_b32 a169, v249
    v_accvgpr_read_b32 v249, a170
    v_mul_f32 v249, v249, v250
    v_accvgpr_write_b32 a170, v249
    v_accvgpr_read_b32 v249, a171
    v_mul_f32 v249, v249, v250
    v_accvgpr_write_b32 a171, v249
    v_accvgpr_read_b32 v249, a172
    v_mul_f32 v249, v249, v250
    v_accvgpr_write_b32 a172, v249
    v_accvgpr_read_b32 v249, a173
    v_mul_f32 v249, v249, v250
    v_accvgpr_write_b32 a173, v249
    v_accvgpr_read_b32 v249, a174
    v_mul_f32 v249, v249, v250
    v_accvgpr_write_b32 a174, v249
    v_accvgpr_read_b32 v249, a175
    v_mul_f32 v249, v249, v250
    v_accvgpr_write_b32 a175, v249
    v_accvgpr_read_b32 v249, a176
    v_mul_f32 v249, v249, v250
    v_accvgpr_write_b32 a176, v249
    v_accvgpr_read_b32 v249, a177
    v_mul_f32 v249, v249, v250
    v_accvgpr_write_b32 a177, v249
    v_accvgpr_read_b32 v249, a178
    v_mul_f32 v249, v249, v250
    v_accvgpr_write_b32 a178, v249
    v_accvgpr_read_b32 v249, a179
    v_mul_f32 v249, v249, v250
    v_accvgpr_write_b32 a179, v249
    v_accvgpr_read_b32 v249, a180
    v_mul_f32 v249, v249, v250
    v_accvgpr_write_b32 a180, v249
    v_accvgpr_read_b32 v249, a181
    v_mul_f32 v249, v249, v250
    v_accvgpr_write_b32 a181, v249
    v_accvgpr_read_b32 v249, a182
    v_mul_f32 v249, v249, v250
    v_accvgpr_write_b32 a182, v249
    v_accvgpr_read_b32 v249, a183
    v_mul_f32 v249, v249, v250
    v_accvgpr_write_b32 a183, v249
    v_accvgpr_read_b32 v249, a184
    v_mul_f32 v249, v249, v250
    v_accvgpr_write_b32 a184, v249
    v_accvgpr_read_b32 v249, a185
    v_mul_f32 v249, v249, v250
    v_accvgpr_write_b32 a185, v249
    v_accvgpr_read_b32 v249, a186
    v_mul_f32 v249, v249, v250
    v_accvgpr_write_b32 a186, v249
    v_accvgpr_read_b32 v249, a187
    v_mul_f32 v249, v249, v250
    v_accvgpr_write_b32 a187, v249
    v_accvgpr_read_b32 v249, a188
    v_mul_f32 v249, v249, v250
    v_accvgpr_write_b32 a188, v249
    v_accvgpr_read_b32 v249, a189
    v_mul_f32 v249, v249, v250
    v_accvgpr_write_b32 a189, v249
    v_accvgpr_read_b32 v249, a190
    v_mul_f32 v249, v249, v250
    v_accvgpr_write_b32 a190, v249
    v_accvgpr_read_b32 v249, a191
    v_mul_f32 v249, v249, v250
    v_accvgpr_write_b32 a191, v249
    s_nop 3
    s_setpc_b64 s[70:71]
L_rare10:
    s_nop 15
    v_max3_f32 v248, v184, v185, v186
    v_max3_f32 v248, v248, v187, v208
    v_max3_f32 v248, v248, v209, v210
    v_max3_f32 v248, v248, v211, 0
    v_mov_b32 v249, v248
    s_nop 1
    v_permlane16_swap_b32 v248, v249
    v_max_f32 v248, v248, v249
    v_mov_b32 v249, v248
    s_nop 1
    v_permlane32_swap_b32 v248, v249
    v_max_f32 v248, v248, v249
    v_exp_f32 v250, -v248
    v_sub_f32 v160, v160, v248
    v_sub_f32 v161, v161, v248
    v_sub_f32 v162, v162, v248
    v_sub_f32 v163, v163, v248
    v_mul_f32 v238, v232, v250
    v_sub_f32 v184, v184, v248
    v_sub_f32 v185, v185, v248
    v_sub_f32 v186, v186, v248
    v_sub_f32 v187, v187, v248
    v_sub_f32 v208, v208, v248
    v_sub_f32 v209, v209, v248
    v_sub_f32 v210, v210, v248
    v_sub_f32 v211, v211, v248
    v_exp_f32 v184, v184
    v_exp_f32 v185, v185
    v_exp_f32 v186, v186
    v_exp_f32 v187, v187
    v_exp_f32 v208, v208
    v_exp_f32 v209, v209
    v_exp_f32 v210, v210
    v_exp_f32 v211, v211
    v_add_f32 v238, v238, v184
    v_add_f32 v238, v238, v185
    v_add_f32 v238, v238, v186
    v_add_f32 v238, v238, v187
    v_add_f32 v238, v238, v208
    v_add_f32 v238, v238, v209
    v_add_f32 v238, v238, v210
    v_add_f32 v238, v238, v211
    v_cvt_pk_bf16_f32 v40, v184, v185
    v_cvt_pk_bf16_f32 v41, v186, v187
    v_cvt_pk_bf16_f32 v42, v208, v209
    v_cvt_pk_bf16_f32 v43, v210, v211
    v_accvgpr_read_b32 v249, a0
    v_mul_f32 v249, v249, v250
    v_accvgpr_write_b32 a0, v249
    v_accvgpr_read_b32 v249, a1
    v_mul_f32 v249, v249, v250
    v_accvgpr_write_b32 a1, v249
    v_accvgpr_read_b32 v249, a2
    v_mul_f32 v249, v249, v250
    v_accvgpr_write_b32 a2, v249
    v_accvgpr_read_b32 v249, a3
    v_mul_f32 v249, v249, v250
    v_accvgpr_write_b32 a3, v249
    v_accvgpr_read_b32 v249, a4
    v_mul_f32 v249, v249, v250
    v_accvgpr_write_b32 a4, v249
    v_accvgpr_read_b32 v249, a5
    v_mul_f32 v249, v249, v250
    v_accvgpr_write_b32 a5, v249
    v_accvgpr_read_b32 v249, a6
    v_mul_f32 v249, v249, v250
    v_accvgpr_write_b32 a6, v249
    v_accvgpr_read_b32 v249, a7
    v_mul_f32 v249, v249, v250
    v_accvgpr_write_b32 a7, v249
    v_accvgpr_read_b32 v249, a8
    v_mul_f32 v249, v249, v250
    v_accvgpr_write_b32 a8, v249
    v_accvgpr_read_b32 v249, a9
    v_mul_f32 v249, v249, v250
    v_accvgpr_write_b32 a9, v249
    v_accvgpr_read_b32 v249, a10
    v_mul_f32 v249, v249, v250
    v_accvgpr_write_b32 a10, v249
    v_accvgpr_read_b32 v249, a11
    v_mul_f32 v249, v249, v250
    v_accvgpr_write_b32 a11, v249
    v_accvgpr_read_b32 v249, a12
    v_mul_f32 v249, v249, v250
    v_accvgpr_write_b32 a12, v249
    v_accvgpr_read_b32 v249, a13
    v_mul_f32 v249, v249, v250
    v_accvgpr_write_b32 a13, v249
    v_accvgpr_read_b32 v249, a14
    v_mul_f32 v249, v249, v250
    v_accvgpr_write_b32 a14, v249
    v_accvgpr_read_b32 v249, a15
    v_mul_f32 v249, v249, v250
    v_accvgpr_write_b32 a15, v249
    v_accvgpr_read_b32 v249, a16
    v_mul_f32 v249, v249, v250
    v_accvgpr_write_b32 a16, v249
    v_accvgpr_read_b32 v249, a17
    v_mul_f32 v249, v249, v250
    v_accvgpr_write_b32 a17, v249
    v_accvgpr_read_b32 v249, a18
    v_mul_f32 v249, v249, v250
    v_accvgpr_write_b32 a18, v249
    v_accvgpr_read_b32 v249, a19
    v_mul_f32 v249, v249, v250
    v_accvgpr_write_b32 a19, v249
    v_accvgpr_read_b32 v249, a20
    v_mul_f32 v249, v249, v250
    v_accvgpr_write_b32 a20, v249
    v_accvgpr_read_b32 v249, a21
    v_mul_f32 v249, v249, v250
    v_accvgpr_write_b32 a21, v249
    v_accvgpr_read_b32 v249, a22
    v_mul_f32 v249, v249, v250
    v_accvgpr_write_b32 a22, v249
    v_accvgpr_read_b32 v249, a23
    v_mul_f32 v249, v249, v250
    v_accvgpr_write_b32 a23, v249
    v_accvgpr_read_b32 v249, a24
    v_mul_f32 v249, v249, v250
    v_accvgpr_write_b32 a24, v249
    v_accvgpr_read_b32 v249, a25
    v_mul_f32 v249, v249, v250
    v_accvgpr_write_b32 a25, v249
    v_accvgpr_read_b32 v249, a26
    v_mul_f32 v249, v249, v250
    v_accvgpr_write_b32 a26, v249
    v_accvgpr_read_b32 v249, a27
    v_mul_f32 v249, v249, v250
    v_accvgpr_write_b32 a27, v249
    v_accvgpr_read_b32 v249, a28
    v_mul_f32 v249, v249, v250
    v_accvgpr_write_b32 a28, v249
    v_accvgpr_read_b32 v249, a29
    v_mul_f32 v249, v249, v250
    v_accvgpr_write_b32 a29, v249
    v_accvgpr_read_b32 v249, a30
    v_mul_f32 v249, v249, v250
    v_accvgpr_write_b32 a30, v249
    v_accvgpr_read_b32 v249, a31
    v_mul_f32 v249, v249, v250
    v_accvgpr_write_b32 a31, v249
    v_max3_f32 v248, v188, v189, v190
    v_max3_f32 v248, v248, v191, v212
    v_max3_f32 v248, v248, v213, v214
    v_max3_f32 v248, v248, v215, 0
    v_mov_b32 v249, v248
    s_nop 1
    v_permlane16_swap_b32 v248, v249
    v_max_f32 v248, v248, v249
    v_mov_b32 v249, v248
    s_nop 1
    v_permlane32_swap_b32 v248, v249
    v_max_f32 v248, v248, v249
    v_exp_f32 v250, -v248
    v_sub_f32 v164, v164, v248
    v_sub_f32 v165, v165, v248
    v_sub_f32 v166, v166, v248
    v_sub_f32 v167, v167, v248
    v_mul_f32 v239, v233, v250
    v_sub_f32 v188, v188, v248
    v_sub_f32 v189, v189, v248
    v_sub_f32 v190, v190, v248
    v_sub_f32 v191, v191, v248
    v_sub_f32 v212, v212, v248
    v_sub_f32 v213, v213, v248
    v_sub_f32 v214, v214, v248
    v_sub_f32 v215, v215, v248
    v_exp_f32 v188, v188
    v_exp_f32 v189, v189
    v_exp_f32 v190, v190
    v_exp_f32 v191, v191
    v_exp_f32 v212, v212
    v_exp_f32 v213, v213
    v_exp_f32 v214, v214
    v_exp_f32 v215, v215
    v_add_f32 v239, v239, v188
    v_add_f32 v239, v239, v189
    v_add_f32 v239, v239, v190
    v_add_f32 v239, v239, v191
    v_add_f32 v239, v239, v212
    v_add_f32 v239, v239, v213
    v_add_f32 v239, v239, v214
    v_add_f32 v239, v239, v215
    v_cvt_pk_bf16_f32 v44, v188, v189
    v_cvt_pk_bf16_f32 v45, v190, v191
    v_cvt_pk_bf16_f32 v46, v212, v213
    v_cvt_pk_bf16_f32 v47, v214, v215
    v_accvgpr_read_b32 v249, a32
    v_mul_f32 v249, v249, v250
    v_accvgpr_write_b32 a32, v249
    v_accvgpr_read_b32 v249, a33
    v_mul_f32 v249, v249, v250
    v_accvgpr_write_b32 a33, v249
    v_accvgpr_read_b32 v249, a34
    v_mul_f32 v249, v249, v250
    v_accvgpr_write_b32 a34, v249
    v_accvgpr_read_b32 v249, a35
    v_mul_f32 v249, v249, v250
    v_accvgpr_write_b32 a35, v249
    v_accvgpr_read_b32 v249, a36
    v_mul_f32 v249, v249, v250
    v_accvgpr_write_b32 a36, v249
    v_accvgpr_read_b32 v249, a37
    v_mul_f32 v249, v249, v250
    v_accvgpr_write_b32 a37, v249
    v_accvgpr_read_b32 v249, a38
    v_mul_f32 v249, v249, v250
    v_accvgpr_write_b32 a38, v249
    v_accvgpr_read_b32 v249, a39
    v_mul_f32 v249, v249, v250
    v_accvgpr_write_b32 a39, v249
    v_accvgpr_read_b32 v249, a40
    v_mul_f32 v249, v249, v250
    v_accvgpr_write_b32 a40, v249
    v_accvgpr_read_b32 v249, a41
    v_mul_f32 v249, v249, v250
    v_accvgpr_write_b32 a41, v249
    v_accvgpr_read_b32 v249, a42
    v_mul_f32 v249, v249, v250
    v_accvgpr_write_b32 a42, v249
    v_accvgpr_read_b32 v249, a43
    v_mul_f32 v249, v249, v250
    v_accvgpr_write_b32 a43, v249
    v_accvgpr_read_b32 v249, a44
    v_mul_f32 v249, v249, v250
    v_accvgpr_write_b32 a44, v249
    v_accvgpr_read_b32 v249, a45
    v_mul_f32 v249, v249, v250
    v_accvgpr_write_b32 a45, v249
    v_accvgpr_read_b32 v249, a46
    v_mul_f32 v249, v249, v250
    v_accvgpr_write_b32 a46, v249
    v_accvgpr_read_b32 v249, a47
    v_mul_f32 v249, v249, v250
    v_accvgpr_write_b32 a47, v249
    v_accvgpr_read_b32 v249, a48
    v_mul_f32 v249, v249, v250
    v_accvgpr_write_b32 a48, v249
    v_accvgpr_read_b32 v249, a49
    v_mul_f32 v249, v249, v250
    v_accvgpr_write_b32 a49, v249
    v_accvgpr_read_b32 v249, a50
    v_mul_f32 v249, v249, v250
    v_accvgpr_write_b32 a50, v249
    v_accvgpr_read_b32 v249, a51
    v_mul_f32 v249, v249, v250
    v_accvgpr_write_b32 a51, v249
    v_accvgpr_read_b32 v249, a52
    v_mul_f32 v249, v249, v250
    v_accvgpr_write_b32 a52, v249
    v_accvgpr_read_b32 v249, a53
    v_mul_f32 v249, v249, v250
    v_accvgpr_write_b32 a53, v249
    v_accvgpr_read_b32 v249, a54
    v_mul_f32 v249, v249, v250
    v_accvgpr_write_b32 a54, v249
    v_accvgpr_read_b32 v249, a55
    v_mul_f32 v249, v249, v250
    v_accvgpr_write_b32 a55, v249
    v_accvgpr_read_b32 v249, a56
    v_mul_f32 v249, v249, v250
    v_accvgpr_write_b32 a56, v249
    v_accvgpr_read_b32 v249, a57
    v_mul_f32 v249, v249, v250
    v_accvgpr_write_b32 a57, v249
    v_accvgpr_read_b32 v249, a58
    v_mul_f32 v249, v249, v250
    v_accvgpr_write_b32 a58, v249
    v_accvgpr_read_b32 v249, a59
    v_mul_f32 v249, v249, v250
    v_accvgpr_write_b32 a59, v249
    v_accvgpr_read_b32 v249, a60
    v_mul_f32 v249, v249, v250
    v_accvgpr_write_b32 a60, v249
    v_accvgpr_read_b32 v249, a61
    v_mul_f32 v249, v249, v250
    v_accvgpr_write_b32 a61, v249
    v_accvgpr_read_b32 v249, a62
    v_mul_f32 v249, v249, v250
    v_accvgpr_write_b32 a62, v249
    v_accvgpr_read_b32 v249, a63
    v_mul_f32 v249, v249, v250
    v_accvgpr_write_b32 a63, v249
    v_max3_f32 v248, v192, v193, v194
    v_max3_f32 v248, v248, v195, v216
    v_max3_f32 v248, v248, v217, v218
    v_max3_f32 v248, v248, v219, 0
    v_mov_b32 v249, v248
    s_nop 1
    v_permlane16_swap_b32 v248, v249
    v_max_f32 v248, v248, v249
    v_mov_b32 v249, v248
    s_nop 1
    v_permlane32_swap_b32 v248, v249
    v_max_f32 v248, v248, v249
    v_exp_f32 v250, -v248
    v_sub_f32 v168, v168, v248
    v_sub_f32 v169, v169, v248
    v_sub_f32 v170, v170, v248
    v_sub_f32 v171, v171, v248
    v_mul_f32 v240, v234, v250
    v_sub_f32 v192, v192, v248
    v_sub_f32 v193, v193, v248
    v_sub_f32 v194, v194, v248
    v_sub_f32 v195, v195, v248
    v_sub_f32 v216, v216, v248
    v_sub_f32 v217, v217, v248
    v_sub_f32 v218, v218, v248
    v_sub_f32 v219, v219, v248
    v_exp_f32 v192, v192
    v_exp_f32 v193, v193
    v_exp_f32 v194, v194
    v_exp_f32 v195, v195
    v_exp_f32 v216, v216
    v_exp_f32 v217, v217
    v_exp_f32 v218, v218
    v_exp_f32 v219, v219
    v_add_f32 v240, v240, v192
    v_add_f32 v240, v240, v193
    v_add_f32 v240, v240, v194
    v_add_f32 v240, v240, v195
    v_add_f32 v240, v240, v216
    v_add_f32 v240, v240, v217
    v_add_f32 v240, v240, v218
    v_add_f32 v240, v240, v219
    v_cvt_pk_bf16_f32 v48, v192, v193
    v_cvt_pk_bf16_f32 v49, v194, v195
    v_cvt_pk_bf16_f32 v50, v216, v217
    v_cvt_pk_bf16_f32 v51, v218, v219
    v_accvgpr_read_b32 v249, a64
    v_mul_f32 v249, v249, v250
    v_accvgpr_write_b32 a64, v249
    v_accvgpr_read_b32 v249, a65
    v_mul_f32 v249, v249, v250
    v_accvgpr_write_b32 a65, v249
    v_accvgpr_read_b32 v249, a66
    v_mul_f32 v249, v249, v250
    v_accvgpr_write_b32 a66, v249
    v_accvgpr_read_b32 v249, a67
    v_mul_f32 v249, v249, v250
    v_accvgpr_write_b32 a67, v249
    v_accvgpr_read_b32 v249, a68
    v_mul_f32 v249, v249, v250
    v_accvgpr_write_b32 a68, v249
    v_accvgpr_read_b32 v249, a69
    v_mul_f32 v249, v249, v250
    v_accvgpr_write_b32 a69, v249
    v_accvgpr_read_b32 v249, a70
    v_mul_f32 v249, v249, v250
    v_accvgpr_write_b32 a70, v249
    v_accvgpr_read_b32 v249, a71
    v_mul_f32 v249, v249, v250
    v_accvgpr_write_b32 a71, v249
    v_accvgpr_read_b32 v249, a72
    v_mul_f32 v249, v249, v250
    v_accvgpr_write_b32 a72, v249
    v_accvgpr_read_b32 v249, a73
    v_mul_f32 v249, v249, v250
    v_accvgpr_write_b32 a73, v249
    v_accvgpr_read_b32 v249, a74
    v_mul_f32 v249, v249, v250
    v_accvgpr_write_b32 a74, v249
    v_accvgpr_read_b32 v249, a75
    v_mul_f32 v249, v249, v250
    v_accvgpr_write_b32 a75, v249
    v_accvgpr_read_b32 v249, a76
    v_mul_f32 v249, v249, v250
    v_accvgpr_write_b32 a76, v249
    v_accvgpr_read_b32 v249, a77
    v_mul_f32 v249, v249, v250
    v_accvgpr_write_b32 a77, v249
    v_accvgpr_read_b32 v249, a78
    v_mul_f32 v249, v249, v250
    v_accvgpr_write_b32 a78, v249
    v_accvgpr_read_b32 v249, a79
    v_mul_f32 v249, v249, v250
    v_accvgpr_write_b32 a79, v249
    v_accvgpr_read_b32 v249, a80
    v_mul_f32 v249, v249, v250
    v_accvgpr_write_b32 a80, v249
    v_accvgpr_read_b32 v249, a81
    v_mul_f32 v249, v249, v250
    v_accvgpr_write_b32 a81, v249
    v_accvgpr_read_b32 v249, a82
    v_mul_f32 v249, v249, v250
    v_accvgpr_write_b32 a82, v249
    v_accvgpr_read_b32 v249, a83
    v_mul_f32 v249, v249, v250
    v_accvgpr_write_b32 a83, v249
    v_accvgpr_read_b32 v249, a84
    v_mul_f32 v249, v249, v250
    v_accvgpr_write_b32 a84, v249
    v_accvgpr_read_b32 v249, a85
    v_mul_f32 v249, v249, v250
    v_accvgpr_write_b32 a85, v249
    v_accvgpr_read_b32 v249, a86
    v_mul_f32 v249, v249, v250
    v_accvgpr_write_b32 a86, v249
    v_accvgpr_read_b32 v249, a87
    v_mul_f32 v249, v249, v250
    v_accvgpr_write_b32 a87, v249
    v_accvgpr_read_b32 v249, a88
    v_mul_f32 v249, v249, v250
    v_accvgpr_write_b32 a88, v249
    v_accvgpr_read_b32 v249, a89
    v_mul_f32 v249, v249, v250
    v_accvgpr_write_b32 a89, v249
    v_accvgpr_read_b32 v249, a90
    v_mul_f32 v249, v249, v250
    v_accvgpr_write_b32 a90, v249
    v_accvgpr_read_b32 v249, a91
    v_mul_f32 v249, v249, v250
    v_accvgpr_write_b32 a91, v249
    v_accvgpr_read_b32 v249, a92
    v_mul_f32 v249, v249, v250
    v_accvgpr_write_b32 a92, v249
    v_accvgpr_read_b32 v249, a93
    v_mul_f32 v249, v249, v250
    v_accvgpr_write_b32 a93, v249
    v_accvgpr_read_b32 v249, a94
    v_mul_f32 v249, v249, v250
    v_accvgpr_write_b32 a94, v249
    v_accvgpr_read_b32 v249, a95
    v_mul_f32 v249, v249, v250
    v_accvgpr_write_b32 a95, v249
    s_nop 3
    s_setpc_b64 s[70:71]
L_rare11:
    s_nop 15
    v_max3_f32 v248, v196, v197, v198
    v_max3_f32 v248, v248, v199, v220
    v_max3_f32 v248, v248, v221, v222
    v_max3_f32 v248, v248, v223, 0
    v_mov_b32 v249, v248
    s_nop 1
    v_permlane16_swap_b32 v248, v249
    v_max_f32 v248, v248, v249
    v_mov_b32 v249, v248
    s_nop 1
    v_permlane32_swap_b32 v248, v249
    v_max_f32 v248, v248, v249
    v_exp_f32 v250, -v248
    v_sub_f32 v172, v172, v248
    v_sub_f32 v173, v173, v248
    v_sub_f32 v174, v174, v248
    v_sub_f32 v175, v175, v248
    v_mul_f32 v241, v235, v250
    v_sub_f32 v196, v196, v248
    v_sub_f32 v197, v197, v248
    v_sub_f32 v198, v198, v248
    v_sub_f32 v199, v199, v248
    v_sub_f32 v220, v220, v248
    v_sub_f32 v221, v221, v248
    v_sub_f32 v222, v222, v248
    v_sub_f32 v223, v223, v248
    v_exp_f32 v196, v196
    v_exp_f32 v197, v197
    v_exp_f32 v198, v198
    v_exp_f32 v199, v199
    v_exp_f32 v220, v220
    v_exp_f32 v221, v221
    v_exp_f32 v222, v222
    v_exp_f32 v223, v223
    v_add_f32 v241, v241, v196
    v_add_f32 v241, v241, v197
    v_add_f32 v241, v241, v198
    v_add_f32 v241, v241, v199
    v_add_f32 v241, v241, v220
    v_add_f32 v241, v241, v221
    v_add_f32 v241, v241, v222
    v_add_f32 v241, v241, v223
    v_cvt_pk_bf16_f32 v52, v196, v197
    v_cvt_pk_bf16_f32 v53, v198, v199
    v_cvt_pk_bf16_f32 v54, v220, v221
    v_cvt_pk_bf16_f32 v55, v222, v223
    v_accvgpr_read_b32 v249, a96
    v_mul_f32 v249, v249, v250
    v_accvgpr_write_b32 a96, v249
    v_accvgpr_read_b32 v249, a97
    v_mul_f32 v249, v249, v250
    v_accvgpr_write_b32 a97, v249
    v_accvgpr_read_b32 v249, a98
    v_mul_f32 v249, v249, v250
    v_accvgpr_write_b32 a98, v249
    v_accvgpr_read_b32 v249, a99
    v_mul_f32 v249, v249, v250
    v_accvgpr_write_b32 a99, v249
    v_accvgpr_read_b32 v249, a100
    v_mul_f32 v249, v249, v250
    v_accvgpr_write_b32 a100, v249
    v_accvgpr_read_b32 v249, a101
    v_mul_f32 v249, v249, v250
    v_accvgpr_write_b32 a101, v249
    v_accvgpr_read_b32 v249, a102
    v_mul_f32 v249, v249, v250
    v_accvgpr_write_b32 a102, v249
    v_accvgpr_read_b32 v249, a103
    v_mul_f32 v249, v249, v250
    v_accvgpr_write_b32 a103, v249
    v_accvgpr_read_b32 v249, a104
    v_mul_f32 v249, v249, v250
    v_accvgpr_write_b32 a104, v249
    v_accvgpr_read_b32 v249, a105
    v_mul_f32 v249, v249, v250
    v_accvgpr_write_b32 a105, v249
    v_accvgpr_read_b32 v249, a106
    v_mul_f32 v249, v249, v250
    v_accvgpr_write_b32 a106, v249
    v_accvgpr_read_b32 v249, a107
    v_mul_f32 v249, v249, v250
    v_accvgpr_write_b32 a107, v249
    v_accvgpr_read_b32 v249, a108
    v_mul_f32 v249, v249, v250
    v_accvgpr_write_b32 a108, v249
    v_accvgpr_read_b32 v249, a109
    v_mul_f32 v249, v249, v250
    v_accvgpr_write_b32 a109, v249
    v_accvgpr_read_b32 v249, a110
    v_mul_f32 v249, v249, v250
    v_accvgpr_write_b32 a110, v249
    v_accvgpr_read_b32 v249, a111
    v_mul_f32 v249, v249, v250
    v_accvgpr_write_b32 a111, v249
    v_accvgpr_read_b32 v249, a112
    v_mul_f32 v249, v249, v250
    v_accvgpr_write_b32 a112, v249
    v_accvgpr_read_b32 v249, a113
    v_mul_f32 v249, v249, v250
    v_accvgpr_write_b32 a113, v249
    v_accvgpr_read_b32 v249, a114
    v_mul_f32 v249, v249, v250
    v_accvgpr_write_b32 a114, v249
    v_accvgpr_read_b32 v249, a115
    v_mul_f32 v249, v249, v250
    v_accvgpr_write_b32 a115, v249
    v_accvgpr_read_b32 v249, a116
    v_mul_f32 v249, v249, v250
    v_accvgpr_write_b32 a116, v249
    v_accvgpr_read_b32 v249, a117
    v_mul_f32 v249, v249, v250
    v_accvgpr_write_b32 a117, v249
    v_accvgpr_read_b32 v249, a118
    v_mul_f32 v249, v249, v250
    v_accvgpr_write_b32 a118, v249
    v_accvgpr_read_b32 v249, a119
    v_mul_f32 v249, v249, v250
    v_accvgpr_write_b32 a119, v249
    v_accvgpr_read_b32 v249, a120
    v_mul_f32 v249, v249, v250
    v_accvgpr_write_b32 a120, v249
    v_accvgpr_read_b32 v249, a121
    v_mul_f32 v249, v249, v250
    v_accvgpr_write_b32 a121, v249
    v_accvgpr_read_b32 v249, a122
    v_mul_f32 v249, v249, v250
    v_accvgpr_write_b32 a122, v249
    v_accvgpr_read_b32 v249, a123
    v_mul_f32 v249, v249, v250
    v_accvgpr_write_b32 a123, v249
    v_accvgpr_read_b32 v249, a124
    v_mul_f32 v249, v249, v250
    v_accvgpr_write_b32 a124, v249
    v_accvgpr_read_b32 v249, a125
    v_mul_f32 v249, v249, v250
    v_accvgpr_write_b32 a125, v249
    v_accvgpr_read_b32 v249, a126
    v_mul_f32 v249, v249, v250
    v_accvgpr_write_b32 a126, v249
    v_accvgpr_read_b32 v249, a127
    v_mul_f32 v249, v249, v250
    v_accvgpr_write_b32 a127, v249
    v_max3_f32 v248, v200, v201, v202
    v_max3_f32 v248, v248, v203, v224
    v_max3_f32 v248, v248, v225, v226
    v_max3_f32 v248, v248, v227, 0
    v_mov_b32 v249, v248
    s_nop 1
    v_permlane16_swap_b32 v248, v249
    v_max_f32 v248, v248, v249
    v_mov_b32 v249, v248
    s_nop 1
    v_permlane32_swap_b32 v248, v249
    v_max_f32 v248, v248, v249
    v_exp_f32 v250, -v248
    v_sub_f32 v176, v176, v248
    v_sub_f32 v177, v177, v248
    v_sub_f32 v178, v178, v248
    v_sub_f32 v179, v179, v248
    v_mul_f32 v242, v236, v250
    v_sub_f32 v200, v200, v248
    v_sub_f32 v201, v201, v248
    v_sub_f32 v202, v202, v248
    v_sub_f32 v203, v203, v248
    v_sub_f32 v224, v224, v248
    v_sub_f32 v225, v225, v248
    v_sub_f32 v226, v226, v248
    v_sub_f32 v227, v227, v248
    v_exp_f32 v200, v200
    v_exp_f32 v201, v201
    v_exp_f32 v202, v202
    v_exp_f32 v203, v203
    v_exp_f32 v224, v224
    v_exp_f32 v225, v225
    v_exp_f32 v226, v226
    v_exp_f32 v227, v227
    v_add_f32 v242, v242, v200
    v_add_f32 v242, v242, v201
    v_add_f32 v242, v242, v202
    v_add_f32 v242, v242, v203
    v_add_f32 v242, v242, v224
    v_add_f32 v242, v242, v225
    v_add_f32 v242, v242, v226
    v_add_f32 v242, v242, v227
    v_cvt_pk_bf16_f32 v56, v200, v201
    v_cvt_pk_bf16_f32 v57, v202, v203
    v_cvt_pk_bf16_f32 v58, v224, v225
    v_cvt_pk_bf16_f32 v59, v226, v227
    v_accvgpr_read_b32 v249, a128
    v_mul_f32 v249, v249, v250
    v_accvgpr_write_b32 a128, v249
    v_accvgpr_read_b32 v249, a129
    v_mul_f32 v249, v249, v250
    v_accvgpr_write_b32 a129, v249
    v_accvgpr_read_b32 v249, a130
    v_mul_f32 v249, v249, v250
    v_accvgpr_write_b32 a130, v249
    v_accvgpr_read_b32 v249, a131
    v_mul_f32 v249, v249, v250
    v_accvgpr_write_b32 a131, v249
    v_accvgpr_read_b32 v249, a132
    v_mul_f32 v249, v249, v250
    v_accvgpr_write_b32 a132, v249
    v_accvgpr_read_b32 v249, a133
    v_mul_f32 v249, v249, v250
    v_accvgpr_write_b32 a133, v249
    v_accvgpr_read_b32 v249, a134
    v_mul_f32 v249, v249, v250
    v_accvgpr_write_b32 a134, v249
    v_accvgpr_read_b32 v249, a135
    v_mul_f32 v249, v249, v250
    v_accvgpr_write_b32 a135, v249
    v_accvgpr_read_b32 v249, a136
    v_mul_f32 v249, v249, v250
    v_accvgpr_write_b32 a136, v249
    v_accvgpr_read_b32 v249, a137
    v_mul_f32 v249, v249, v250
    v_accvgpr_write_b32 a137, v249
    v_accvgpr_read_b32 v249, a138
    v_mul_f32 v249, v249, v250
    v_accvgpr_write_b32 a138, v249
    v_accvgpr_read_b32 v249, a139
    v_mul_f32 v249, v249, v250
    v_accvgpr_write_b32 a139, v249
    v_accvgpr_read_b32 v249, a140
    v_mul_f32 v249, v249, v250
    v_accvgpr_write_b32 a140, v249
    v_accvgpr_read_b32 v249, a141
    v_mul_f32 v249, v249, v250
    v_accvgpr_write_b32 a141, v249
    v_accvgpr_read_b32 v249, a142
    v_mul_f32 v249, v249, v250
    v_accvgpr_write_b32 a142, v249
    v_accvgpr_read_b32 v249, a143
    v_mul_f32 v249, v249, v250
    v_accvgpr_write_b32 a143, v249
    v_accvgpr_read_b32 v249, a144
    v_mul_f32 v249, v249, v250
    v_accvgpr_write_b32 a144, v249
    v_accvgpr_read_b32 v249, a145
    v_mul_f32 v249, v249, v250
    v_accvgpr_write_b32 a145, v249
    v_accvgpr_read_b32 v249, a146
    v_mul_f32 v249, v249, v250
    v_accvgpr_write_b32 a146, v249
    v_accvgpr_read_b32 v249, a147
    v_mul_f32 v249, v249, v250
    v_accvgpr_write_b32 a147, v249
    v_accvgpr_read_b32 v249, a148
    v_mul_f32 v249, v249, v250
    v_accvgpr_write_b32 a148, v249
    v_accvgpr_read_b32 v249, a149
    v_mul_f32 v249, v249, v250
    v_accvgpr_write_b32 a149, v249
    v_accvgpr_read_b32 v249, a150
    v_mul_f32 v249, v249, v250
    v_accvgpr_write_b32 a150, v249
    v_accvgpr_read_b32 v249, a151
    v_mul_f32 v249, v249, v250
    v_accvgpr_write_b32 a151, v249
    v_accvgpr_read_b32 v249, a152
    v_mul_f32 v249, v249, v250
    v_accvgpr_write_b32 a152, v249
    v_accvgpr_read_b32 v249, a153
    v_mul_f32 v249, v249, v250
    v_accvgpr_write_b32 a153, v249
    v_accvgpr_read_b32 v249, a154
    v_mul_f32 v249, v249, v250
    v_accvgpr_write_b32 a154, v249
    v_accvgpr_read_b32 v249, a155
    v_mul_f32 v249, v249, v250
    v_accvgpr_write_b32 a155, v249
    v_accvgpr_read_b32 v249, a156
    v_mul_f32 v249, v249, v250
    v_accvgpr_write_b32 a156, v249
    v_accvgpr_read_b32 v249, a157
    v_mul_f32 v249, v249, v250
    v_accvgpr_write_b32 a157, v249
    v_accvgpr_read_b32 v249, a158
    v_mul_f32 v249, v249, v250
    v_accvgpr_write_b32 a158, v249
    v_accvgpr_read_b32 v249, a159
    v_mul_f32 v249, v249, v250
    v_accvgpr_write_b32 a159, v249
    v_max3_f32 v248, v204, v205, v206
    v_max3_f32 v248, v248, v207, v228
    v_max3_f32 v248, v248, v229, v230
    v_max3_f32 v248, v248, v231, 0
    v_mov_b32 v249, v248
    s_nop 1
    v_permlane16_swap_b32 v248, v249
    v_max_f32 v248, v248, v249
    v_mov_b32 v249, v248
    s_nop 1
    v_permlane32_swap_b32 v248, v249
    v_max_f32 v248, v248, v249
    v_exp_f32 v250, -v248
    v_sub_f32 v180, v180, v248
    v_sub_f32 v181, v181, v248
    v_sub_f32 v182, v182, v248
    v_sub_f32 v183, v183, v248
    v_mul_f32 v243, v237, v250
    v_sub_f32 v204, v204, v248
    v_sub_f32 v205, v205, v248
    v_sub_f32 v206, v206, v248
    v_sub_f32 v207, v207, v248
    v_sub_f32 v228, v228, v248
    v_sub_f32 v229, v229, v248
    v_sub_f32 v230, v230, v248
    v_sub_f32 v231, v231, v248
    v_exp_f32 v204, v204
    v_exp_f32 v205, v205
    v_exp_f32 v206, v206
    v_exp_f32 v207, v207
    v_exp_f32 v228, v228
    v_exp_f32 v229, v229
    v_exp_f32 v230, v230
    v_exp_f32 v231, v231
    v_add_f32 v243, v243, v204
    v_add_f32 v243, v243, v205
    v_add_f32 v243, v243, v206
    v_add_f32 v243, v243, v207
    v_add_f32 v243, v243, v228
    v_add_f32 v243, v243, v229
    v_add_f32 v243, v243, v230
    v_add_f32 v243, v243, v231
    v_cvt_pk_bf16_f32 v60, v204, v205
    v_cvt_pk_bf16_f32 v61, v206, v207
    v_cvt_pk_bf16_f32 v62, v228, v229
    v_cvt_pk_bf16_f32 v63, v230, v231
    v_accvgpr_read_b32 v249, a160
    v_mul_f32 v249, v249, v250
    v_accvgpr_write_b32 a160, v249
    v_accvgpr_read_b32 v249, a161
    v_mul_f32 v249, v249, v250
    v_accvgpr_write_b32 a161, v249
    v_accvgpr_read_b32 v249, a162
    v_mul_f32 v249, v249, v250
    v_accvgpr_write_b32 a162, v249
    v_accvgpr_read_b32 v249, a163
    v_mul_f32 v249, v249, v250
    v_accvgpr_write_b32 a163, v249
    v_accvgpr_read_b32 v249, a164
    v_mul_f32 v249, v249, v250
    v_accvgpr_write_b32 a164, v249
    v_accvgpr_read_b32 v249, a165
    v_mul_f32 v249, v249, v250
    v_accvgpr_write_b32 a165, v249
    v_accvgpr_read_b32 v249, a166
    v_mul_f32 v249, v249, v250
    v_accvgpr_write_b32 a166, v249
    v_accvgpr_read_b32 v249, a167
    v_mul_f32 v249, v249, v250
    v_accvgpr_write_b32 a167, v249
    v_accvgpr_read_b32 v249, a168
    v_mul_f32 v249, v249, v250
    v_accvgpr_write_b32 a168, v249
    v_accvgpr_read_b32 v249, a169
    v_mul_f32 v249, v249, v250
    v_accvgpr_write_b32 a169, v249
    v_accvgpr_read_b32 v249, a170
    v_mul_f32 v249, v249, v250
    v_accvgpr_write_b32 a170, v249
    v_accvgpr_read_b32 v249, a171
    v_mul_f32 v249, v249, v250
    v_accvgpr_write_b32 a171, v249
    v_accvgpr_read_b32 v249, a172
    v_mul_f32 v249, v249, v250
    v_accvgpr_write_b32 a172, v249
    v_accvgpr_read_b32 v249, a173
    v_mul_f32 v249, v249, v250
    v_accvgpr_write_b32 a173, v249
    v_accvgpr_read_b32 v249, a174
    v_mul_f32 v249, v249, v250
    v_accvgpr_write_b32 a174, v249
    v_accvgpr_read_b32 v249, a175
    v_mul_f32 v249, v249, v250
    v_accvgpr_write_b32 a175, v249
    v_accvgpr_read_b32 v249, a176
    v_mul_f32 v249, v249, v250
    v_accvgpr_write_b32 a176, v249
    v_accvgpr_read_b32 v249, a177
    v_mul_f32 v249, v249, v250
    v_accvgpr_write_b32 a177, v249
    v_accvgpr_read_b32 v249, a178
    v_mul_f32 v249, v249, v250
    v_accvgpr_write_b32 a178, v249
    v_accvgpr_read_b32 v249, a179
    v_mul_f32 v249, v249, v250
    v_accvgpr_write_b32 a179, v249
    v_accvgpr_read_b32 v249, a180
    v_mul_f32 v249, v249, v250
    v_accvgpr_write_b32 a180, v249
    v_accvgpr_read_b32 v249, a181
    v_mul_f32 v249, v249, v250
    v_accvgpr_write_b32 a181, v249
    v_accvgpr_read_b32 v249, a182
    v_mul_f32 v249, v249, v250
    v_accvgpr_write_b32 a182, v249
    v_accvgpr_read_b32 v249, a183
    v_mul_f32 v249, v249, v250
    v_accvgpr_write_b32 a183, v249
    v_accvgpr_read_b32 v249, a184
    v_mul_f32 v249, v249, v250
    v_accvgpr_write_b32 a184, v249
    v_accvgpr_read_b32 v249, a185
    v_mul_f32 v249, v249, v250
    v_accvgpr_write_b32 a185, v249
    v_accvgpr_read_b32 v249, a186
    v_mul_f32 v249, v249, v250
    v_accvgpr_write_b32 a186, v249
    v_accvgpr_read_b32 v249, a187
    v_mul_f32 v249, v249, v250
    v_accvgpr_write_b32 a187, v249
    v_accvgpr_read_b32 v249, a188
    v_mul_f32 v249, v249, v250
    v_accvgpr_write_b32 a188, v249
    v_accvgpr_read_b32 v249, a189
    v_mul_f32 v249, v249, v250
    v_accvgpr_write_b32 a189, v249
    v_accvgpr_read_b32 v249, a190
    v_mul_f32 v249, v249, v250
    v_accvgpr_write_b32 a190, v249
    v_accvgpr_read_b32 v249, a191
    v_mul_f32 v249, v249, v250
    v_accvgpr_write_b32 a191, v249
    s_nop 3
    s_setpc_b64 s[70:71]
.fill 256, 4, 0xbf810000
.section .rodata,"a"
.p2align 6
.amdhsa_kernel standalone__mha_block_cached__near_ridge_kernel
  .amdhsa_next_free_vgpr 512
  .amdhsa_next_free_sgpr 102
  .amdhsa_accum_offset 256
  .amdhsa_group_segment_fixed_size 0
  .amdhsa_kernarg_size 64
  .amdhsa_user_sgpr_count 2
  .amdhsa_user_sgpr_kernarg_segment_ptr 1
  .amdhsa_system_sgpr_workgroup_id_x 1
.end_amdhsa_kernel
```
